```python
import torch

def _softmax(x, axis=-1):
    return torch.softmax(x, dim=axis)

def _gelu(x):
    return torch.nn.functional.gelu(x, approximate='tanh')

def _silu(x):
    return torch.nn.functional.silu(x)

def _sigmoid(x):
    return torch.sigmoid(x)

def _layernorm(x, axis=-1, eps=1e-05):
    m = x.mean(dim=axis, keepdim=True)
    v = x.var(dim=axis, keepdim=True, unbiased=False)
    return (x - m) / torch.sqrt(v + eps)

def _scatter_add(tgt, idx, src, axis=0):
    return tgt.clone().index_add_(axis, idx, src)

def _segment_sum(src, seg, n):
    out = torch.zeros((n,) + src.shape[1:], dtype=src.dtype)
    return out.index_add_(0, seg, src)

def _pad(x, pw):
    flat = tuple((v for pair in reversed(pw) for v in pair))
    return torch.nn.functional.pad(x, flat)
kernel_name = 'adaLN_cond__memory_aug_recurrent_mem_tr__dense_activation_gelu__prompt'

def setup_inputs():

    _w = lambda a: (lambda t: t.to(torch.bfloat16) if t.is_floating_point() else t)(torch.as_tensor(a))

    def _A_setup():
        B, S, Dm = (1, 2048, 448)
        H, Dh = (16, 256)
        M, seg = (8, 32)
        seg = min(seg, S)
        S = S // seg * seg
        return {'x': _w((lambda *s: torch.randn(*s, dtype=torch.bfloat16) * 0.05)(B, S, Dm)), 'mem0': _w((lambda *s: torch.randn(*s, dtype=torch.bfloat16) * 0.8)(B, M, Dm)), 'Wq': _w((lambda *s: torch.randn(*s, dtype=torch.bfloat16) * 0.8)(Dm, H, Dh) * Dm ** (-0.5)), 'Wk': _w((lambda *s: torch.randn(*s, dtype=torch.bfloat16) * 0.8)(Dm, H, Dh) * Dm ** (-0.5)), 'Wv': _w((lambda *s: torch.randn(*s, dtype=torch.bfloat16) * 0.8)(Dm, H, Dh) * Dm ** (-0.5)), 'Wo': _w((lambda *s: torch.randn(*s, dtype=torch.bfloat16) * 0.8)(H, Dh, Dm) * (H * Dh) ** (-0.5)), 'seg_len': seg}
    _A_in = _A_setup()

    def _B_setup():
        B, S, D, F = (1, 2048, 448, 1792)
        return {'x': _w((lambda *s: torch.randn(*s, dtype=torch.bfloat16) * 0.05)(B, S, D)), 'w1': _w((lambda *s: torch.randn(*s, dtype=torch.bfloat16) * 0.8)(D, F) * D ** (-0.5)), 'b1': _w((lambda *s: torch.randn(*s, dtype=torch.bfloat16) * 12.8)(F) * 0.01), 'w2': _w((lambda *s: torch.randn(*s, dtype=torch.bfloat16) * 0.8)(F, D) * F ** (-0.5)), 'b2': _w((lambda *s: torch.randn(*s, dtype=torch.bfloat16) * 12.8)(D) * 0.01)}
    _B_in = _B_setup()
    return {'A_x': _A_in['x'], 'A_mem0': _A_in['mem0'], 'A_Wq': _A_in['Wq'], 'A_Wk': _A_in['Wk'], 'A_Wv': _A_in['Wv'], 'A_Wo': _A_in['Wo'], 'A_seg_len': _A_in['seg_len'], 'B_x': _B_in['x'], 'B_w1': _B_in['w1'], 'B_b1': _B_in['b1'], 'B_w2': _B_in['w2'], 'B_b2': _B_in['b2'], 'c': _w((lambda *s: torch.randn(*s, dtype=torch.bfloat16) * 0.1)(1, 448) * 8.0), 'w_mod': _w((lambda *s: torch.randn(*s, dtype=torch.bfloat16) * 0.1)(448, 6 * 448) * 448 ** (-0.5) * 8.0)}

def reference(A_x, A_mem0, A_Wq, A_Wk, A_Wv, A_Wo, A_seg_len, B_x, B_w1, B_b1, B_w2, B_b2, c, w_mod):

    def _A_ref(x, mem0, Wq, Wk, Wv, Wo, seg_len):
        B, S, Dm = x.shape
        H, Dh = (Wq.shape[1], Wq.shape[2])
        M = mem0.shape[1]
        scale = Dh ** (-0.5)
        n_seg = S // seg_len
        L = M + seg_len
        idx = torch.arange(L)
        mask = (idx[:, None] < M) | (idx[:, None] >= idx[None, :])
        mem = mem0
        outs = []
        for s in range(n_seg):
            xs = x[:, s * seg_len:(s + 1) * seg_len, :].clone()
            h = torch.concatenate([mem, xs], axis=1)
            q = torch.einsum('btd,dhe->bhte', h, Wq)
            k = torch.einsum('btd,dhe->bhte', h, Wk)
            v = torch.einsum('btd,dhe->bhte', h, Wv)
            scores = torch.einsum('bhqe,bhke->bhqk', q, k) * scale
            scores = torch.where(mask[None, None], scores, -1000000000.0)
            p = _softmax(scores, axis=-1)
            o = torch.einsum('bhqk,bhke->bhqe', p, v)
            o = torch.einsum('bhte,hed->btd', o, Wo)
            mem = o[:, :M, :].clone()
            outs.append(o[:, M:, :])
        return torch.concatenate(outs, axis=1)

    def _B_ref(x, w1, b1, w2, b2):
        h = torch.einsum('bsd,df->bsf', x, w1) + b1
        h = _gelu(h)
        return torch.einsum('bsf,fd->bsd', h, w2) + b2
    x = A_x
    mod = (_silu(c) @ w_mod).reshape(c.shape[0], 6, 1, -1)
    sa, ca, ga, sb, cb, gb = (mod[:, 0].clone(), mod[:, 1].clone(), mod[:, 2].clone(), mod[:, 3].clone(), mod[:, 4].clone(), mod[:, 5].clone())
    h = _layernorm(x, axis=-1) * (1 + ca) + sa
    x = x + ga * _A_ref(h, A_mem0, A_Wq, A_Wk, A_Wv, A_Wo, A_seg_len)
    h = _layernorm(x, axis=-1) * (1 + cb) + sb
    x = x + gb * _B_ref(h, B_w1, B_b1, B_w2, B_b2)
    return x
```

```asm
; @launch kernel=prea_kernel grid=(2560,1,1) block=(256,1,1) lds=36864
; @launch kernel=chain_kernel grid=(256,1,1) block=(256,1,1) lds=153600
.amdgcn_target "amdgcn-amd-amdhsa--gfx950"
.text
.globl prea_kernel
.p2align 8
.type prea_kernel,@function
prea_kernel:
    s_cmp_lt_u32 s2, 480
    s_cbranch_scc1 sub_prea_1
    s_sub_u32 s2, s2, 480
    s_cmp_lt_u32 s2, 784
    s_cbranch_scc1 sub_prea_2
    s_sub_u32 s2, s2, 784
    s_cmp_lt_u32 s2, 784
    s_cbranch_scc1 sub_prea_3
    s_sub_u32 s2, s2, 784
    s_cmp_lt_u32 s2, 512
    s_cbranch_scc1 sub_prea_4
    s_sub_u32 s2, s2, 512
    s_endpgm
sub_prea_1:
    s_cmp_ge_u32 s2, 477
    s_cbranch_scc1 end_prep0_1
    s_load_dwordx2 s[4:5], s[0:1], 96
    s_load_dwordx2 s[6:7], s[0:1], 104
    s_load_dwordx2 s[8:9], s[0:1], 128
    s_load_dwordx2 s[12:13], s[0:1], 40
    s_load_dwordx2 s[14:15], s[0:1], 64
    s_load_dwordx2 s[16:17], s[0:1], 80
    s_load_dwordx2 s[18:19], s[0:1], 8
    s_load_dwordx2 s[80:81], s[0:1], 120
    v_and_b32 v1, 63, v0
    v_lshrrev_b32 v2, 6, v0
    s_nop 0
    v_readfirstlane_b32 s10, v2
    s_waitcnt lgkmcnt(0)
    s_cmp_ge_u32 s2, 21
    s_cbranch_scc1 tr_prep0_2
    s_mul_i32 s11, s10, 112
    v_add_u32 v2, s11, v1
    v_min_u32 v3, 47, v1
    v_add_u32 v3, 64, v3
    v_add_u32 v3, s11, v3
    v_lshlrev_b32 v2, 1, v2
    v_lshlrev_b32 v3, 1, v3
    global_load_ushort v4, v2, s[4:5]
    global_load_ushort v5, v3, s[4:5]
    s_mul_i32 s20, s11, 5376
    s_lshl_b32 s21, s2, 8
    s_add_u32 s20, s20, s21
    v_lshlrev_b32 v6, 2, v1
    v_add_u32 v6, s20, v6
    s_waitcnt vmcnt(0)
    v_lshlrev_b32 v4, 16, v4
    v_mul_f32 v7, 0xbfb8aa3b, v4
    v_exp_f32 v7, v7
    s_nop 0
    v_add_f32 v7, 1.0, v7
    v_rcp_f32 v7, v7
    s_nop 0
    v_mul_f32 v4, v4, v7
    v_lshlrev_b32 v5, 16, v5
    v_mul_f32 v7, 0xbfb8aa3b, v5
    v_exp_f32 v7, v7
    s_nop 0
    v_add_f32 v7, 1.0, v7
    v_rcp_f32 v7, v7
    s_nop 0
    v_mul_f32 v5, v5, v7
    v_cvt_pk_bf16_f32 v7, v4, v5
    v_lshlrev_b32 v4, 16, v7
    v_and_b32 v5, 0xffff0000, v7
    v_mov_b32 v8, 0
    v_mov_b32 v9, 0
    global_load_dword v16, v6, s[6:7]
    v_add_u32 v6, 5376, v6
    global_load_dword v17, v6, s[6:7]
    v_add_u32 v6, 5376, v6
    global_load_dword v18, v6, s[6:7]
    v_add_u32 v6, 5376, v6
    global_load_dword v19, v6, s[6:7]
    v_add_u32 v6, 5376, v6
    global_load_dword v20, v6, s[6:7]
    v_add_u32 v6, 5376, v6
    global_load_dword v21, v6, s[6:7]
    v_add_u32 v6, 5376, v6
    global_load_dword v22, v6, s[6:7]
    v_add_u32 v6, 5376, v6
    global_load_dword v23, v6, s[6:7]
    v_add_u32 v6, 5376, v6
    global_load_dword v24, v6, s[6:7]
    v_add_u32 v6, 5376, v6
    global_load_dword v25, v6, s[6:7]
    v_add_u32 v6, 5376, v6
    global_load_dword v26, v6, s[6:7]
    v_add_u32 v6, 5376, v6
    global_load_dword v27, v6, s[6:7]
    v_add_u32 v6, 5376, v6
    global_load_dword v28, v6, s[6:7]
    v_add_u32 v6, 5376, v6
    global_load_dword v29, v6, s[6:7]
    v_add_u32 v6, 5376, v6
    global_load_dword v30, v6, s[6:7]
    v_add_u32 v6, 5376, v6
    global_load_dword v31, v6, s[6:7]
    v_add_u32 v6, 5376, v6
    global_load_dword v32, v6, s[6:7]
    v_add_u32 v6, 5376, v6
    global_load_dword v33, v6, s[6:7]
    v_add_u32 v6, 5376, v6
    global_load_dword v34, v6, s[6:7]
    v_add_u32 v6, 5376, v6
    global_load_dword v35, v6, s[6:7]
    v_add_u32 v6, 5376, v6
    global_load_dword v36, v6, s[6:7]
    v_add_u32 v6, 5376, v6
    global_load_dword v37, v6, s[6:7]
    v_add_u32 v6, 5376, v6
    global_load_dword v38, v6, s[6:7]
    v_add_u32 v6, 5376, v6
    global_load_dword v39, v6, s[6:7]
    v_add_u32 v6, 5376, v6
    global_load_dword v40, v6, s[6:7]
    v_add_u32 v6, 5376, v6
    global_load_dword v41, v6, s[6:7]
    v_add_u32 v6, 5376, v6
    global_load_dword v42, v6, s[6:7]
    v_add_u32 v6, 5376, v6
    global_load_dword v43, v6, s[6:7]
    v_add_u32 v6, 5376, v6
    global_load_dword v44, v6, s[6:7]
    v_add_u32 v6, 5376, v6
    global_load_dword v45, v6, s[6:7]
    v_add_u32 v6, 5376, v6
    global_load_dword v46, v6, s[6:7]
    v_add_u32 v6, 5376, v6
    global_load_dword v47, v6, s[6:7]
    v_add_u32 v6, 5376, v6
    global_load_dword v48, v6, s[6:7]
    v_add_u32 v6, 5376, v6
    global_load_dword v49, v6, s[6:7]
    v_add_u32 v6, 5376, v6
    global_load_dword v50, v6, s[6:7]
    v_add_u32 v6, 5376, v6
    global_load_dword v51, v6, s[6:7]
    v_add_u32 v6, 5376, v6
    global_load_dword v52, v6, s[6:7]
    v_add_u32 v6, 5376, v6
    global_load_dword v53, v6, s[6:7]
    v_add_u32 v6, 5376, v6
    global_load_dword v54, v6, s[6:7]
    v_add_u32 v6, 5376, v6
    global_load_dword v55, v6, s[6:7]
    v_add_u32 v6, 5376, v6
    global_load_dword v56, v6, s[6:7]
    v_add_u32 v6, 5376, v6
    global_load_dword v57, v6, s[6:7]
    v_add_u32 v6, 5376, v6
    global_load_dword v58, v6, s[6:7]
    v_add_u32 v6, 5376, v6
    global_load_dword v59, v6, s[6:7]
    v_add_u32 v6, 5376, v6
    global_load_dword v60, v6, s[6:7]
    v_add_u32 v6, 5376, v6
    global_load_dword v61, v6, s[6:7]
    v_add_u32 v6, 5376, v6
    global_load_dword v62, v6, s[6:7]
    v_add_u32 v6, 5376, v6
    global_load_dword v63, v6, s[6:7]
    v_add_u32 v6, 5376, v6
    global_load_dword v64, v6, s[6:7]
    v_add_u32 v6, 5376, v6
    global_load_dword v65, v6, s[6:7]
    v_add_u32 v6, 5376, v6
    global_load_dword v66, v6, s[6:7]
    v_add_u32 v6, 5376, v6
    global_load_dword v67, v6, s[6:7]
    v_add_u32 v6, 5376, v6
    global_load_dword v68, v6, s[6:7]
    v_add_u32 v6, 5376, v6
    global_load_dword v69, v6, s[6:7]
    v_add_u32 v6, 5376, v6
    global_load_dword v70, v6, s[6:7]
    v_add_u32 v6, 5376, v6
    global_load_dword v71, v6, s[6:7]
    v_add_u32 v6, 5376, v6
    v_readlane_b32 s24, v4, 0
    v_readlane_b32 s25, v4, 1
    v_readlane_b32 s26, v4, 2
    v_readlane_b32 s27, v4, 3
    v_readlane_b32 s28, v4, 4
    v_readlane_b32 s29, v4, 5
    v_readlane_b32 s30, v4, 6
    v_readlane_b32 s31, v4, 7
    v_readlane_b32 s32, v4, 8
    v_readlane_b32 s33, v4, 9
    v_readlane_b32 s34, v4, 10
    v_readlane_b32 s35, v4, 11
    v_readlane_b32 s36, v4, 12
    v_readlane_b32 s37, v4, 13
    v_readlane_b32 s38, v4, 14
    v_readlane_b32 s39, v4, 15
    v_readlane_b32 s40, v4, 16
    v_readlane_b32 s41, v4, 17
    v_readlane_b32 s42, v4, 18
    v_readlane_b32 s43, v4, 19
    v_readlane_b32 s44, v4, 20
    v_readlane_b32 s45, v4, 21
    v_readlane_b32 s46, v4, 22
    v_readlane_b32 s47, v4, 23
    v_readlane_b32 s48, v4, 24
    v_readlane_b32 s49, v4, 25
    v_readlane_b32 s50, v4, 26
    v_readlane_b32 s51, v4, 27
    v_readlane_b32 s52, v4, 28
    v_readlane_b32 s53, v4, 29
    v_readlane_b32 s54, v4, 30
    v_readlane_b32 s55, v4, 31
    v_readlane_b32 s56, v4, 32
    v_readlane_b32 s57, v4, 33
    v_readlane_b32 s58, v4, 34
    v_readlane_b32 s59, v4, 35
    v_readlane_b32 s60, v4, 36
    v_readlane_b32 s61, v4, 37
    v_readlane_b32 s62, v4, 38
    v_readlane_b32 s63, v4, 39
    v_readlane_b32 s64, v4, 40
    v_readlane_b32 s65, v4, 41
    v_readlane_b32 s66, v4, 42
    v_readlane_b32 s67, v4, 43
    v_readlane_b32 s68, v4, 44
    v_readlane_b32 s69, v4, 45
    v_readlane_b32 s70, v4, 46
    v_readlane_b32 s71, v4, 47
    v_readlane_b32 s72, v4, 48
    v_readlane_b32 s73, v4, 49
    v_readlane_b32 s74, v4, 50
    v_readlane_b32 s75, v4, 51
    v_readlane_b32 s76, v4, 52
    v_readlane_b32 s77, v4, 53
    v_readlane_b32 s78, v4, 54
    v_readlane_b32 s79, v4, 55
    s_waitcnt vmcnt(0)
    v_lshlrev_b32 v10, 16, v16
    v_and_b32 v11, 0xffff0000, v16
    v_fmac_f32 v8, s24, v10
    v_fmac_f32 v9, s24, v11
    v_lshlrev_b32 v10, 16, v17
    v_and_b32 v11, 0xffff0000, v17
    v_fmac_f32 v8, s25, v10
    v_fmac_f32 v9, s25, v11
    v_lshlrev_b32 v10, 16, v18
    v_and_b32 v11, 0xffff0000, v18
    v_fmac_f32 v8, s26, v10
    v_fmac_f32 v9, s26, v11
    v_lshlrev_b32 v10, 16, v19
    v_and_b32 v11, 0xffff0000, v19
    v_fmac_f32 v8, s27, v10
    v_fmac_f32 v9, s27, v11
    v_lshlrev_b32 v10, 16, v20
    v_and_b32 v11, 0xffff0000, v20
    v_fmac_f32 v8, s28, v10
    v_fmac_f32 v9, s28, v11
    v_lshlrev_b32 v10, 16, v21
    v_and_b32 v11, 0xffff0000, v21
    v_fmac_f32 v8, s29, v10
    v_fmac_f32 v9, s29, v11
    v_lshlrev_b32 v10, 16, v22
    v_and_b32 v11, 0xffff0000, v22
    v_fmac_f32 v8, s30, v10
    v_fmac_f32 v9, s30, v11
    v_lshlrev_b32 v10, 16, v23
    v_and_b32 v11, 0xffff0000, v23
    v_fmac_f32 v8, s31, v10
    v_fmac_f32 v9, s31, v11
    v_lshlrev_b32 v10, 16, v24
    v_and_b32 v11, 0xffff0000, v24
    v_fmac_f32 v8, s32, v10
    v_fmac_f32 v9, s32, v11
    v_lshlrev_b32 v10, 16, v25
    v_and_b32 v11, 0xffff0000, v25
    v_fmac_f32 v8, s33, v10
    v_fmac_f32 v9, s33, v11
    v_lshlrev_b32 v10, 16, v26
    v_and_b32 v11, 0xffff0000, v26
    v_fmac_f32 v8, s34, v10
    v_fmac_f32 v9, s34, v11
    v_lshlrev_b32 v10, 16, v27
    v_and_b32 v11, 0xffff0000, v27
    v_fmac_f32 v8, s35, v10
    v_fmac_f32 v9, s35, v11
    v_lshlrev_b32 v10, 16, v28
    v_and_b32 v11, 0xffff0000, v28
    v_fmac_f32 v8, s36, v10
    v_fmac_f32 v9, s36, v11
    v_lshlrev_b32 v10, 16, v29
    v_and_b32 v11, 0xffff0000, v29
    v_fmac_f32 v8, s37, v10
    v_fmac_f32 v9, s37, v11
    v_lshlrev_b32 v10, 16, v30
    v_and_b32 v11, 0xffff0000, v30
    v_fmac_f32 v8, s38, v10
    v_fmac_f32 v9, s38, v11
    v_lshlrev_b32 v10, 16, v31
    v_and_b32 v11, 0xffff0000, v31
    v_fmac_f32 v8, s39, v10
    v_fmac_f32 v9, s39, v11
    v_lshlrev_b32 v10, 16, v32
    v_and_b32 v11, 0xffff0000, v32
    v_fmac_f32 v8, s40, v10
    v_fmac_f32 v9, s40, v11
    v_lshlrev_b32 v10, 16, v33
    v_and_b32 v11, 0xffff0000, v33
    v_fmac_f32 v8, s41, v10
    v_fmac_f32 v9, s41, v11
    v_lshlrev_b32 v10, 16, v34
    v_and_b32 v11, 0xffff0000, v34
    v_fmac_f32 v8, s42, v10
    v_fmac_f32 v9, s42, v11
    v_lshlrev_b32 v10, 16, v35
    v_and_b32 v11, 0xffff0000, v35
    v_fmac_f32 v8, s43, v10
    v_fmac_f32 v9, s43, v11
    v_lshlrev_b32 v10, 16, v36
    v_and_b32 v11, 0xffff0000, v36
    v_fmac_f32 v8, s44, v10
    v_fmac_f32 v9, s44, v11
    v_lshlrev_b32 v10, 16, v37
    v_and_b32 v11, 0xffff0000, v37
    v_fmac_f32 v8, s45, v10
    v_fmac_f32 v9, s45, v11
    v_lshlrev_b32 v10, 16, v38
    v_and_b32 v11, 0xffff0000, v38
    v_fmac_f32 v8, s46, v10
    v_fmac_f32 v9, s46, v11
    v_lshlrev_b32 v10, 16, v39
    v_and_b32 v11, 0xffff0000, v39
    v_fmac_f32 v8, s47, v10
    v_fmac_f32 v9, s47, v11
    v_lshlrev_b32 v10, 16, v40
    v_and_b32 v11, 0xffff0000, v40
    v_fmac_f32 v8, s48, v10
    v_fmac_f32 v9, s48, v11
    v_lshlrev_b32 v10, 16, v41
    v_and_b32 v11, 0xffff0000, v41
    v_fmac_f32 v8, s49, v10
    v_fmac_f32 v9, s49, v11
    v_lshlrev_b32 v10, 16, v42
    v_and_b32 v11, 0xffff0000, v42
    v_fmac_f32 v8, s50, v10
    v_fmac_f32 v9, s50, v11
    v_lshlrev_b32 v10, 16, v43
    v_and_b32 v11, 0xffff0000, v43
    v_fmac_f32 v8, s51, v10
    v_fmac_f32 v9, s51, v11
    v_lshlrev_b32 v10, 16, v44
    v_and_b32 v11, 0xffff0000, v44
    v_fmac_f32 v8, s52, v10
    v_fmac_f32 v9, s52, v11
    v_lshlrev_b32 v10, 16, v45
    v_and_b32 v11, 0xffff0000, v45
    v_fmac_f32 v8, s53, v10
    v_fmac_f32 v9, s53, v11
    v_lshlrev_b32 v10, 16, v46
    v_and_b32 v11, 0xffff0000, v46
    v_fmac_f32 v8, s54, v10
    v_fmac_f32 v9, s54, v11
    v_lshlrev_b32 v10, 16, v47
    v_and_b32 v11, 0xffff0000, v47
    v_fmac_f32 v8, s55, v10
    v_fmac_f32 v9, s55, v11
    v_lshlrev_b32 v10, 16, v48
    v_and_b32 v11, 0xffff0000, v48
    v_fmac_f32 v8, s56, v10
    v_fmac_f32 v9, s56, v11
    v_lshlrev_b32 v10, 16, v49
    v_and_b32 v11, 0xffff0000, v49
    v_fmac_f32 v8, s57, v10
    v_fmac_f32 v9, s57, v11
    v_lshlrev_b32 v10, 16, v50
    v_and_b32 v11, 0xffff0000, v50
    v_fmac_f32 v8, s58, v10
    v_fmac_f32 v9, s58, v11
    v_lshlrev_b32 v10, 16, v51
    v_and_b32 v11, 0xffff0000, v51
    v_fmac_f32 v8, s59, v10
    v_fmac_f32 v9, s59, v11
    v_lshlrev_b32 v10, 16, v52
    v_and_b32 v11, 0xffff0000, v52
    v_fmac_f32 v8, s60, v10
    v_fmac_f32 v9, s60, v11
    v_lshlrev_b32 v10, 16, v53
    v_and_b32 v11, 0xffff0000, v53
    v_fmac_f32 v8, s61, v10
    v_fmac_f32 v9, s61, v11
    v_lshlrev_b32 v10, 16, v54
    v_and_b32 v11, 0xffff0000, v54
    v_fmac_f32 v8, s62, v10
    v_fmac_f32 v9, s62, v11
    v_lshlrev_b32 v10, 16, v55
    v_and_b32 v11, 0xffff0000, v55
    v_fmac_f32 v8, s63, v10
    v_fmac_f32 v9, s63, v11
    v_lshlrev_b32 v10, 16, v56
    v_and_b32 v11, 0xffff0000, v56
    v_fmac_f32 v8, s64, v10
    v_fmac_f32 v9, s64, v11
    v_lshlrev_b32 v10, 16, v57
    v_and_b32 v11, 0xffff0000, v57
    v_fmac_f32 v8, s65, v10
    v_fmac_f32 v9, s65, v11
    v_lshlrev_b32 v10, 16, v58
    v_and_b32 v11, 0xffff0000, v58
    v_fmac_f32 v8, s66, v10
    v_fmac_f32 v9, s66, v11
    v_lshlrev_b32 v10, 16, v59
    v_and_b32 v11, 0xffff0000, v59
    v_fmac_f32 v8, s67, v10
    v_fmac_f32 v9, s67, v11
    v_lshlrev_b32 v10, 16, v60
    v_and_b32 v11, 0xffff0000, v60
    v_fmac_f32 v8, s68, v10
    v_fmac_f32 v9, s68, v11
    v_lshlrev_b32 v10, 16, v61
    v_and_b32 v11, 0xffff0000, v61
    v_fmac_f32 v8, s69, v10
    v_fmac_f32 v9, s69, v11
    v_lshlrev_b32 v10, 16, v62
    v_and_b32 v11, 0xffff0000, v62
    v_fmac_f32 v8, s70, v10
    v_fmac_f32 v9, s70, v11
    v_lshlrev_b32 v10, 16, v63
    v_and_b32 v11, 0xffff0000, v63
    v_fmac_f32 v8, s71, v10
    v_fmac_f32 v9, s71, v11
    v_lshlrev_b32 v10, 16, v64
    v_and_b32 v11, 0xffff0000, v64
    v_fmac_f32 v8, s72, v10
    v_fmac_f32 v9, s72, v11
    v_lshlrev_b32 v10, 16, v65
    v_and_b32 v11, 0xffff0000, v65
    v_fmac_f32 v8, s73, v10
    v_fmac_f32 v9, s73, v11
    v_lshlrev_b32 v10, 16, v66
    v_and_b32 v11, 0xffff0000, v66
    v_fmac_f32 v8, s74, v10
    v_fmac_f32 v9, s74, v11
    v_lshlrev_b32 v10, 16, v67
    v_and_b32 v11, 0xffff0000, v67
    v_fmac_f32 v8, s75, v10
    v_fmac_f32 v9, s75, v11
    v_lshlrev_b32 v10, 16, v68
    v_and_b32 v11, 0xffff0000, v68
    v_fmac_f32 v8, s76, v10
    v_fmac_f32 v9, s76, v11
    v_lshlrev_b32 v10, 16, v69
    v_and_b32 v11, 0xffff0000, v69
    v_fmac_f32 v8, s77, v10
    v_fmac_f32 v9, s77, v11
    v_lshlrev_b32 v10, 16, v70
    v_and_b32 v11, 0xffff0000, v70
    v_fmac_f32 v8, s78, v10
    v_fmac_f32 v9, s78, v11
    v_lshlrev_b32 v10, 16, v71
    v_and_b32 v11, 0xffff0000, v71
    v_fmac_f32 v8, s79, v10
    v_fmac_f32 v9, s79, v11
    global_load_dword v16, v6, s[6:7]
    v_add_u32 v6, 5376, v6
    global_load_dword v17, v6, s[6:7]
    v_add_u32 v6, 5376, v6
    global_load_dword v18, v6, s[6:7]
    v_add_u32 v6, 5376, v6
    global_load_dword v19, v6, s[6:7]
    v_add_u32 v6, 5376, v6
    global_load_dword v20, v6, s[6:7]
    v_add_u32 v6, 5376, v6
    global_load_dword v21, v6, s[6:7]
    v_add_u32 v6, 5376, v6
    global_load_dword v22, v6, s[6:7]
    v_add_u32 v6, 5376, v6
    global_load_dword v23, v6, s[6:7]
    v_add_u32 v6, 5376, v6
    global_load_dword v24, v6, s[6:7]
    v_add_u32 v6, 5376, v6
    global_load_dword v25, v6, s[6:7]
    v_add_u32 v6, 5376, v6
    global_load_dword v26, v6, s[6:7]
    v_add_u32 v6, 5376, v6
    global_load_dword v27, v6, s[6:7]
    v_add_u32 v6, 5376, v6
    global_load_dword v28, v6, s[6:7]
    v_add_u32 v6, 5376, v6
    global_load_dword v29, v6, s[6:7]
    v_add_u32 v6, 5376, v6
    global_load_dword v30, v6, s[6:7]
    v_add_u32 v6, 5376, v6
    global_load_dword v31, v6, s[6:7]
    v_add_u32 v6, 5376, v6
    global_load_dword v32, v6, s[6:7]
    v_add_u32 v6, 5376, v6
    global_load_dword v33, v6, s[6:7]
    v_add_u32 v6, 5376, v6
    global_load_dword v34, v6, s[6:7]
    v_add_u32 v6, 5376, v6
    global_load_dword v35, v6, s[6:7]
    v_add_u32 v6, 5376, v6
    global_load_dword v36, v6, s[6:7]
    v_add_u32 v6, 5376, v6
    global_load_dword v37, v6, s[6:7]
    v_add_u32 v6, 5376, v6
    global_load_dword v38, v6, s[6:7]
    v_add_u32 v6, 5376, v6
    global_load_dword v39, v6, s[6:7]
    v_add_u32 v6, 5376, v6
    global_load_dword v40, v6, s[6:7]
    v_add_u32 v6, 5376, v6
    global_load_dword v41, v6, s[6:7]
    v_add_u32 v6, 5376, v6
    global_load_dword v42, v6, s[6:7]
    v_add_u32 v6, 5376, v6
    global_load_dword v43, v6, s[6:7]
    v_add_u32 v6, 5376, v6
    global_load_dword v44, v6, s[6:7]
    v_add_u32 v6, 5376, v6
    global_load_dword v45, v6, s[6:7]
    v_add_u32 v6, 5376, v6
    global_load_dword v46, v6, s[6:7]
    v_add_u32 v6, 5376, v6
    global_load_dword v47, v6, s[6:7]
    v_add_u32 v6, 5376, v6
    global_load_dword v48, v6, s[6:7]
    v_add_u32 v6, 5376, v6
    global_load_dword v49, v6, s[6:7]
    v_add_u32 v6, 5376, v6
    global_load_dword v50, v6, s[6:7]
    v_add_u32 v6, 5376, v6
    global_load_dword v51, v6, s[6:7]
    v_add_u32 v6, 5376, v6
    global_load_dword v52, v6, s[6:7]
    v_add_u32 v6, 5376, v6
    global_load_dword v53, v6, s[6:7]
    v_add_u32 v6, 5376, v6
    global_load_dword v54, v6, s[6:7]
    v_add_u32 v6, 5376, v6
    global_load_dword v55, v6, s[6:7]
    v_add_u32 v6, 5376, v6
    global_load_dword v56, v6, s[6:7]
    v_add_u32 v6, 5376, v6
    global_load_dword v57, v6, s[6:7]
    v_add_u32 v6, 5376, v6
    global_load_dword v58, v6, s[6:7]
    v_add_u32 v6, 5376, v6
    global_load_dword v59, v6, s[6:7]
    v_add_u32 v6, 5376, v6
    global_load_dword v60, v6, s[6:7]
    v_add_u32 v6, 5376, v6
    global_load_dword v61, v6, s[6:7]
    v_add_u32 v6, 5376, v6
    global_load_dword v62, v6, s[6:7]
    v_add_u32 v6, 5376, v6
    global_load_dword v63, v6, s[6:7]
    v_add_u32 v6, 5376, v6
    global_load_dword v64, v6, s[6:7]
    v_add_u32 v6, 5376, v6
    global_load_dword v65, v6, s[6:7]
    v_add_u32 v6, 5376, v6
    global_load_dword v66, v6, s[6:7]
    v_add_u32 v6, 5376, v6
    global_load_dword v67, v6, s[6:7]
    v_add_u32 v6, 5376, v6
    global_load_dword v68, v6, s[6:7]
    v_add_u32 v6, 5376, v6
    global_load_dword v69, v6, s[6:7]
    v_add_u32 v6, 5376, v6
    global_load_dword v70, v6, s[6:7]
    v_add_u32 v6, 5376, v6
    global_load_dword v71, v6, s[6:7]
    v_add_u32 v6, 5376, v6
    v_readlane_b32 s24, v4, 56
    v_readlane_b32 s25, v4, 57
    v_readlane_b32 s26, v4, 58
    v_readlane_b32 s27, v4, 59
    v_readlane_b32 s28, v4, 60
    v_readlane_b32 s29, v4, 61
    v_readlane_b32 s30, v4, 62
    v_readlane_b32 s31, v4, 63
    v_readlane_b32 s32, v5, 0
    v_readlane_b32 s33, v5, 1
    v_readlane_b32 s34, v5, 2
    v_readlane_b32 s35, v5, 3
    v_readlane_b32 s36, v5, 4
    v_readlane_b32 s37, v5, 5
    v_readlane_b32 s38, v5, 6
    v_readlane_b32 s39, v5, 7
    v_readlane_b32 s40, v5, 8
    v_readlane_b32 s41, v5, 9
    v_readlane_b32 s42, v5, 10
    v_readlane_b32 s43, v5, 11
    v_readlane_b32 s44, v5, 12
    v_readlane_b32 s45, v5, 13
    v_readlane_b32 s46, v5, 14
    v_readlane_b32 s47, v5, 15
    v_readlane_b32 s48, v5, 16
    v_readlane_b32 s49, v5, 17
    v_readlane_b32 s50, v5, 18
    v_readlane_b32 s51, v5, 19
    v_readlane_b32 s52, v5, 20
    v_readlane_b32 s53, v5, 21
    v_readlane_b32 s54, v5, 22
    v_readlane_b32 s55, v5, 23
    v_readlane_b32 s56, v5, 24
    v_readlane_b32 s57, v5, 25
    v_readlane_b32 s58, v5, 26
    v_readlane_b32 s59, v5, 27
    v_readlane_b32 s60, v5, 28
    v_readlane_b32 s61, v5, 29
    v_readlane_b32 s62, v5, 30
    v_readlane_b32 s63, v5, 31
    v_readlane_b32 s64, v5, 32
    v_readlane_b32 s65, v5, 33
    v_readlane_b32 s66, v5, 34
    v_readlane_b32 s67, v5, 35
    v_readlane_b32 s68, v5, 36
    v_readlane_b32 s69, v5, 37
    v_readlane_b32 s70, v5, 38
    v_readlane_b32 s71, v5, 39
    v_readlane_b32 s72, v5, 40
    v_readlane_b32 s73, v5, 41
    v_readlane_b32 s74, v5, 42
    v_readlane_b32 s75, v5, 43
    v_readlane_b32 s76, v5, 44
    v_readlane_b32 s77, v5, 45
    v_readlane_b32 s78, v5, 46
    v_readlane_b32 s79, v5, 47
    s_waitcnt vmcnt(0)
    v_lshlrev_b32 v10, 16, v16
    v_and_b32 v11, 0xffff0000, v16
    v_fmac_f32 v8, s24, v10
    v_fmac_f32 v9, s24, v11
    v_lshlrev_b32 v10, 16, v17
    v_and_b32 v11, 0xffff0000, v17
    v_fmac_f32 v8, s25, v10
    v_fmac_f32 v9, s25, v11
    v_lshlrev_b32 v10, 16, v18
    v_and_b32 v11, 0xffff0000, v18
    v_fmac_f32 v8, s26, v10
    v_fmac_f32 v9, s26, v11
    v_lshlrev_b32 v10, 16, v19
    v_and_b32 v11, 0xffff0000, v19
    v_fmac_f32 v8, s27, v10
    v_fmac_f32 v9, s27, v11
    v_lshlrev_b32 v10, 16, v20
    v_and_b32 v11, 0xffff0000, v20
    v_fmac_f32 v8, s28, v10
    v_fmac_f32 v9, s28, v11
    v_lshlrev_b32 v10, 16, v21
    v_and_b32 v11, 0xffff0000, v21
    v_fmac_f32 v8, s29, v10
    v_fmac_f32 v9, s29, v11
    v_lshlrev_b32 v10, 16, v22
    v_and_b32 v11, 0xffff0000, v22
    v_fmac_f32 v8, s30, v10
    v_fmac_f32 v9, s30, v11
    v_lshlrev_b32 v10, 16, v23
    v_and_b32 v11, 0xffff0000, v23
    v_fmac_f32 v8, s31, v10
    v_fmac_f32 v9, s31, v11
    v_lshlrev_b32 v10, 16, v24
    v_and_b32 v11, 0xffff0000, v24
    v_fmac_f32 v8, s32, v10
    v_fmac_f32 v9, s32, v11
    v_lshlrev_b32 v10, 16, v25
    v_and_b32 v11, 0xffff0000, v25
    v_fmac_f32 v8, s33, v10
    v_fmac_f32 v9, s33, v11
    v_lshlrev_b32 v10, 16, v26
    v_and_b32 v11, 0xffff0000, v26
    v_fmac_f32 v8, s34, v10
    v_fmac_f32 v9, s34, v11
    v_lshlrev_b32 v10, 16, v27
    v_and_b32 v11, 0xffff0000, v27
    v_fmac_f32 v8, s35, v10
    v_fmac_f32 v9, s35, v11
    v_lshlrev_b32 v10, 16, v28
    v_and_b32 v11, 0xffff0000, v28
    v_fmac_f32 v8, s36, v10
    v_fmac_f32 v9, s36, v11
    v_lshlrev_b32 v10, 16, v29
    v_and_b32 v11, 0xffff0000, v29
    v_fmac_f32 v8, s37, v10
    v_fmac_f32 v9, s37, v11
    v_lshlrev_b32 v10, 16, v30
    v_and_b32 v11, 0xffff0000, v30
    v_fmac_f32 v8, s38, v10
    v_fmac_f32 v9, s38, v11
    v_lshlrev_b32 v10, 16, v31
    v_and_b32 v11, 0xffff0000, v31
    v_fmac_f32 v8, s39, v10
    v_fmac_f32 v9, s39, v11
    v_lshlrev_b32 v10, 16, v32
    v_and_b32 v11, 0xffff0000, v32
    v_fmac_f32 v8, s40, v10
    v_fmac_f32 v9, s40, v11
    v_lshlrev_b32 v10, 16, v33
    v_and_b32 v11, 0xffff0000, v33
    v_fmac_f32 v8, s41, v10
    v_fmac_f32 v9, s41, v11
    v_lshlrev_b32 v10, 16, v34
    v_and_b32 v11, 0xffff0000, v34
    v_fmac_f32 v8, s42, v10
    v_fmac_f32 v9, s42, v11
    v_lshlrev_b32 v10, 16, v35
    v_and_b32 v11, 0xffff0000, v35
    v_fmac_f32 v8, s43, v10
    v_fmac_f32 v9, s43, v11
    v_lshlrev_b32 v10, 16, v36
    v_and_b32 v11, 0xffff0000, v36
    v_fmac_f32 v8, s44, v10
    v_fmac_f32 v9, s44, v11
    v_lshlrev_b32 v10, 16, v37
    v_and_b32 v11, 0xffff0000, v37
    v_fmac_f32 v8, s45, v10
    v_fmac_f32 v9, s45, v11
    v_lshlrev_b32 v10, 16, v38
    v_and_b32 v11, 0xffff0000, v38
    v_fmac_f32 v8, s46, v10
    v_fmac_f32 v9, s46, v11
    v_lshlrev_b32 v10, 16, v39
    v_and_b32 v11, 0xffff0000, v39
    v_fmac_f32 v8, s47, v10
    v_fmac_f32 v9, s47, v11
    v_lshlrev_b32 v10, 16, v40
    v_and_b32 v11, 0xffff0000, v40
    v_fmac_f32 v8, s48, v10
    v_fmac_f32 v9, s48, v11
    v_lshlrev_b32 v10, 16, v41
    v_and_b32 v11, 0xffff0000, v41
    v_fmac_f32 v8, s49, v10
    v_fmac_f32 v9, s49, v11
    v_lshlrev_b32 v10, 16, v42
    v_and_b32 v11, 0xffff0000, v42
    v_fmac_f32 v8, s50, v10
    v_fmac_f32 v9, s50, v11
    v_lshlrev_b32 v10, 16, v43
    v_and_b32 v11, 0xffff0000, v43
    v_fmac_f32 v8, s51, v10
    v_fmac_f32 v9, s51, v11
    v_lshlrev_b32 v10, 16, v44
    v_and_b32 v11, 0xffff0000, v44
    v_fmac_f32 v8, s52, v10
    v_fmac_f32 v9, s52, v11
    v_lshlrev_b32 v10, 16, v45
    v_and_b32 v11, 0xffff0000, v45
    v_fmac_f32 v8, s53, v10
    v_fmac_f32 v9, s53, v11
    v_lshlrev_b32 v10, 16, v46
    v_and_b32 v11, 0xffff0000, v46
    v_fmac_f32 v8, s54, v10
    v_fmac_f32 v9, s54, v11
    v_lshlrev_b32 v10, 16, v47
    v_and_b32 v11, 0xffff0000, v47
    v_fmac_f32 v8, s55, v10
    v_fmac_f32 v9, s55, v11
    v_lshlrev_b32 v10, 16, v48
    v_and_b32 v11, 0xffff0000, v48
    v_fmac_f32 v8, s56, v10
    v_fmac_f32 v9, s56, v11
    v_lshlrev_b32 v10, 16, v49
    v_and_b32 v11, 0xffff0000, v49
    v_fmac_f32 v8, s57, v10
    v_fmac_f32 v9, s57, v11
    v_lshlrev_b32 v10, 16, v50
    v_and_b32 v11, 0xffff0000, v50
    v_fmac_f32 v8, s58, v10
    v_fmac_f32 v9, s58, v11
    v_lshlrev_b32 v10, 16, v51
    v_and_b32 v11, 0xffff0000, v51
    v_fmac_f32 v8, s59, v10
    v_fmac_f32 v9, s59, v11
    v_lshlrev_b32 v10, 16, v52
    v_and_b32 v11, 0xffff0000, v52
    v_fmac_f32 v8, s60, v10
    v_fmac_f32 v9, s60, v11
    v_lshlrev_b32 v10, 16, v53
    v_and_b32 v11, 0xffff0000, v53
    v_fmac_f32 v8, s61, v10
    v_fmac_f32 v9, s61, v11
    v_lshlrev_b32 v10, 16, v54
    v_and_b32 v11, 0xffff0000, v54
    v_fmac_f32 v8, s62, v10
    v_fmac_f32 v9, s62, v11
    v_lshlrev_b32 v10, 16, v55
    v_and_b32 v11, 0xffff0000, v55
    v_fmac_f32 v8, s63, v10
    v_fmac_f32 v9, s63, v11
    v_lshlrev_b32 v10, 16, v56
    v_and_b32 v11, 0xffff0000, v56
    v_fmac_f32 v8, s64, v10
    v_fmac_f32 v9, s64, v11
    v_lshlrev_b32 v10, 16, v57
    v_and_b32 v11, 0xffff0000, v57
    v_fmac_f32 v8, s65, v10
    v_fmac_f32 v9, s65, v11
    v_lshlrev_b32 v10, 16, v58
    v_and_b32 v11, 0xffff0000, v58
    v_fmac_f32 v8, s66, v10
    v_fmac_f32 v9, s66, v11
    v_lshlrev_b32 v10, 16, v59
    v_and_b32 v11, 0xffff0000, v59
    v_fmac_f32 v8, s67, v10
    v_fmac_f32 v9, s67, v11
    v_lshlrev_b32 v10, 16, v60
    v_and_b32 v11, 0xffff0000, v60
    v_fmac_f32 v8, s68, v10
    v_fmac_f32 v9, s68, v11
    v_lshlrev_b32 v10, 16, v61
    v_and_b32 v11, 0xffff0000, v61
    v_fmac_f32 v8, s69, v10
    v_fmac_f32 v9, s69, v11
    v_lshlrev_b32 v10, 16, v62
    v_and_b32 v11, 0xffff0000, v62
    v_fmac_f32 v8, s70, v10
    v_fmac_f32 v9, s70, v11
    v_lshlrev_b32 v10, 16, v63
    v_and_b32 v11, 0xffff0000, v63
    v_fmac_f32 v8, s71, v10
    v_fmac_f32 v9, s71, v11
    v_lshlrev_b32 v10, 16, v64
    v_and_b32 v11, 0xffff0000, v64
    v_fmac_f32 v8, s72, v10
    v_fmac_f32 v9, s72, v11
    v_lshlrev_b32 v10, 16, v65
    v_and_b32 v11, 0xffff0000, v65
    v_fmac_f32 v8, s73, v10
    v_fmac_f32 v9, s73, v11
    v_lshlrev_b32 v10, 16, v66
    v_and_b32 v11, 0xffff0000, v66
    v_fmac_f32 v8, s74, v10
    v_fmac_f32 v9, s74, v11
    v_lshlrev_b32 v10, 16, v67
    v_and_b32 v11, 0xffff0000, v67
    v_fmac_f32 v8, s75, v10
    v_fmac_f32 v9, s75, v11
    v_lshlrev_b32 v10, 16, v68
    v_and_b32 v11, 0xffff0000, v68
    v_fmac_f32 v8, s76, v10
    v_fmac_f32 v9, s76, v11
    v_lshlrev_b32 v10, 16, v69
    v_and_b32 v11, 0xffff0000, v69
    v_fmac_f32 v8, s77, v10
    v_fmac_f32 v9, s77, v11
    v_lshlrev_b32 v10, 16, v70
    v_and_b32 v11, 0xffff0000, v70
    v_fmac_f32 v8, s78, v10
    v_fmac_f32 v9, s78, v11
    v_lshlrev_b32 v10, 16, v71
    v_and_b32 v11, 0xffff0000, v71
    v_fmac_f32 v8, s79, v10
    v_fmac_f32 v9, s79, v11
    v_lshlrev_b32 v10, 3, v0
    ds_write_b64 v10, v[8:9]
    s_waitcnt lgkmcnt(0)
    s_barrier
    s_cmp_lg_u32 s10, 0
    s_cbranch_scc1 end_prep0_1
    ds_read_b64 v[12:13], v10 offset:512
    ds_read_b64 v[14:15], v10 offset:1024
    ds_read_b64 v[16:17], v10 offset:1536
    s_waitcnt lgkmcnt(0)
    v_add_f32 v8, v8, v12
    v_add_f32 v9, v9, v13
    v_add_f32 v8, v8, v14
    v_add_f32 v9, v9, v15
    v_add_f32 v8, v8, v16
    v_add_f32 v9, v9, v17
    v_cvt_pk_bf16_f32 v7, v8, v9
    v_lshlrev_b32 v8, 16, v7
    v_and_b32 v9, 0xffff0000, v7
    v_add_f32 v12, 1.0, v8
    v_add_f32 v13, 1.0, v9
    v_cvt_pk_bf16_f32 v7, v12, v13
    v_lshlrev_b32 v12, 16, v7
    v_and_b32 v13, 0xffff0000, v7
    s_lshl_b32 s21, s2, 7
    v_lshlrev_b32 v14, 1, v1
    v_add_u32 v14, s21, v14
    v_subrev_u32 v15, 448, v14
    v_cmp_gt_u32 vcc, 448, v15
    s_nop 1
    s_mov_b64 s[22:23], vcc
    v_subrev_u32 v15, 1792, v14
    v_cmp_gt_u32 vcc, 448, v15
    s_nop 1
    s_or_b64 vcc, vcc, s[22:23]
    s_nop 1
    v_cndmask_b32 v8, v8, v12, vcc
    v_cndmask_b32 v9, v9, v13, vcc
    v_lshlrev_b32 v14, 2, v14
    global_store_dwordx2 v14, v[8:9], s[8:9] offset:0 sc1
    s_waitcnt vmcnt(0)
    v_mov_b32 v14, 128
    v_mov_b32 v15, 1
    s_mov_b64 exec, 1
    global_atomic_add v14, v15, s[80:81] sc1
    s_branch end_prep0_1
tr_prep0_2:
    s_cmp_ge_u32 s2, 413
    s_cbranch_scc1 fill_prep0_3
    s_sub_u32 s20, s2, 21
    s_add_u32 s20, s20, 448
    s_cmp_ge_u32 s20, 448
    s_cbranch_scc1 t1_prep0_4
    s_mul_i32 s21, s20, 293
    s_lshr_b32 s21, s21, 13
    s_mul_i32 s22, s21, 28
    s_sub_u32 s20, s20, s22
    s_mul_i32 s23, s20, 37
    s_lshr_b32 s23, s23, 8
    s_mul_i32 s22, s23, 7
    s_sub_u32 s24, s20, s22
    s_mul_i32 s22, s21, 229376
    s_add_u32 s30, s12, s22
    s_addc_u32 s31, s13, 0
    s_add_u32 s22, s22, 0x1c3000
    s_add_u32 s32, s8, s22
    s_addc_u32 s33, s9, 0
    s_mov_b32 s25, 896
    s_mov_b32 s26, 512
    s_branch tc_prep0_6
t1_prep0_4:
    s_cmp_ge_u32 s20, 644
    s_cbranch_scc1 t2_prep0_5
    s_sub_u32 s20, s20, 448
    s_mul_i32 s23, s20, 147
    s_lshr_b32 s23, s23, 12
    s_mul_i32 s22, s23, 28
    s_sub_u32 s24, s20, s22
    s_mov_b32 s30, s14
    s_mov_b32 s31, s15
    s_add_u32 s32, s8, 0x543000
    s_addc_u32 s33, s9, 0
    s_mov_b32 s25, 3584
    s_mov_b32 s26, 896
    s_branch tc_prep0_6
t2_prep0_5:
    s_sub_u32 s20, s20, 644
    s_mul_i32 s23, s20, 147
    s_lshr_b32 s23, s23, 10
    s_mul_i32 s22, s23, 7
    s_sub_u32 s24, s20, s22
    s_mov_b32 s30, s16
    s_mov_b32 s31, s17
    s_add_u32 s32, s8, 0x6cb000
    s_addc_u32 s33, s9, 0
    s_mov_b32 s25, 896
    s_mov_b32 s26, 3584
tc_prep0_6:
    v_lshrrev_b32 v2, 3, v0
    v_and_b32 v3, 7, v0
    s_lshl_b32 s27, s23, 6
    s_lshl_b32 s28, s24, 6
    v_add_u32 v4, s27, v2
    v_mul_lo_u32 v4, v4, s25
    v_lshlrev_b32 v5, 4, v3
    s_lshl_b32 s29, s28, 1
    v_add3_u32 v4, v4, v5, s29
    s_lshl_b32 s34, s25, 5
    v_add_u32 v6, s34, v4
    global_load_dwordx4 v[16:19], v4, s[30:31]
    global_load_dwordx4 v[20:23], v6, s[30:31]
    v_mul_u32_u24 v7, 144, v2
    v_add_u32 v7, v7, v5
    s_waitcnt vmcnt(0)
    ds_write_b128 v7, v[16:19]
    ds_write_b128 v7, v[20:23] offset:4608
    s_waitcnt lgkmcnt(0)
    s_barrier
    v_mul_u32_u24 v7, 1152, v3
    v_lshl_add_u32 v7, v2, 1, v7
    ds_read_u16 v32, v7 offset:0
    ds_read_u16 v33, v7 offset:144
    ds_read_u16 v34, v7 offset:288
    ds_read_u16 v35, v7 offset:432
    ds_read_u16 v36, v7 offset:576
    ds_read_u16 v37, v7 offset:720
    ds_read_u16 v38, v7 offset:864
    ds_read_u16 v39, v7 offset:1008
    ds_read_u16 v40, v7 offset:64
    ds_read_u16 v41, v7 offset:208
    ds_read_u16 v42, v7 offset:352
    ds_read_u16 v43, v7 offset:496
    ds_read_u16 v44, v7 offset:640
    ds_read_u16 v45, v7 offset:784
    ds_read_u16 v46, v7 offset:928
    ds_read_u16 v47, v7 offset:1072
    v_add_u32 v4, s28, v2
    v_mul_lo_u32 v4, v4, s26
    s_lshl_b32 s29, s27, 1
    v_add3_u32 v4, v4, v5, s29
    s_lshl_b32 s34, s26, 5
    v_add_u32 v6, s34, v4
    s_waitcnt lgkmcnt(0)
    v_lshl_or_b32 v24, v33, 16, v32
    v_lshl_or_b32 v25, v35, 16, v34
    v_lshl_or_b32 v26, v37, 16, v36
    v_lshl_or_b32 v27, v39, 16, v38
    v_lshl_or_b32 v28, v41, 16, v40
    v_lshl_or_b32 v29, v43, 16, v42
    v_lshl_or_b32 v30, v45, 16, v44
    v_lshl_or_b32 v31, v47, 16, v46
    global_store_dwordx4 v4, v[24:27], s[32:33]
    global_store_dwordx4 v6, v[28:31], s[32:33]
    s_branch end_prep0_1
fill_prep0_3:
    s_sub_u32 s20, s2, 413
    v_lshlrev_b32 v2, 4, v0
    s_lshl_b32 s21, s20, 13
    s_add_u32 s22, s21, 0x4c93000
    s_add_u32 s30, s8, s22
    s_addc_u32 s31, s9, 0
    s_lshl_b32 s21, s20, 14
    s_add_u32 s21, s21, 0x5093000
    s_add_u32 s32, s8, s21
    s_addc_u32 s33, s9, 0
    v_mov_b32 v4, -1
    v_mov_b32 v5, -1
    v_mov_b32 v6, -1
    v_mov_b32 v7, -1
    v_add_u32 v3, 4096, v2
    s_cmp_eq_u32 s20, 0
    s_cbranch_scc1 f1_prep0_7
    global_store_dwordx4 v2, v[4:7], s[30:31]
    global_store_dwordx4 v3, v[4:7], s[30:31]
    s_branch f2_prep0_8
f1_prep0_7:
    s_add_u32 s24, s8, 0x6bd3000
    s_addc_u32 s25, s9, 0
    v_mov_b32 v12, 0
    v_mov_b32 v13, 0
    v_mov_b32 v14, 0
    v_mov_b32 v15, 0
    global_store_dwordx4 v2, v[12:15], s[24:25]
    global_store_dwordx4 v3, v[12:15], s[24:25]
    s_add_u32 s26, s8, 0x6bd5000
    s_addc_u32 s27, s9, 0
    v_and_b32 v8, 7, v0
    v_mul_u32_u24 v8, 896, v8
    v_lshrrev_b32 v9, 3, v0
    v_lshl_add_u32 v10, v9, 4, v8
    global_load_dwordx4 v[12:15], v10, s[18:19]
    s_waitcnt vmcnt(0)
    global_store_dwordx4 v2, v[12:15], s[30:31]
    global_store_dwordx4 v2, v[12:15], s[26:27]
    v_cmp_gt_u32 vcc, 192, v0
    s_and_saveexec_b64 s[22:23], vcc
    global_load_dwordx4 v[12:15], v10, s[18:19] offset:512
    s_waitcnt vmcnt(0)
    global_store_dwordx4 v3, v[12:15], s[30:31]
    global_store_dwordx4 v3, v[12:15], s[26:27]
    s_mov_b64 exec, s[22:23]
f2_prep0_8:
    global_store_dwordx4 v2, v[4:7], s[32:33]
    v_add_u32 v2, 4096, v2
    global_store_dwordx4 v2, v[4:7], s[32:33]
    v_add_u32 v2, 4096, v2
    global_store_dwordx4 v2, v[4:7], s[32:33]
    v_add_u32 v2, 4096, v2
    global_store_dwordx4 v2, v[4:7], s[32:33]
end_prep0_1:
    s_endpgm
sub_prea_2:
    s_cmp_ge_u32 s2, 784
    s_cbranch_scc1 end_g1_1
    s_load_dwordx2 s[4:5], s[0:1], 128
    s_load_dwordx2 s[6:7], s[0:1], 24
    s_load_dwordx2 s[8:9], s[0:1], 16
    s_lshr_b32 s43, s2, 3
    s_and_b32 s44, s2, 7
    s_mul_i32 s20, s43, 21
    s_lshr_b32 s20, s20, 10
    s_mul_i32 s21, s20, 49
    s_sub_u32 s21, s43, s21
    s_mul_i32 s44, s44, 2
    s_add_u32 s20, s20, s44
    s_mul_i32 s22, s21, 37
    s_lshr_b32 s22, s22, 8
    s_mul_i32 s23, s22, 7
    s_sub_u32 s23, s21, s23
    v_and_b32 v1, 63, v0
    v_lshrrev_b32 v2, 6, v0
    s_nop 0
    v_readfirstlane_b32 s24, v2
    s_waitcnt lgkmcnt(0)
    s_mul_i32 s40, s20, 512
    s_add_u32 s6, s6, s40
    s_addc_u32 s7, s7, 0
    s_mul_i32 s40, s20, 512
    s_add_u32 s8, s8, s40
    s_addc_u32 s9, s9, 0
    s_add_u32 s10, s4, 0x853000
    s_addc_u32 s11, s5, 0
    s_mul_i32 s40, s20, 401408
    s_add_u32 s10, s10, s40
    s_addc_u32 s11, s11, 0
    s_lshr_b32 s25, s24, 1
    s_and_b32 s26, s24, 1
    v_lshrrev_b32 v2, 3, v0
    v_and_b32 v3, 7, v0
    v_lshlrev_b32 v3, 4, v3
    s_mul_i32 s27, s22, 64
    s_mul_i32 s28, s23, 64
    s_mov_b32 s29, 8192
    s_mov_b32 s30, 8192
    v_add_u32 v4, s27, v2
    v_mul_lo_u32 v4, v4, s29
    v_add_u32 v8, v4, v3
    v_add_u32 v9, 262144, v8
    v_add_u32 v4, s28, v2
    v_mul_lo_u32 v4, v4, s30
    v_add_u32 v10, v4, v3
    v_add_u32 v11, 262144, v10
    v_mul_u32_u24 v4, 144, v2
    v_add_u32 v12, v4, v3
    v_add_u32 v13, 9216, v12
    v_and_b32 v4, 31, v1
    v_lshrrev_b32 v5, 5, v1
    v_lshlrev_b32 v5, 4, v5
    s_mul_i32 s31, s25, 32
    v_add_u32 v6, s31, v4
    v_mul_u32_u24 v6, 144, v6
    v_add_u32 v14, v6, v5
    s_mul_i32 s31, s26, 32
    v_add_u32 v6, s31, v4
    v_mul_u32_u24 v6, 144, v6
    v_add_u32 v6, v6, v5
    v_add_u32 v15, 9216, v6
    v_accvgpr_write_b32 a0, 0
    v_accvgpr_write_b32 a1, 0
    v_accvgpr_write_b32 a2, 0
    v_accvgpr_write_b32 a3, 0
    v_accvgpr_write_b32 a4, 0
    v_accvgpr_write_b32 a5, 0
    v_accvgpr_write_b32 a6, 0
    v_accvgpr_write_b32 a7, 0
    v_accvgpr_write_b32 a8, 0
    v_accvgpr_write_b32 a9, 0
    v_accvgpr_write_b32 a10, 0
    v_accvgpr_write_b32 a11, 0
    v_accvgpr_write_b32 a12, 0
    v_accvgpr_write_b32 a13, 0
    v_accvgpr_write_b32 a14, 0
    v_accvgpr_write_b32 a15, 0
    v_add_u32 v18, 18432, v14
    v_add_u32 v19, 18432, v15
    v_add_u32 v16, 18432, v12
    v_add_u32 v17, 18432, v13
    global_load_dwordx4 v[24:27], v8, s[6:7]
    global_load_dwordx4 v[28:31], v9, s[6:7]
    global_load_dwordx4 v[32:35], v10, s[8:9]
    global_load_dwordx4 v[36:39], v11, s[8:9]
    s_add_u32 s6, s6, 128
    s_addc_u32 s7, s7, 0
    s_add_u32 s8, s8, 128
    s_addc_u32 s9, s9, 0
    global_load_dwordx4 v[40:43], v8, s[6:7]
    global_load_dwordx4 v[44:47], v9, s[6:7]
    global_load_dwordx4 v[48:51], v10, s[8:9]
    global_load_dwordx4 v[52:55], v11, s[8:9]
    s_add_u32 s6, s6, 128
    s_addc_u32 s7, s7, 0
    s_add_u32 s8, s8, 128
    s_addc_u32 s9, s9, 0
    global_load_dwordx4 v[56:59], v8, s[6:7]
    global_load_dwordx4 v[60:63], v9, s[6:7]
    global_load_dwordx4 v[64:67], v10, s[8:9]
    global_load_dwordx4 v[68:71], v11, s[8:9]
    s_add_u32 s6, s6, 128
    s_addc_u32 s7, s7, 0
    s_add_u32 s8, s8, 128
    s_addc_u32 s9, s9, 0
    global_load_dwordx4 v[72:75], v8, s[6:7]
    global_load_dwordx4 v[76:79], v9, s[6:7]
    global_load_dwordx4 v[80:83], v10, s[8:9]
    global_load_dwordx4 v[84:87], v11, s[8:9]
    s_add_u32 s6, s6, 128
    s_addc_u32 s7, s7, 0
    s_add_u32 s8, s8, 128
    s_addc_u32 s9, s9, 0
    s_waitcnt vmcnt(12)
    ds_write_b128 v12, v[24:27] offset:0
    ds_write_b128 v12, v[28:31] offset:4608
    ds_write_b128 v13, v[32:35] offset:0
    ds_write_b128 v13, v[36:39] offset:4608
    s_waitcnt lgkmcnt(0)
    s_barrier
    ds_read_b128 v[88:91], v14 offset:0
    ds_read_b128 v[92:95], v15 offset:0
    ds_read_b128 v[96:99], v14 offset:32
    ds_read_b128 v[100:103], v15 offset:32
    ds_read_b128 v[104:107], v14 offset:64
    ds_read_b128 v[108:111], v15 offset:64
    ds_read_b128 v[112:115], v14 offset:96
    ds_read_b128 v[116:119], v15 offset:96
    s_waitcnt lgkmcnt(6)
    v_mfma_f32_32x32x16_bf16 a[0:15], v[92:95], v[88:91], a[0:15]
    s_waitcnt lgkmcnt(4)
    v_mfma_f32_32x32x16_bf16 a[0:15], v[100:103], v[96:99], a[0:15]
    s_waitcnt lgkmcnt(2)
    v_mfma_f32_32x32x16_bf16 a[0:15], v[108:111], v[104:107], a[0:15]
    s_waitcnt lgkmcnt(0)
    v_mfma_f32_32x32x16_bf16 a[0:15], v[116:119], v[112:115], a[0:15]
    s_waitcnt vmcnt(8)
    ds_write_b128 v16, v[40:43] offset:0
    ds_write_b128 v16, v[44:47] offset:4608
    ds_write_b128 v17, v[48:51] offset:0
    ds_write_b128 v17, v[52:55] offset:4608
    s_waitcnt lgkmcnt(0)
    s_barrier
    ds_read_b128 v[88:91], v18 offset:0
    ds_read_b128 v[92:95], v19 offset:0
    ds_read_b128 v[96:99], v18 offset:32
    ds_read_b128 v[100:103], v19 offset:32
    ds_read_b128 v[104:107], v18 offset:64
    ds_read_b128 v[108:111], v19 offset:64
    ds_read_b128 v[112:115], v18 offset:96
    ds_read_b128 v[116:119], v19 offset:96
    s_waitcnt lgkmcnt(6)
    v_mfma_f32_32x32x16_bf16 a[0:15], v[92:95], v[88:91], a[0:15]
    s_waitcnt lgkmcnt(4)
    v_mfma_f32_32x32x16_bf16 a[0:15], v[100:103], v[96:99], a[0:15]
    s_waitcnt lgkmcnt(2)
    v_mfma_f32_32x32x16_bf16 a[0:15], v[108:111], v[104:107], a[0:15]
    s_waitcnt lgkmcnt(0)
    v_mfma_f32_32x32x16_bf16 a[0:15], v[116:119], v[112:115], a[0:15]
    s_waitcnt vmcnt(4)
    ds_write_b128 v12, v[56:59] offset:0
    ds_write_b128 v12, v[60:63] offset:4608
    ds_write_b128 v13, v[64:67] offset:0
    ds_write_b128 v13, v[68:71] offset:4608
    s_waitcnt lgkmcnt(0)
    s_barrier
    ds_read_b128 v[88:91], v14 offset:0
    ds_read_b128 v[92:95], v15 offset:0
    ds_read_b128 v[96:99], v14 offset:32
    ds_read_b128 v[100:103], v15 offset:32
    ds_read_b128 v[104:107], v14 offset:64
    ds_read_b128 v[108:111], v15 offset:64
    ds_read_b128 v[112:115], v14 offset:96
    ds_read_b128 v[116:119], v15 offset:96
    s_waitcnt lgkmcnt(6)
    v_mfma_f32_32x32x16_bf16 a[0:15], v[92:95], v[88:91], a[0:15]
    s_waitcnt lgkmcnt(4)
    v_mfma_f32_32x32x16_bf16 a[0:15], v[100:103], v[96:99], a[0:15]
    s_waitcnt lgkmcnt(2)
    v_mfma_f32_32x32x16_bf16 a[0:15], v[108:111], v[104:107], a[0:15]
    s_waitcnt lgkmcnt(0)
    v_mfma_f32_32x32x16_bf16 a[0:15], v[116:119], v[112:115], a[0:15]
    s_waitcnt vmcnt(0)
    ds_write_b128 v16, v[72:75] offset:0
    ds_write_b128 v16, v[76:79] offset:4608
    ds_write_b128 v17, v[80:83] offset:0
    ds_write_b128 v17, v[84:87] offset:4608
    s_waitcnt lgkmcnt(0)
    s_barrier
    ds_read_b128 v[88:91], v18 offset:0
    ds_read_b128 v[92:95], v19 offset:0
    ds_read_b128 v[96:99], v18 offset:32
    ds_read_b128 v[100:103], v19 offset:32
    ds_read_b128 v[104:107], v18 offset:64
    ds_read_b128 v[108:111], v19 offset:64
    ds_read_b128 v[112:115], v18 offset:96
    ds_read_b128 v[116:119], v19 offset:96
    s_waitcnt lgkmcnt(6)
    v_mfma_f32_32x32x16_bf16 a[0:15], v[92:95], v[88:91], a[0:15]
    s_waitcnt lgkmcnt(4)
    v_mfma_f32_32x32x16_bf16 a[0:15], v[100:103], v[96:99], a[0:15]
    s_waitcnt lgkmcnt(2)
    v_mfma_f32_32x32x16_bf16 a[0:15], v[108:111], v[104:107], a[0:15]
    s_waitcnt lgkmcnt(0)
    v_mfma_f32_32x32x16_bf16 a[0:15], v[116:119], v[112:115], a[0:15]
    s_nop 15
    v_and_b32 v4, 31, v1
    v_lshrrev_b32 v5, 5, v1
    s_mul_i32 s31, s25, 32
    s_add_u32 s31, s31, s27
    v_add_u32 v4, s31, v4
    s_mul_i32 s36, s26, 32
    s_add_u32 s36, s36, s28
    v_lshlrev_b32 v5, 2, v5
    v_add_u32 v5, s36, v5
    s_mov_b32 s37, 896
    v_mul_lo_u32 v6, v4, s37
    v_lshl_add_u32 v6, v5, 1, v6
    s_add_u32 s14, s4, 0x5f93000
    s_addc_u32 s15, s5, 0
    s_mul_i32 s38, s20, 28
    v_lshrrev_b32 v7, 4, v4
    v_add_u32 v7, s38, v7
    v_mul_u32_u24 v7, 14, v7
    s_lshr_b32 s38, s36, 5
    v_add_u32 v7, s38, v7
    v_lshlrev_b32 v7, 6, v7
    v_and_b32 v2, 15, v4
    v_add_u32 v7, v7, v2
    v_lshlrev_b32 v7, 4, v7
    v_lshrrev_b32 v2, 5, v1
    v_lshl_add_u32 v7, v2, 3, v7
    v_accvgpr_read_b32 v24, a0
    v_accvgpr_read_b32 v25, a1
    v_accvgpr_read_b32 v26, a2
    v_accvgpr_read_b32 v27, a3
    v_mul_f32 v24, 0x3d800000, v24
    v_mul_f32 v25, 0x3d800000, v25
    v_mul_f32 v26, 0x3d800000, v26
    v_mul_f32 v27, 0x3d800000, v27
    v_cvt_pk_bf16_f32 v28, v24, v25
    v_cvt_pk_bf16_f32 v29, v26, v27
    global_store_dwordx2 v6, v[28:29], s[10:11] offset:0
    global_store_dwordx2 v7, v[28:29], s[14:15] offset:0
    v_accvgpr_read_b32 v40, a4
    v_accvgpr_read_b32 v41, a5
    v_accvgpr_read_b32 v42, a6
    v_accvgpr_read_b32 v43, a7
    v_mul_f32 v40, 0x3d800000, v40
    v_mul_f32 v41, 0x3d800000, v41
    v_mul_f32 v42, 0x3d800000, v42
    v_mul_f32 v43, 0x3d800000, v43
    v_cvt_pk_bf16_f32 v44, v40, v41
    v_cvt_pk_bf16_f32 v45, v42, v43
    global_store_dwordx2 v6, v[44:45], s[10:11] offset:16
    global_store_dwordx2 v7, v[44:45], s[14:15] offset:256
    v_accvgpr_read_b32 v56, a8
    v_accvgpr_read_b32 v57, a9
    v_accvgpr_read_b32 v58, a10
    v_accvgpr_read_b32 v59, a11
    v_mul_f32 v56, 0x3d800000, v56
    v_mul_f32 v57, 0x3d800000, v57
    v_mul_f32 v58, 0x3d800000, v58
    v_mul_f32 v59, 0x3d800000, v59
    v_cvt_pk_bf16_f32 v60, v56, v57
    v_cvt_pk_bf16_f32 v61, v58, v59
    global_store_dwordx2 v6, v[60:61], s[10:11] offset:32
    global_store_dwordx2 v7, v[60:61], s[14:15] offset:512
    v_accvgpr_read_b32 v72, a12
    v_accvgpr_read_b32 v73, a13
    v_accvgpr_read_b32 v74, a14
    v_accvgpr_read_b32 v75, a15
    v_mul_f32 v72, 0x3d800000, v72
    v_mul_f32 v73, 0x3d800000, v73
    v_mul_f32 v74, 0x3d800000, v74
    v_mul_f32 v75, 0x3d800000, v75
    v_cvt_pk_bf16_f32 v76, v72, v73
    v_cvt_pk_bf16_f32 v77, v74, v75
    global_store_dwordx2 v6, v[76:77], s[10:11] offset:48
    global_store_dwordx2 v7, v[76:77], s[14:15] offset:768
end_g1_1:
    s_endpgm
sub_prea_3:
    s_cmp_ge_u32 s2, 784
    s_cbranch_scc1 end_g2_1
    s_load_dwordx2 s[4:5], s[0:1], 128
    s_load_dwordx2 s[6:7], s[0:1], 40
    s_load_dwordx2 s[8:9], s[0:1], 32
    s_lshr_b32 s43, s2, 3
    s_and_b32 s44, s2, 7
    s_mul_i32 s20, s43, 21
    s_lshr_b32 s20, s20, 10
    s_mul_i32 s21, s20, 49
    s_sub_u32 s21, s43, s21
    s_mul_i32 s44, s44, 2
    s_add_u32 s20, s20, s44
    s_mul_i32 s22, s21, 37
    s_lshr_b32 s22, s22, 8
    s_mul_i32 s23, s22, 7
    s_sub_u32 s23, s21, s23
    v_and_b32 v1, 63, v0
    v_lshrrev_b32 v2, 6, v0
    s_nop 0
    v_readfirstlane_b32 s24, v2
    s_waitcnt lgkmcnt(0)
    s_mul_i32 s40, s20, 229376
    s_add_u32 s6, s6, s40
    s_addc_u32 s7, s7, 0
    s_mul_i32 s40, s20, 512
    s_add_u32 s8, s8, s40
    s_addc_u32 s9, s9, 0
    s_add_u32 s10, s4, 0xe73000
    s_addc_u32 s11, s5, 0
    s_mul_i32 s40, s20, 401408
    s_add_u32 s10, s10, s40
    s_addc_u32 s11, s11, 0
    s_lshr_b32 s25, s24, 1
    s_and_b32 s26, s24, 1
    v_lshrrev_b32 v2, 3, v0
    v_and_b32 v3, 7, v0
    v_lshlrev_b32 v3, 4, v3
    s_mul_i32 s27, s22, 64
    s_mul_i32 s28, s23, 64
    s_mov_b32 s29, 896
    s_mov_b32 s30, 8192
    v_mul_lo_u32 v4, v2, s29
    s_lshl_b32 s31, s27, 1
    v_add3_u32 v8, v4, v3, s31
    v_add_u32 v9, 28672, v8
    v_add_u32 v4, s28, v2
    v_mul_lo_u32 v4, v4, s30
    v_add_u32 v10, v4, v3
    v_add_u32 v11, 262144, v10
    v_mul_u32_u24 v4, 144, v2
    v_add_u32 v12, v4, v3
    v_add_u32 v13, 9216, v12
    v_and_b32 v4, 31, v1
    v_lshrrev_b32 v5, 5, v1
    v_lshlrev_b32 v5, 4, v5
    s_mul_i32 s31, s25, 32
    v_add_u32 v6, s31, v4
    v_lshlrev_b32 v6, 1, v6
    v_lshrrev_b32 v7, 5, v1
    v_mul_u32_u24 v7, 1152, v7
    v_add_u32 v14, v6, v7
    s_mul_i32 s31, s26, 32
    v_add_u32 v6, s31, v4
    v_mul_u32_u24 v6, 144, v6
    v_add_u32 v6, v6, v5
    v_add_u32 v15, 9216, v6
    v_accvgpr_write_b32 a0, 0
    v_accvgpr_write_b32 a1, 0
    v_accvgpr_write_b32 a2, 0
    v_accvgpr_write_b32 a3, 0
    v_accvgpr_write_b32 a4, 0
    v_accvgpr_write_b32 a5, 0
    v_accvgpr_write_b32 a6, 0
    v_accvgpr_write_b32 a7, 0
    v_accvgpr_write_b32 a8, 0
    v_accvgpr_write_b32 a9, 0
    v_accvgpr_write_b32 a10, 0
    v_accvgpr_write_b32 a11, 0
    v_accvgpr_write_b32 a12, 0
    v_accvgpr_write_b32 a13, 0
    v_accvgpr_write_b32 a14, 0
    v_accvgpr_write_b32 a15, 0
    v_add_u32 v18, 18432, v14
    v_add_u32 v19, 18432, v15
    v_add_u32 v16, 18432, v12
    v_add_u32 v17, 18432, v13
    global_load_dwordx4 v[24:27], v8, s[6:7]
    global_load_dwordx4 v[28:31], v9, s[6:7]
    global_load_dwordx4 v[32:35], v10, s[8:9]
    global_load_dwordx4 v[36:39], v11, s[8:9]
    s_add_u32 s6, s6, 57344
    s_addc_u32 s7, s7, 0
    s_add_u32 s8, s8, 128
    s_addc_u32 s9, s9, 0
    global_load_dwordx4 v[40:43], v8, s[6:7]
    global_load_dwordx4 v[44:47], v9, s[6:7]
    global_load_dwordx4 v[48:51], v10, s[8:9]
    global_load_dwordx4 v[52:55], v11, s[8:9]
    s_add_u32 s6, s6, 57344
    s_addc_u32 s7, s7, 0
    s_add_u32 s8, s8, 128
    s_addc_u32 s9, s9, 0
    global_load_dwordx4 v[56:59], v8, s[6:7]
    global_load_dwordx4 v[60:63], v9, s[6:7]
    global_load_dwordx4 v[64:67], v10, s[8:9]
    global_load_dwordx4 v[68:71], v11, s[8:9]
    s_add_u32 s6, s6, 57344
    s_addc_u32 s7, s7, 0
    s_add_u32 s8, s8, 128
    s_addc_u32 s9, s9, 0
    global_load_dwordx4 v[72:75], v8, s[6:7]
    global_load_dwordx4 v[76:79], v9, s[6:7]
    global_load_dwordx4 v[80:83], v10, s[8:9]
    global_load_dwordx4 v[84:87], v11, s[8:9]
    s_add_u32 s6, s6, 57344
    s_addc_u32 s7, s7, 0
    s_add_u32 s8, s8, 128
    s_addc_u32 s9, s9, 0
    s_waitcnt vmcnt(12)
    ds_write_b128 v12, v[24:27] offset:0
    ds_write_b128 v12, v[28:31] offset:4608
    ds_write_b128 v13, v[32:35] offset:0
    ds_write_b128 v13, v[36:39] offset:4608
    s_waitcnt lgkmcnt(0)
    s_barrier
    ds_read_u16 v104, v14 offset:0
    ds_read_u16 v105, v14 offset:144
    ds_read_u16 v106, v14 offset:288
    ds_read_u16 v107, v14 offset:432
    ds_read_u16 v108, v14 offset:576
    ds_read_u16 v109, v14 offset:720
    ds_read_u16 v110, v14 offset:864
    ds_read_u16 v111, v14 offset:1008
    ds_read_b128 v[92:95], v15 offset:0
    s_waitcnt lgkmcnt(0)
    v_lshl_or_b32 v88, v105, 16, v104
    v_lshl_or_b32 v89, v107, 16, v106
    v_lshl_or_b32 v90, v109, 16, v108
    v_lshl_or_b32 v91, v111, 16, v110
    s_nop 1
    v_mfma_f32_32x32x16_bf16 a[0:15], v[92:95], v[88:91], a[0:15]
    ds_read_u16 v104, v14 offset:2304
    ds_read_u16 v105, v14 offset:2448
    ds_read_u16 v106, v14 offset:2592
    ds_read_u16 v107, v14 offset:2736
    ds_read_u16 v108, v14 offset:2880
    ds_read_u16 v109, v14 offset:3024
    ds_read_u16 v110, v14 offset:3168
    ds_read_u16 v111, v14 offset:3312
    ds_read_b128 v[92:95], v15 offset:32
    s_waitcnt lgkmcnt(0)
    v_lshl_or_b32 v88, v105, 16, v104
    v_lshl_or_b32 v89, v107, 16, v106
    v_lshl_or_b32 v90, v109, 16, v108
    v_lshl_or_b32 v91, v111, 16, v110
    s_nop 1
    v_mfma_f32_32x32x16_bf16 a[0:15], v[92:95], v[88:91], a[0:15]
    ds_read_u16 v104, v14 offset:4608
    ds_read_u16 v105, v14 offset:4752
    ds_read_u16 v106, v14 offset:4896
    ds_read_u16 v107, v14 offset:5040
    ds_read_u16 v108, v14 offset:5184
    ds_read_u16 v109, v14 offset:5328
    ds_read_u16 v110, v14 offset:5472
    ds_read_u16 v111, v14 offset:5616
    ds_read_b128 v[92:95], v15 offset:64
    s_waitcnt lgkmcnt(0)
    v_lshl_or_b32 v88, v105, 16, v104
    v_lshl_or_b32 v89, v107, 16, v106
    v_lshl_or_b32 v90, v109, 16, v108
    v_lshl_or_b32 v91, v111, 16, v110
    s_nop 1
    v_mfma_f32_32x32x16_bf16 a[0:15], v[92:95], v[88:91], a[0:15]
    ds_read_u16 v104, v14 offset:6912
    ds_read_u16 v105, v14 offset:7056
    ds_read_u16 v106, v14 offset:7200
    ds_read_u16 v107, v14 offset:7344
    ds_read_u16 v108, v14 offset:7488
    ds_read_u16 v109, v14 offset:7632
    ds_read_u16 v110, v14 offset:7776
    ds_read_u16 v111, v14 offset:7920
    ds_read_b128 v[92:95], v15 offset:96
    s_waitcnt lgkmcnt(0)
    v_lshl_or_b32 v88, v105, 16, v104
    v_lshl_or_b32 v89, v107, 16, v106
    v_lshl_or_b32 v90, v109, 16, v108
    v_lshl_or_b32 v91, v111, 16, v110
    s_nop 1
    v_mfma_f32_32x32x16_bf16 a[0:15], v[92:95], v[88:91], a[0:15]
    s_waitcnt vmcnt(8)
    ds_write_b128 v16, v[40:43] offset:0
    ds_write_b128 v16, v[44:47] offset:4608
    ds_write_b128 v17, v[48:51] offset:0
    ds_write_b128 v17, v[52:55] offset:4608
    s_waitcnt lgkmcnt(0)
    s_barrier
    ds_read_u16 v104, v18 offset:0
    ds_read_u16 v105, v18 offset:144
    ds_read_u16 v106, v18 offset:288
    ds_read_u16 v107, v18 offset:432
    ds_read_u16 v108, v18 offset:576
    ds_read_u16 v109, v18 offset:720
    ds_read_u16 v110, v18 offset:864
    ds_read_u16 v111, v18 offset:1008
    ds_read_b128 v[92:95], v19 offset:0
    s_waitcnt lgkmcnt(0)
    v_lshl_or_b32 v88, v105, 16, v104
    v_lshl_or_b32 v89, v107, 16, v106
    v_lshl_or_b32 v90, v109, 16, v108
    v_lshl_or_b32 v91, v111, 16, v110
    s_nop 1
    v_mfma_f32_32x32x16_bf16 a[0:15], v[92:95], v[88:91], a[0:15]
    ds_read_u16 v104, v18 offset:2304
    ds_read_u16 v105, v18 offset:2448
    ds_read_u16 v106, v18 offset:2592
    ds_read_u16 v107, v18 offset:2736
    ds_read_u16 v108, v18 offset:2880
    ds_read_u16 v109, v18 offset:3024
    ds_read_u16 v110, v18 offset:3168
    ds_read_u16 v111, v18 offset:3312
    ds_read_b128 v[92:95], v19 offset:32
    s_waitcnt lgkmcnt(0)
    v_lshl_or_b32 v88, v105, 16, v104
    v_lshl_or_b32 v89, v107, 16, v106
    v_lshl_or_b32 v90, v109, 16, v108
    v_lshl_or_b32 v91, v111, 16, v110
    s_nop 1
    v_mfma_f32_32x32x16_bf16 a[0:15], v[92:95], v[88:91], a[0:15]
    ds_read_u16 v104, v18 offset:4608
    ds_read_u16 v105, v18 offset:4752
    ds_read_u16 v106, v18 offset:4896
    ds_read_u16 v107, v18 offset:5040
    ds_read_u16 v108, v18 offset:5184
    ds_read_u16 v109, v18 offset:5328
    ds_read_u16 v110, v18 offset:5472
    ds_read_u16 v111, v18 offset:5616
    ds_read_b128 v[92:95], v19 offset:64
    s_waitcnt lgkmcnt(0)
    v_lshl_or_b32 v88, v105, 16, v104
    v_lshl_or_b32 v89, v107, 16, v106
    v_lshl_or_b32 v90, v109, 16, v108
    v_lshl_or_b32 v91, v111, 16, v110
    s_nop 1
    v_mfma_f32_32x32x16_bf16 a[0:15], v[92:95], v[88:91], a[0:15]
    ds_read_u16 v104, v18 offset:6912
    ds_read_u16 v105, v18 offset:7056
    ds_read_u16 v106, v18 offset:7200
    ds_read_u16 v107, v18 offset:7344
    ds_read_u16 v108, v18 offset:7488
    ds_read_u16 v109, v18 offset:7632
    ds_read_u16 v110, v18 offset:7776
    ds_read_u16 v111, v18 offset:7920
    ds_read_b128 v[92:95], v19 offset:96
    s_waitcnt lgkmcnt(0)
    v_lshl_or_b32 v88, v105, 16, v104
    v_lshl_or_b32 v89, v107, 16, v106
    v_lshl_or_b32 v90, v109, 16, v108
    v_lshl_or_b32 v91, v111, 16, v110
    s_nop 1
    v_mfma_f32_32x32x16_bf16 a[0:15], v[92:95], v[88:91], a[0:15]
    s_waitcnt vmcnt(4)
    ds_write_b128 v12, v[56:59] offset:0
    ds_write_b128 v12, v[60:63] offset:4608
    ds_write_b128 v13, v[64:67] offset:0
    ds_write_b128 v13, v[68:71] offset:4608
    s_waitcnt lgkmcnt(0)
    s_barrier
    ds_read_u16 v104, v14 offset:0
    ds_read_u16 v105, v14 offset:144
    ds_read_u16 v106, v14 offset:288
    ds_read_u16 v107, v14 offset:432
    ds_read_u16 v108, v14 offset:576
    ds_read_u16 v109, v14 offset:720
    ds_read_u16 v110, v14 offset:864
    ds_read_u16 v111, v14 offset:1008
    ds_read_b128 v[92:95], v15 offset:0
    s_waitcnt lgkmcnt(0)
    v_lshl_or_b32 v88, v105, 16, v104
    v_lshl_or_b32 v89, v107, 16, v106
    v_lshl_or_b32 v90, v109, 16, v108
    v_lshl_or_b32 v91, v111, 16, v110
    s_nop 1
    v_mfma_f32_32x32x16_bf16 a[0:15], v[92:95], v[88:91], a[0:15]
    ds_read_u16 v104, v14 offset:2304
    ds_read_u16 v105, v14 offset:2448
    ds_read_u16 v106, v14 offset:2592
    ds_read_u16 v107, v14 offset:2736
    ds_read_u16 v108, v14 offset:2880
    ds_read_u16 v109, v14 offset:3024
    ds_read_u16 v110, v14 offset:3168
    ds_read_u16 v111, v14 offset:3312
    ds_read_b128 v[92:95], v15 offset:32
    s_waitcnt lgkmcnt(0)
    v_lshl_or_b32 v88, v105, 16, v104
    v_lshl_or_b32 v89, v107, 16, v106
    v_lshl_or_b32 v90, v109, 16, v108
    v_lshl_or_b32 v91, v111, 16, v110
    s_nop 1
    v_mfma_f32_32x32x16_bf16 a[0:15], v[92:95], v[88:91], a[0:15]
    ds_read_u16 v104, v14 offset:4608
    ds_read_u16 v105, v14 offset:4752
    ds_read_u16 v106, v14 offset:4896
    ds_read_u16 v107, v14 offset:5040
    ds_read_u16 v108, v14 offset:5184
    ds_read_u16 v109, v14 offset:5328
    ds_read_u16 v110, v14 offset:5472
    ds_read_u16 v111, v14 offset:5616
    ds_read_b128 v[92:95], v15 offset:64
    s_waitcnt lgkmcnt(0)
    v_lshl_or_b32 v88, v105, 16, v104
    v_lshl_or_b32 v89, v107, 16, v106
    v_lshl_or_b32 v90, v109, 16, v108
    v_lshl_or_b32 v91, v111, 16, v110
    s_nop 1
    v_mfma_f32_32x32x16_bf16 a[0:15], v[92:95], v[88:91], a[0:15]
    ds_read_u16 v104, v14 offset:6912
    ds_read_u16 v105, v14 offset:7056
    ds_read_u16 v106, v14 offset:7200
    ds_read_u16 v107, v14 offset:7344
    ds_read_u16 v108, v14 offset:7488
    ds_read_u16 v109, v14 offset:7632
    ds_read_u16 v110, v14 offset:7776
    ds_read_u16 v111, v14 offset:7920
    ds_read_b128 v[92:95], v15 offset:96
    s_waitcnt lgkmcnt(0)
    v_lshl_or_b32 v88, v105, 16, v104
    v_lshl_or_b32 v89, v107, 16, v106
    v_lshl_or_b32 v90, v109, 16, v108
    v_lshl_or_b32 v91, v111, 16, v110
    s_nop 1
    v_mfma_f32_32x32x16_bf16 a[0:15], v[92:95], v[88:91], a[0:15]
    s_waitcnt vmcnt(0)
    ds_write_b128 v16, v[72:75] offset:0
    ds_write_b128 v16, v[76:79] offset:4608
    ds_write_b128 v17, v[80:83] offset:0
    ds_write_b128 v17, v[84:87] offset:4608
    s_waitcnt lgkmcnt(0)
    s_barrier
    ds_read_u16 v104, v18 offset:0
    ds_read_u16 v105, v18 offset:144
    ds_read_u16 v106, v18 offset:288
    ds_read_u16 v107, v18 offset:432
    ds_read_u16 v108, v18 offset:576
    ds_read_u16 v109, v18 offset:720
    ds_read_u16 v110, v18 offset:864
    ds_read_u16 v111, v18 offset:1008
    ds_read_b128 v[92:95], v19 offset:0
    s_waitcnt lgkmcnt(0)
    v_lshl_or_b32 v88, v105, 16, v104
    v_lshl_or_b32 v89, v107, 16, v106
    v_lshl_or_b32 v90, v109, 16, v108
    v_lshl_or_b32 v91, v111, 16, v110
    s_nop 1
    v_mfma_f32_32x32x16_bf16 a[0:15], v[92:95], v[88:91], a[0:15]
    ds_read_u16 v104, v18 offset:2304
    ds_read_u16 v105, v18 offset:2448
    ds_read_u16 v106, v18 offset:2592
    ds_read_u16 v107, v18 offset:2736
    ds_read_u16 v108, v18 offset:2880
    ds_read_u16 v109, v18 offset:3024
    ds_read_u16 v110, v18 offset:3168
    ds_read_u16 v111, v18 offset:3312
    ds_read_b128 v[92:95], v19 offset:32
    s_waitcnt lgkmcnt(0)
    v_lshl_or_b32 v88, v105, 16, v104
    v_lshl_or_b32 v89, v107, 16, v106
    v_lshl_or_b32 v90, v109, 16, v108
    v_lshl_or_b32 v91, v111, 16, v110
    s_nop 1
    v_mfma_f32_32x32x16_bf16 a[0:15], v[92:95], v[88:91], a[0:15]
    ds_read_u16 v104, v18 offset:4608
    ds_read_u16 v105, v18 offset:4752
    ds_read_u16 v106, v18 offset:4896
    ds_read_u16 v107, v18 offset:5040
    ds_read_u16 v108, v18 offset:5184
    ds_read_u16 v109, v18 offset:5328
    ds_read_u16 v110, v18 offset:5472
    ds_read_u16 v111, v18 offset:5616
    ds_read_b128 v[92:95], v19 offset:64
    s_waitcnt lgkmcnt(0)
    v_lshl_or_b32 v88, v105, 16, v104
    v_lshl_or_b32 v89, v107, 16, v106
    v_lshl_or_b32 v90, v109, 16, v108
    v_lshl_or_b32 v91, v111, 16, v110
    s_nop 1
    v_mfma_f32_32x32x16_bf16 a[0:15], v[92:95], v[88:91], a[0:15]
    ds_read_u16 v104, v18 offset:6912
    ds_read_u16 v105, v18 offset:7056
    ds_read_u16 v106, v18 offset:7200
    ds_read_u16 v107, v18 offset:7344
    ds_read_u16 v108, v18 offset:7488
    ds_read_u16 v109, v18 offset:7632
    ds_read_u16 v110, v18 offset:7776
    ds_read_u16 v111, v18 offset:7920
    ds_read_b128 v[92:95], v19 offset:96
    s_waitcnt lgkmcnt(0)
    v_lshl_or_b32 v88, v105, 16, v104
    v_lshl_or_b32 v89, v107, 16, v106
    v_lshl_or_b32 v90, v109, 16, v108
    v_lshl_or_b32 v91, v111, 16, v110
    s_nop 1
    v_mfma_f32_32x32x16_bf16 a[0:15], v[92:95], v[88:91], a[0:15]
    s_nop 15
    v_and_b32 v4, 31, v1
    v_lshrrev_b32 v5, 5, v1
    s_mul_i32 s31, s25, 32
    s_add_u32 s31, s31, s27
    v_add_u32 v4, s31, v4
    s_mul_i32 s36, s26, 32
    s_add_u32 s36, s36, s28
    v_lshlrev_b32 v5, 2, v5
    v_add_u32 v5, s36, v5
    s_mov_b32 s37, 896
    v_mul_lo_u32 v6, v4, s37
    v_lshl_add_u32 v6, v5, 1, v6
    s_add_u32 s14, s4, 0x65b3000
    s_addc_u32 s15, s5, 0
    s_mul_i32 s38, s20, 28
    v_lshrrev_b32 v7, 4, v4
    v_add_u32 v7, s38, v7
    v_mul_u32_u24 v7, 14, v7
    s_lshr_b32 s38, s36, 5
    v_add_u32 v7, s38, v7
    v_lshlrev_b32 v7, 6, v7
    v_and_b32 v2, 15, v4
    v_add_u32 v7, v7, v2
    v_lshlrev_b32 v7, 4, v7
    v_lshrrev_b32 v2, 5, v1
    v_lshl_add_u32 v7, v2, 3, v7
    v_accvgpr_read_b32 v24, a0
    v_accvgpr_read_b32 v25, a1
    v_accvgpr_read_b32 v26, a2
    v_accvgpr_read_b32 v27, a3
    v_cvt_pk_bf16_f32 v28, v24, v25
    v_cvt_pk_bf16_f32 v29, v26, v27
    global_store_dwordx2 v6, v[28:29], s[10:11] offset:0
    global_store_dwordx2 v7, v[28:29], s[14:15] offset:0
    v_accvgpr_read_b32 v40, a4
    v_accvgpr_read_b32 v41, a5
    v_accvgpr_read_b32 v42, a6
    v_accvgpr_read_b32 v43, a7
    v_cvt_pk_bf16_f32 v44, v40, v41
    v_cvt_pk_bf16_f32 v45, v42, v43
    global_store_dwordx2 v6, v[44:45], s[10:11] offset:16
    global_store_dwordx2 v7, v[44:45], s[14:15] offset:256
    v_accvgpr_read_b32 v56, a8
    v_accvgpr_read_b32 v57, a9
    v_accvgpr_read_b32 v58, a10
    v_accvgpr_read_b32 v59, a11
    v_cvt_pk_bf16_f32 v60, v56, v57
    v_cvt_pk_bf16_f32 v61, v58, v59
    global_store_dwordx2 v6, v[60:61], s[10:11] offset:32
    global_store_dwordx2 v7, v[60:61], s[14:15] offset:512
    v_accvgpr_read_b32 v72, a12
    v_accvgpr_read_b32 v73, a13
    v_accvgpr_read_b32 v74, a14
    v_accvgpr_read_b32 v75, a15
    v_cvt_pk_bf16_f32 v76, v72, v73
    v_cvt_pk_bf16_f32 v77, v74, v75
    global_store_dwordx2 v6, v[76:77], s[10:11] offset:48
    global_store_dwordx2 v7, v[76:77], s[14:15] offset:768
end_g2_1:
    s_endpgm
sub_prea_4:
    s_cmp_ge_u32 s2, 512
    s_cbranch_scc1 end_ln1_1
    s_load_dwordx2 s[4:5], s[0:1], 0
    s_load_dwordx2 s[8:9], s[0:1], 128
    s_load_dwordx2 s[26:27], s[0:1], 120
    v_and_b32 v1, 63, v0
    v_lshrrev_b32 v2, 6, v0
    s_lshl_b32 s10, s2, 2
    v_add_u32 v2, s10, v2
    v_mul_u32_u24 v2, 896, v2
    v_min_u32 v3, 55, v1
    v_lshl_add_u32 v2, v3, 4, v2
    v_lshlrev_b32 v4, 5, v3
    s_waitcnt lgkmcnt(0)
    s_add_u32 s12, s8, 0x3000
    s_addc_u32 s13, s9, 0
    global_load_dwordx4 v[8:11], v2, s[4:5]
    s_add_u32 s14, s8, 0x0
    s_addc_u32 s15, s9, 0
    s_add_u32 s16, s8, 0x700
    s_addc_u32 s17, s9, 0
    s_mov_b32 s28, 0
    v_mov_b32 v5, 128
mw_ln1_2:
    global_load_dword v6, v5, s[26:27] sc1
    s_add_u32 s28, s28, 1
    s_cmp_gt_u32 s28, 262144
    s_cbranch_scc1 md_ln1_3
    s_waitcnt vmcnt(0)
    v_cmp_gt_u32 vcc, 21, v6
    s_nop 1
    s_cbranch_vccz md_ln1_3
    s_sleep 8
    s_branch mw_ln1_2
md_ln1_3:
    global_load_dwordx4 v[32:35], v4, s[14:15] sc1
    global_load_dwordx4 v[36:39], v4, s[14:15] offset:16 sc1
    global_load_dwordx4 v[40:43], v4, s[16:17] sc1
    global_load_dwordx4 v[44:47], v4, s[16:17] offset:16 sc1
    v_cmp_gt_u32 s[20:21], 56, v1
    s_waitcnt vmcnt(4)
    v_lshlrev_b32 v16, 16, v8
    v_and_b32 v17, 0xffff0000, v8
    v_lshlrev_b32 v18, 16, v9
    v_and_b32 v19, 0xffff0000, v9
    v_lshlrev_b32 v20, 16, v10
    v_and_b32 v21, 0xffff0000, v10
    v_lshlrev_b32 v22, 16, v11
    v_and_b32 v23, 0xffff0000, v11
    v_add_f32 v24, v16, v17
    v_add_f32 v24, v24, v18
    v_add_f32 v24, v24, v19
    v_add_f32 v24, v24, v20
    v_add_f32 v24, v24, v21
    v_add_f32 v24, v24, v22
    v_add_f32 v24, v24, v23
    v_cndmask_b32 v24, 0, v24, s[20:21]
    s_nop 1
    v_add_f32_dpp v24, v24, v24 row_ror:8 row_mask:0xf bank_mask:0xf
    s_nop 1
    v_add_f32_dpp v24, v24, v24 row_ror:4 row_mask:0xf bank_mask:0xf
    s_nop 1
    v_add_f32_dpp v24, v24, v24 row_ror:2 row_mask:0xf bank_mask:0xf
    s_nop 1
    v_add_f32_dpp v24, v24, v24 row_ror:1 row_mask:0xf bank_mask:0xf
    v_mov_b32 v26, v24
    v_mov_b32 v27, v24
    s_nop 1
    v_permlane16_swap_b32 v26, v27
    s_nop 1
    v_add_f32 v24, v26, v27
    v_mov_b32 v26, v24
    v_mov_b32 v27, v24
    s_nop 1
    v_permlane32_swap_b32 v26, v27
    s_nop 1
    v_add_f32 v24, v26, v27
    v_mul_f32 v24, 0x3b124925, v24
    v_mov_b32 v25, 0
    v_sub_f32 v28, v16, v24
    v_fmac_f32 v25, v28, v28
    v_sub_f32 v28, v17, v24
    v_fmac_f32 v25, v28, v28
    v_sub_f32 v28, v18, v24
    v_fmac_f32 v25, v28, v28
    v_sub_f32 v28, v19, v24
    v_fmac_f32 v25, v28, v28
    v_sub_f32 v28, v20, v24
    v_fmac_f32 v25, v28, v28
    v_sub_f32 v28, v21, v24
    v_fmac_f32 v25, v28, v28
    v_sub_f32 v28, v22, v24
    v_fmac_f32 v25, v28, v28
    v_sub_f32 v28, v23, v24
    v_fmac_f32 v25, v28, v28
    v_cndmask_b32 v25, 0, v25, s[20:21]
    s_nop 1
    v_add_f32_dpp v25, v25, v25 row_ror:8 row_mask:0xf bank_mask:0xf
    s_nop 1
    v_add_f32_dpp v25, v25, v25 row_ror:4 row_mask:0xf bank_mask:0xf
    s_nop 1
    v_add_f32_dpp v25, v25, v25 row_ror:2 row_mask:0xf bank_mask:0xf
    s_nop 1
    v_add_f32_dpp v25, v25, v25 row_ror:1 row_mask:0xf bank_mask:0xf
    v_mov_b32 v26, v25
    v_mov_b32 v27, v25
    s_nop 1
    v_permlane16_swap_b32 v26, v27
    s_nop 1
    v_add_f32 v25, v26, v27
    v_mov_b32 v26, v25
    v_mov_b32 v27, v25
    s_nop 1
    v_permlane32_swap_b32 v26, v27
    s_nop 1
    v_add_f32 v25, v26, v27
    v_mul_f32 v25, 0x3b124925, v25
    v_cvt_pk_bf16_f32 v26, v24, v25
    v_lshlrev_b32 v24, 16, v26
    v_and_b32 v25, 0xffff0000, v26
    v_add_f32 v25, 0x3727c5ac, v25
    v_cvt_pk_bf16_f32 v27, v25, v25
    v_lshlrev_b32 v25, 16, v27
    v_and_b32 v26, 0xffff0000, v27
    v_sqrt_f32 v25, v25
    s_nop 0
    v_cvt_pk_bf16_f32 v27, v25, v25
    v_lshlrev_b32 v25, 16, v27
    v_and_b32 v26, 0xffff0000, v27
    v_rcp_f32 v26, v25
    s_nop 0
    s_waitcnt vmcnt(0)
    v_sub_f32 v16, v16, v24
    v_sub_f32 v17, v17, v24
    v_cvt_pk_bf16_f32 v27, v16, v17
    v_lshlrev_b32 v16, 16, v27
    v_and_b32 v17, 0xffff0000, v27
    v_mul_f32 v28, v16, v26
    v_fma_f32 v29, -v28, v25, v16
    v_fma_f32 v16, v29, v26, v28
    v_mul_f32 v28, v17, v26
    v_fma_f32 v29, -v28, v25, v17
    v_fma_f32 v17, v29, v26, v28
    v_cvt_pk_bf16_f32 v27, v16, v17
    v_lshlrev_b32 v16, 16, v27
    v_and_b32 v17, 0xffff0000, v27
    v_mul_f32 v16, v16, v40
    v_mul_f32 v17, v17, v41
    v_cvt_pk_bf16_f32 v27, v16, v17
    v_lshlrev_b32 v16, 16, v27
    v_and_b32 v17, 0xffff0000, v27
    v_add_f32 v16, v16, v32
    v_add_f32 v17, v17, v33
    v_cvt_pk_bf16_f32 v48, v16, v17
    v_sub_f32 v18, v18, v24
    v_sub_f32 v19, v19, v24
    v_cvt_pk_bf16_f32 v27, v18, v19
    v_lshlrev_b32 v18, 16, v27
    v_and_b32 v19, 0xffff0000, v27
    v_mul_f32 v28, v18, v26
    v_fma_f32 v29, -v28, v25, v18
    v_fma_f32 v18, v29, v26, v28
    v_mul_f32 v28, v19, v26
    v_fma_f32 v29, -v28, v25, v19
    v_fma_f32 v19, v29, v26, v28
    v_cvt_pk_bf16_f32 v27, v18, v19
    v_lshlrev_b32 v18, 16, v27
    v_and_b32 v19, 0xffff0000, v27
    v_mul_f32 v18, v18, v42
    v_mul_f32 v19, v19, v43
    v_cvt_pk_bf16_f32 v27, v18, v19
    v_lshlrev_b32 v18, 16, v27
    v_and_b32 v19, 0xffff0000, v27
    v_add_f32 v18, v18, v34
    v_add_f32 v19, v19, v35
    v_cvt_pk_bf16_f32 v49, v18, v19
    v_sub_f32 v20, v20, v24
    v_sub_f32 v21, v21, v24
    v_cvt_pk_bf16_f32 v27, v20, v21
    v_lshlrev_b32 v20, 16, v27
    v_and_b32 v21, 0xffff0000, v27
    v_mul_f32 v28, v20, v26
    v_fma_f32 v29, -v28, v25, v20
    v_fma_f32 v20, v29, v26, v28
    v_mul_f32 v28, v21, v26
    v_fma_f32 v29, -v28, v25, v21
    v_fma_f32 v21, v29, v26, v28
    v_cvt_pk_bf16_f32 v27, v20, v21
    v_lshlrev_b32 v20, 16, v27
    v_and_b32 v21, 0xffff0000, v27
    v_mul_f32 v20, v20, v44
    v_mul_f32 v21, v21, v45
    v_cvt_pk_bf16_f32 v27, v20, v21
    v_lshlrev_b32 v20, 16, v27
    v_and_b32 v21, 0xffff0000, v27
    v_add_f32 v20, v20, v36
    v_add_f32 v21, v21, v37
    v_cvt_pk_bf16_f32 v50, v20, v21
    v_sub_f32 v22, v22, v24
    v_sub_f32 v23, v23, v24
    v_cvt_pk_bf16_f32 v27, v22, v23
    v_lshlrev_b32 v22, 16, v27
    v_and_b32 v23, 0xffff0000, v27
    v_mul_f32 v28, v22, v26
    v_fma_f32 v29, -v28, v25, v22
    v_fma_f32 v22, v29, v26, v28
    v_mul_f32 v28, v23, v26
    v_fma_f32 v29, -v28, v25, v23
    v_fma_f32 v23, v29, v26, v28
    v_cvt_pk_bf16_f32 v27, v22, v23
    v_lshlrev_b32 v22, 16, v27
    v_and_b32 v23, 0xffff0000, v27
    v_mul_f32 v22, v22, v46
    v_mul_f32 v23, v23, v47
    v_cvt_pk_bf16_f32 v27, v22, v23
    v_lshlrev_b32 v22, 16, v27
    v_and_b32 v23, 0xffff0000, v27
    v_add_f32 v22, v22, v38
    v_add_f32 v23, v23, v39
    v_cvt_pk_bf16_f32 v51, v22, v23
    v_lshrrev_b32 v52, 6, v0
    v_add_u32 v52, s10, v52
    v_lshrrev_b32 v53, 4, v52
    v_and_b32 v54, 15, v52
    v_mul_u32_u24 v55, 14, v53
    v_lshrrev_b32 v56, 2, v3
    v_add_u32 v55, v55, v56
    v_lshlrev_b32 v55, 6, v55
    v_and_b32 v56, 3, v3
    v_lshl_add_u32 v55, v56, 4, v55
    v_add_u32 v55, v55, v54
    v_lshlrev_b32 v55, 4, v55
    v_mul_u32_u24 v57, 28, v53
    v_lshrrev_b32 v56, 1, v3
    v_add_u32 v57, v57, v56
    v_lshlrev_b32 v57, 6, v57
    v_and_b32 v56, 1, v3
    v_lshl_add_u32 v57, v56, 5, v57
    v_add_u32 v57, v57, v54
    v_lshlrev_b32 v57, 3, v57
    s_add_u32 s22, s8, 0x4ed3000
    s_addc_u32 s23, s9, 0
    s_add_u32 s24, s8, 0x4d13000
    s_addc_u32 s25, s9, 0
    s_mov_b64 exec, s[20:21]
    global_store_dwordx4 v2, v[48:51], s[12:13]
    global_store_dwordx4 v55, v[48:51], s[22:23]
    global_store_dwordx2 v57, v[48:49], s[24:25]
    global_store_dwordx2 v57, v[50:51], s[24:25] offset:128
end_ln1_1:
    s_endpgm
    s_endpgm
.section .rodata,"a"
.p2align 6
.amdhsa_kernel prea_kernel
  .amdhsa_next_free_vgpr 144
  .amdhsa_next_free_sgpr 96
  .amdhsa_accum_offset 128
  .amdhsa_group_segment_fixed_size 0
  .amdhsa_kernarg_size 136
  .amdhsa_user_sgpr_count 2
  .amdhsa_user_sgpr_kernarg_segment_ptr 1
  .amdhsa_system_sgpr_workgroup_id_x 1
.end_amdhsa_kernel
.text
.globl chain_kernel
.p2align 8
.type chain_kernel,@function
chain_kernel:
    s_and_b32 s3, s2, 7
    s_cmp_lg_u32 s3, 0
    s_cbranch_scc1 wk_chain_3
    s_cmp_eq_u32 s2, 240
    s_cbranch_scc1 pf_chain_4
    s_cmp_ge_u32 s2, 240
    s_cbranch_scc1 end_chain_1
    s_lshr_b32 s3, s2, 3
    s_load_dwordx2 s[4:5], s[0:1], 128
    s_load_dwordx2 s[6:7], s[0:1], 120
    v_and_b32 v1, 63, v0
    v_lshrrev_b32 v2, 6, v0
    s_nop 0
    v_readfirstlane_b32 s10, v2
    v_and_b32 v2, 15, v1
    v_lshrrev_b32 v3, 4, v1
    s_mov_b32 s45, 0
    s_getreg_b32 s20, hwreg(HW_REG_XCC_ID)
    s_and_b32 s20, s20, 0xff
    s_add_u32 s20, s20, 1
    s_waitcnt lgkmcnt(0)
    v_mov_b32 v5, s20
    s_lshl_b32 s21, s3, 2
    v_mov_b32 v6, s21
    s_mov_b64 exec, 1
    global_store_dword v6, v5, s[6:7] sc1
    s_mov_b64 exec, -1
    s_add_u32 s91, s3, 208
    v_lshlrev_b32 v9, 4, v1
    s_lshl_b32 s21, s10, 10
    v_add_u32 v5, s21, v9
    s_add_u32 s22, s10, 4
    s_min_u32 s22, s22, 6
    s_lshl_b32 s22, s22, 10
    v_add_u32 v6, s22, v9
    v_lshrrev_b32 v7, 5, v1
    v_lshlrev_b32 v7, 10, v7
    v_bfe_u32 v8, v1, 3, 2
    v_lshl_add_u32 v7, v8, 8, v7
    v_and_b32 v8, 7, v1
    v_lshl_add_u32 v7, v8, 4, v7
    v_add_u32 v7, 139264, v7
    s_lshl_b32 s21, s21, 1
    v_add_u32 v8, s21, v7
    s_lshl_b32 s22, s22, 1
    v_add_u32 v4, s22, v7
    v_add_u32 v18, 139264, v9
    v_cmp_gt_u32 s[40:41], 32, v1
    v_cmp_gt_u32 s[42:43], 8, v2
    s_and_b64 s[48:49], s[40:41], s[42:43]
    v_mov_b32 v64, 0
    v_mov_b32 v65, 0
    v_mov_b32 v66, 0
    v_mov_b32 v67, 0
    v_lshlrev_b32 v19, 4, v0
    v_add_u32 v19, 139264, v19
    ds_write_b128 v19, v[64:67] offset:0
    ds_write_b128 v19, v[64:67] offset:4096
    ds_write_b128 v19, v[64:67] offset:8192
    v_cmp_gt_u32 vcc, 128, v0
    s_and_saveexec_b64 s[22:23], vcc
    ds_write_b128 v19, v[64:67] offset:12288
    s_mov_b64 exec, -1
    s_waitcnt lgkmcnt(0)
    s_barrier
    s_cmp_ge_u32 s3, 16
    s_cbranch_scc1 O_chain_2
    s_mul_i32 s21, s3, 401408
    s_mul_i32 s24, s10, 100352
    s_add_u32 s21, s21, s24
    s_add_u32 s21, s21, 0x5f93000
    s_add_u32 s22, s4, s21
    s_addc_u32 s23, s5, 0
    global_load_dwordx4 a[0:3], v9, s[22:23] offset:0
    global_load_dwordx4 a[4:7], v9, s[22:23] offset:1024
    global_load_dwordx4 a[8:11], v9, s[22:23] offset:2048
    global_load_dwordx4 a[12:15], v9, s[22:23] offset:3072
    s_add_u32 s22, s22, 4096
    s_addc_u32 s23, s23, 0
    global_load_dwordx4 a[16:19], v9, s[22:23] offset:0
    global_load_dwordx4 a[20:23], v9, s[22:23] offset:1024
    global_load_dwordx4 a[24:27], v9, s[22:23] offset:2048
    global_load_dwordx4 a[28:31], v9, s[22:23] offset:3072
    s_add_u32 s22, s22, 4096
    s_addc_u32 s23, s23, 0
    global_load_dwordx4 a[32:35], v9, s[22:23] offset:0
    global_load_dwordx4 a[36:39], v9, s[22:23] offset:1024
    global_load_dwordx4 a[40:43], v9, s[22:23] offset:2048
    global_load_dwordx4 a[44:47], v9, s[22:23] offset:3072
    s_add_u32 s22, s22, 4096
    s_addc_u32 s23, s23, 0
    global_load_dwordx4 a[48:51], v9, s[22:23] offset:0
    global_load_dwordx4 a[52:55], v9, s[22:23] offset:1024
    global_load_dwordx4 a[56:59], v9, s[22:23] offset:2048
    global_load_dwordx4 a[60:63], v9, s[22:23] offset:3072
    s_add_u32 s22, s22, 4096
    s_addc_u32 s23, s23, 0
    global_load_dwordx4 a[64:67], v9, s[22:23] offset:0
    global_load_dwordx4 a[68:71], v9, s[22:23] offset:1024
    global_load_dwordx4 a[72:75], v9, s[22:23] offset:2048
    global_load_dwordx4 a[76:79], v9, s[22:23] offset:3072
    s_add_u32 s22, s22, 4096
    s_addc_u32 s23, s23, 0
    global_load_dwordx4 a[80:83], v9, s[22:23] offset:0
    global_load_dwordx4 a[84:87], v9, s[22:23] offset:1024
    global_load_dwordx4 a[88:91], v9, s[22:23] offset:2048
    global_load_dwordx4 a[92:95], v9, s[22:23] offset:3072
    s_add_u32 s22, s22, 4096
    s_addc_u32 s23, s23, 0
    global_load_dwordx4 a[96:99], v9, s[22:23] offset:0
    global_load_dwordx4 a[100:103], v9, s[22:23] offset:1024
    global_load_dwordx4 a[104:107], v9, s[22:23] offset:2048
    global_load_dwordx4 a[108:111], v9, s[22:23] offset:3072
    s_add_u32 s22, s22, 4096
    s_addc_u32 s23, s23, 0
    global_load_dwordx4 a[112:115], v9, s[22:23] offset:0
    global_load_dwordx4 a[116:119], v9, s[22:23] offset:1024
    global_load_dwordx4 a[120:123], v9, s[22:23] offset:2048
    global_load_dwordx4 a[124:127], v9, s[22:23] offset:3072
    s_add_u32 s22, s22, 4096
    s_addc_u32 s23, s23, 0
    global_load_dwordx4 a[128:131], v9, s[22:23] offset:0
    global_load_dwordx4 a[132:135], v9, s[22:23] offset:1024
    global_load_dwordx4 a[136:139], v9, s[22:23] offset:2048
    global_load_dwordx4 a[140:143], v9, s[22:23] offset:3072
    s_add_u32 s22, s22, 4096
    s_addc_u32 s23, s23, 0
    global_load_dwordx4 a[144:147], v9, s[22:23] offset:0
    global_load_dwordx4 a[148:151], v9, s[22:23] offset:1024
    global_load_dwordx4 a[152:155], v9, s[22:23] offset:2048
    global_load_dwordx4 a[156:159], v9, s[22:23] offset:3072
    s_add_u32 s22, s22, 4096
    s_addc_u32 s23, s23, 0
    global_load_dwordx4 a[160:163], v9, s[22:23] offset:0
    global_load_dwordx4 a[164:167], v9, s[22:23] offset:1024
    global_load_dwordx4 a[168:171], v9, s[22:23] offset:2048
    global_load_dwordx4 a[172:175], v9, s[22:23] offset:3072
    s_add_u32 s22, s22, 4096
    s_addc_u32 s23, s23, 0
    global_load_dwordx4 a[176:179], v9, s[22:23] offset:0
    global_load_dwordx4 a[180:183], v9, s[22:23] offset:1024
    global_load_dwordx4 a[184:187], v9, s[22:23] offset:2048
    global_load_dwordx4 a[188:191], v9, s[22:23] offset:3072
    s_add_u32 s22, s22, 4096
    s_addc_u32 s23, s23, 0
    global_load_dwordx4 a[192:195], v9, s[22:23] offset:0
    global_load_dwordx4 a[196:199], v9, s[22:23] offset:1024
    global_load_dwordx4 a[200:203], v9, s[22:23] offset:2048
    global_load_dwordx4 a[204:207], v9, s[22:23] offset:3072
    s_add_u32 s22, s22, 4096
    s_addc_u32 s23, s23, 0
    global_load_dwordx4 a[208:211], v9, s[22:23] offset:0
    global_load_dwordx4 a[212:215], v9, s[22:23] offset:1024
    global_load_dwordx4 a[216:219], v9, s[22:23] offset:2048
    global_load_dwordx4 a[220:223], v9, s[22:23] offset:3072
    s_add_u32 s22, s22, 4096
    s_addc_u32 s23, s23, 0
    global_load_dwordx4 a[224:227], v9, s[22:23] offset:0
    global_load_dwordx4 a[228:231], v9, s[22:23] offset:1024
    global_load_dwordx4 a[232:235], v9, s[22:23] offset:2048
    global_load_dwordx4 a[236:239], v9, s[22:23] offset:3072
    s_add_u32 s22, s22, 4096
    s_addc_u32 s23, s23, 0
    global_load_dwordx4 a[240:243], v9, s[22:23] offset:0
    global_load_dwordx4 a[244:247], v9, s[22:23] offset:1024
    global_load_dwordx4 a[248:251], v9, s[22:23] offset:2048
    global_load_dwordx4 a[252:255], v9, s[22:23] offset:3072
    s_add_u32 s22, s22, 4096
    s_addc_u32 s23, s23, 0
    global_load_dwordx4 v[120:123], v9, s[22:23] offset:0
    global_load_dwordx4 v[124:127], v9, s[22:23] offset:1024
    global_load_dwordx4 v[128:131], v9, s[22:23] offset:2048
    global_load_dwordx4 v[132:135], v9, s[22:23] offset:3072
    s_add_u32 s22, s22, 4096
    s_addc_u32 s23, s23, 0
    global_load_dwordx4 v[136:139], v9, s[22:23] offset:0
    global_load_dwordx4 v[140:143], v9, s[22:23] offset:1024
    global_load_dwordx4 v[144:147], v9, s[22:23] offset:2048
    global_load_dwordx4 v[148:151], v9, s[22:23] offset:3072
    s_add_u32 s22, s22, 4096
    s_addc_u32 s23, s23, 0
    global_load_dwordx4 v[152:155], v9, s[22:23] offset:0
    global_load_dwordx4 v[156:159], v9, s[22:23] offset:1024
    global_load_dwordx4 v[160:163], v9, s[22:23] offset:2048
    global_load_dwordx4 v[164:167], v9, s[22:23] offset:3072
    s_add_u32 s22, s22, 4096
    s_addc_u32 s23, s23, 0
    global_load_dwordx4 v[168:171], v9, s[22:23] offset:0
    global_load_dwordx4 v[172:175], v9, s[22:23] offset:1024
    global_load_dwordx4 v[176:179], v9, s[22:23] offset:2048
    global_load_dwordx4 v[180:183], v9, s[22:23] offset:3072
    s_add_u32 s22, s22, 4096
    s_addc_u32 s23, s23, 0
    global_load_dwordx4 v[184:187], v9, s[22:23] offset:0
    global_load_dwordx4 v[188:191], v9, s[22:23] offset:1024
    global_load_dwordx4 v[192:195], v9, s[22:23] offset:2048
    global_load_dwordx4 v[196:199], v9, s[22:23] offset:3072
    s_add_u32 s22, s22, 4096
    s_addc_u32 s23, s23, 0
    global_load_dwordx4 v[200:203], v9, s[22:23] offset:0
    global_load_dwordx4 v[204:207], v9, s[22:23] offset:1024
    global_load_dwordx4 v[208:211], v9, s[22:23] offset:2048
    global_load_dwordx4 v[212:215], v9, s[22:23] offset:3072
    s_add_u32 s22, s22, 4096
    s_addc_u32 s23, s23, 0
    global_load_dwordx4 v[216:219], v9, s[22:23] offset:0
    global_load_dwordx4 v[220:223], v9, s[22:23] offset:1024
    global_load_dwordx4 v[224:227], v9, s[22:23] offset:2048
    global_load_dwordx4 v[228:231], v9, s[22:23] offset:3072
    s_add_u32 s22, s22, 4096
    s_addc_u32 s23, s23, 0
    global_load_dwordx4 v[232:235], v9, s[22:23] offset:0
    global_load_dwordx4 v[236:239], v9, s[22:23] offset:1024
    global_load_dwordx4 v[240:243], v9, s[22:23] offset:2048
    global_load_dwordx4 v[244:247], v9, s[22:23] offset:3072
    s_add_u32 s22, s22, 4096
    s_addc_u32 s23, s23, 0
    global_load_dwordx4 v[248:251], v9, s[22:23] offset:0
    global_load_dwordx4 v[252:255], v9, s[22:23] offset:1024
    s_mul_i32 s24, s10, 3584
    v_lshlrev_b32 v11, 3, v1
    v_add_u32 v11, s24, v11
    v_add_u32 v12, 14336, v11
    v_lshrrev_b32 v13, 1, v3
    v_lshl_add_u32 v13, v13, 4, v2
    v_lshlrev_b32 v13, 4, v13
    v_and_b32 v14, 1, v3
    v_lshl_add_u32 v13, v14, 3, v13
    v_add_u32 v13, s24, v13
    v_add_u32 v13, 139264, v13
    s_mul_i32 s24, s10, 3072
    s_add_u32 s24, s24, 114688
    v_add_u32 v14, s24, v9
    v_add_u32 v15, 114688, v9
    s_add_u32 s30, s4, 0x4c93000
    s_addc_u32 s31, s5, 0
    s_add_u32 s32, s4, 0x4d13000
    s_addc_u32 s33, s5, 0
    s_add_u32 s34, s4, 0x5093000
    s_addc_u32 s35, s5, 0
    s_lshl_b32 s24, s3, 10
    v_add_u32 v16, s24, v9
    v_mov_b32 v61, 0xf149f2ca
    v_mov_b32 v62, 0x3fb8aa3b
    s_mov_b32 s36, 0
    s_mov_b32 s37, 0
    s_waitcnt vmcnt(0)
    v_min_u32 v60, 29, v1
    v_lshlrev_b32 v60, 2, v60
xp_chain_7:
    global_load_dword v17, v60, s[6:7] sc1
    s_add_u32 s45, s45, 1
    s_cmp_gt_u32 s45, 262144
    s_cbranch_scc1 end_chain_1
    s_waitcnt vmcnt(0)
    v_cmp_eq_u32 vcc, 0, v17
    s_nop 1
    s_cbranch_vccnz xp_chain_7
    v_cmp_ne_u32 vcc, s20, v17
    s_nop 1
    s_cmp_eq_u64 vcc, 0
    s_cselect_b32 s44, 1, 0
S_chain_5:
poll_chain_8:
    global_load_dwordx4 v[112:115], v5, s[30:31] sc1
    global_load_dwordx4 v[116:119], v6, s[30:31] sc1
    s_add_u32 s45, s45, 1
    s_cmp_gt_u32 s45, 262144
    s_cbranch_scc1 end_chain_1
    s_waitcnt vmcnt(0)
    v_max_u32 v60, v112, v113
    v_max3_u32 v60, v60, v114, v115
    v_max3_u32 v60, v60, v116, v117
    v_max3_u32 v60, v60, v118, v119
    v_cmp_eq_u32 vcc, -1, v60
    s_nop 1
    s_cbranch_vccnz poll_chain_8
    ds_write_b128 v8, v[112:115]
    ds_write_b128 v4, v[116:119]
    s_waitcnt lgkmcnt(0)
    s_barrier
    ds_read_b128 v[64:67], v18 offset:0
    ds_read_b128 v[68:71], v18 offset:1024
    ds_read_b128 v[72:75], v18 offset:2048
    ds_read_b128 v[76:79], v18 offset:3072
    ds_read_b128 v[80:83], v18 offset:4096
    ds_read_b128 v[84:87], v18 offset:5120
    ds_read_b128 v[88:91], v18 offset:6144
    ds_read_b128 v[92:95], v18 offset:7168
    ds_read_b128 v[96:99], v18 offset:8192
    ds_read_b128 v[100:103], v18 offset:9216
    ds_read_b128 v[104:107], v18 offset:10240
    ds_read_b128 v[108:111], v18 offset:11264
    ds_read_b128 v[112:115], v18 offset:12288
    ds_read_b128 v[116:119], v18 offset:13312
    s_waitcnt lgkmcnt(13)
    v_mfma_f32_16x16x32_bf16 v[32:35], a[0:3], v[64:67], 0
    v_mfma_f32_16x16x32_bf16 v[36:39], a[56:59], v[64:67], 0
    v_mfma_f32_16x16x32_bf16 v[40:43], a[112:115], v[64:67], 0
    v_mfma_f32_16x16x32_bf16 v[44:47], a[168:171], v[64:67], 0
    v_mfma_f32_16x16x32_bf16 v[48:51], a[224:227], v[64:67], 0
    v_mfma_f32_16x16x32_bf16 v[52:55], v[144:147], v[64:67], 0
    v_mfma_f32_16x16x32_bf16 v[56:59], v[200:203], v[64:67], 0
    global_load_dwordx2 v[64:65], v11, s[32:33] offset:0
    global_load_dwordx2 v[66:67], v11, s[32:33] offset:512
    s_waitcnt lgkmcnt(12)
    v_mfma_f32_16x16x32_bf16 v[32:35], a[4:7], v[68:71], v[32:35]
    v_mfma_f32_16x16x32_bf16 v[36:39], a[60:63], v[68:71], v[36:39]
    v_mfma_f32_16x16x32_bf16 v[40:43], a[116:119], v[68:71], v[40:43]
    v_mfma_f32_16x16x32_bf16 v[44:47], a[172:175], v[68:71], v[44:47]
    v_mfma_f32_16x16x32_bf16 v[48:51], a[228:231], v[68:71], v[48:51]
    v_mfma_f32_16x16x32_bf16 v[52:55], v[148:151], v[68:71], v[52:55]
    v_mfma_f32_16x16x32_bf16 v[56:59], v[204:207], v[68:71], v[56:59]
    global_load_dwordx2 v[68:69], v11, s[32:33] offset:1024
    global_load_dwordx2 v[70:71], v11, s[32:33] offset:1536
    s_waitcnt lgkmcnt(11)
    v_mfma_f32_16x16x32_bf16 v[32:35], a[8:11], v[72:75], v[32:35]
    v_mfma_f32_16x16x32_bf16 v[36:39], a[64:67], v[72:75], v[36:39]
    v_mfma_f32_16x16x32_bf16 v[40:43], a[120:123], v[72:75], v[40:43]
    v_mfma_f32_16x16x32_bf16 v[44:47], a[176:179], v[72:75], v[44:47]
    v_mfma_f32_16x16x32_bf16 v[48:51], a[232:235], v[72:75], v[48:51]
    v_mfma_f32_16x16x32_bf16 v[52:55], v[152:155], v[72:75], v[52:55]
    v_mfma_f32_16x16x32_bf16 v[56:59], v[208:211], v[72:75], v[56:59]
    global_load_dwordx2 v[72:73], v11, s[32:33] offset:2048
    global_load_dwordx2 v[74:75], v11, s[32:33] offset:2560
    s_waitcnt lgkmcnt(10)
    v_mfma_f32_16x16x32_bf16 v[32:35], a[12:15], v[76:79], v[32:35]
    v_mfma_f32_16x16x32_bf16 v[36:39], a[68:71], v[76:79], v[36:39]
    v_mfma_f32_16x16x32_bf16 v[40:43], a[124:127], v[76:79], v[40:43]
    v_mfma_f32_16x16x32_bf16 v[44:47], a[180:183], v[76:79], v[44:47]
    v_mfma_f32_16x16x32_bf16 v[48:51], a[236:239], v[76:79], v[48:51]
    v_mfma_f32_16x16x32_bf16 v[52:55], v[156:159], v[76:79], v[52:55]
    v_mfma_f32_16x16x32_bf16 v[56:59], v[212:215], v[76:79], v[56:59]
    global_load_dwordx2 v[76:77], v11, s[32:33] offset:3072
    global_load_dwordx2 v[78:79], v11, s[32:33] offset:3072
    s_waitcnt lgkmcnt(9)
    v_mfma_f32_16x16x32_bf16 v[32:35], a[16:19], v[80:83], v[32:35]
    v_mfma_f32_16x16x32_bf16 v[36:39], a[72:75], v[80:83], v[36:39]
    v_mfma_f32_16x16x32_bf16 v[40:43], a[128:131], v[80:83], v[40:43]
    v_mfma_f32_16x16x32_bf16 v[44:47], a[184:187], v[80:83], v[44:47]
    v_mfma_f32_16x16x32_bf16 v[48:51], a[240:243], v[80:83], v[48:51]
    v_mfma_f32_16x16x32_bf16 v[52:55], v[160:163], v[80:83], v[52:55]
    v_mfma_f32_16x16x32_bf16 v[56:59], v[216:219], v[80:83], v[56:59]
    global_load_dwordx2 v[80:81], v12, s[32:33] offset:0
    global_load_dwordx2 v[82:83], v12, s[32:33] offset:512
    s_waitcnt lgkmcnt(8)
    v_mfma_f32_16x16x32_bf16 v[32:35], a[20:23], v[84:87], v[32:35]
    v_mfma_f32_16x16x32_bf16 v[36:39], a[76:79], v[84:87], v[36:39]
    v_mfma_f32_16x16x32_bf16 v[40:43], a[132:135], v[84:87], v[40:43]
    v_mfma_f32_16x16x32_bf16 v[44:47], a[188:191], v[84:87], v[44:47]
    v_mfma_f32_16x16x32_bf16 v[48:51], a[244:247], v[84:87], v[48:51]
    v_mfma_f32_16x16x32_bf16 v[52:55], v[164:167], v[84:87], v[52:55]
    v_mfma_f32_16x16x32_bf16 v[56:59], v[220:223], v[84:87], v[56:59]
    global_load_dwordx2 v[84:85], v12, s[32:33] offset:1024
    global_load_dwordx2 v[86:87], v12, s[32:33] offset:1536
    s_waitcnt lgkmcnt(7)
    v_mfma_f32_16x16x32_bf16 v[32:35], a[24:27], v[88:91], v[32:35]
    v_mfma_f32_16x16x32_bf16 v[36:39], a[80:83], v[88:91], v[36:39]
    v_mfma_f32_16x16x32_bf16 v[40:43], a[136:139], v[88:91], v[40:43]
    v_mfma_f32_16x16x32_bf16 v[44:47], a[192:195], v[88:91], v[44:47]
    v_mfma_f32_16x16x32_bf16 v[48:51], a[248:251], v[88:91], v[48:51]
    v_mfma_f32_16x16x32_bf16 v[52:55], v[168:171], v[88:91], v[52:55]
    v_mfma_f32_16x16x32_bf16 v[56:59], v[224:227], v[88:91], v[56:59]
    global_load_dwordx2 v[88:89], v12, s[32:33] offset:2048
    global_load_dwordx2 v[90:91], v12, s[32:33] offset:2560
    s_waitcnt lgkmcnt(6)
    v_mfma_f32_16x16x32_bf16 v[32:35], a[28:31], v[92:95], v[32:35]
    v_mfma_f32_16x16x32_bf16 v[36:39], a[84:87], v[92:95], v[36:39]
    v_mfma_f32_16x16x32_bf16 v[40:43], a[140:143], v[92:95], v[40:43]
    v_mfma_f32_16x16x32_bf16 v[44:47], a[196:199], v[92:95], v[44:47]
    v_mfma_f32_16x16x32_bf16 v[48:51], a[252:255], v[92:95], v[48:51]
    v_mfma_f32_16x16x32_bf16 v[52:55], v[172:175], v[92:95], v[52:55]
    v_mfma_f32_16x16x32_bf16 v[56:59], v[228:231], v[92:95], v[56:59]
    global_load_dwordx2 v[92:93], v12, s[32:33] offset:3072
    global_load_dwordx2 v[94:95], v12, s[32:33] offset:3072
    s_waitcnt lgkmcnt(0)
    v_mfma_f32_16x16x32_bf16 v[32:35], a[32:35], v[96:99], v[32:35]
    v_mfma_f32_16x16x32_bf16 v[36:39], a[88:91], v[96:99], v[36:39]
    v_mfma_f32_16x16x32_bf16 v[40:43], a[144:147], v[96:99], v[40:43]
    v_mfma_f32_16x16x32_bf16 v[44:47], a[200:203], v[96:99], v[44:47]
    v_mfma_f32_16x16x32_bf16 v[48:51], v[120:123], v[96:99], v[48:51]
    v_mfma_f32_16x16x32_bf16 v[52:55], v[176:179], v[96:99], v[52:55]
    v_mfma_f32_16x16x32_bf16 v[56:59], v[232:235], v[96:99], v[56:59]
    ds_read_b64 v[96:97], v13 offset:0
    ds_read_b64 v[98:99], v13 offset:512
    v_mfma_f32_16x16x32_bf16 v[32:35], a[36:39], v[100:103], v[32:35]
    v_mfma_f32_16x16x32_bf16 v[36:39], a[92:95], v[100:103], v[36:39]
    v_mfma_f32_16x16x32_bf16 v[40:43], a[148:151], v[100:103], v[40:43]
    v_mfma_f32_16x16x32_bf16 v[44:47], a[204:207], v[100:103], v[44:47]
    v_mfma_f32_16x16x32_bf16 v[48:51], v[124:127], v[100:103], v[48:51]
    v_mfma_f32_16x16x32_bf16 v[52:55], v[180:183], v[100:103], v[52:55]
    v_mfma_f32_16x16x32_bf16 v[56:59], v[236:239], v[100:103], v[56:59]
    ds_read_b64 v[100:101], v13 offset:1024
    ds_read_b64 v[102:103], v13 offset:1536
    v_mfma_f32_16x16x32_bf16 v[32:35], a[40:43], v[104:107], v[32:35]
    v_mfma_f32_16x16x32_bf16 v[36:39], a[96:99], v[104:107], v[36:39]
    v_mfma_f32_16x16x32_bf16 v[40:43], a[152:155], v[104:107], v[40:43]
    v_mfma_f32_16x16x32_bf16 v[44:47], a[208:211], v[104:107], v[44:47]
    v_mfma_f32_16x16x32_bf16 v[48:51], v[128:131], v[104:107], v[48:51]
    v_mfma_f32_16x16x32_bf16 v[52:55], v[184:187], v[104:107], v[52:55]
    v_mfma_f32_16x16x32_bf16 v[56:59], v[240:243], v[104:107], v[56:59]
    ds_read_b64 v[104:105], v13 offset:2048
    ds_read_b64 v[106:107], v13 offset:2560
    v_mfma_f32_16x16x32_bf16 v[32:35], a[44:47], v[108:111], v[32:35]
    v_mfma_f32_16x16x32_bf16 v[36:39], a[100:103], v[108:111], v[36:39]
    v_mfma_f32_16x16x32_bf16 v[40:43], a[156:159], v[108:111], v[40:43]
    v_mfma_f32_16x16x32_bf16 v[44:47], a[212:215], v[108:111], v[44:47]
    v_mfma_f32_16x16x32_bf16 v[48:51], v[132:135], v[108:111], v[48:51]
    v_mfma_f32_16x16x32_bf16 v[52:55], v[188:191], v[108:111], v[52:55]
    v_mfma_f32_16x16x32_bf16 v[56:59], v[244:247], v[108:111], v[56:59]
    ds_read_b64 v[108:109], v13 offset:3072
    ds_read_b64 v[110:111], v13 offset:3072
    v_add_u32 v17, s37, v14
    v_mfma_f32_16x16x32_bf16 v[32:35], a[48:51], v[112:115], v[32:35]
    v_mfma_f32_16x16x32_bf16 v[36:39], a[104:107], v[112:115], v[36:39]
    v_mfma_f32_16x16x32_bf16 v[32:35], a[52:55], v[116:119], v[32:35]
    v_mfma_f32_16x16x32_bf16 v[36:39], a[108:111], v[116:119], v[36:39]
    v_mfma_f32_16x16x32_bf16 v[40:43], a[160:163], v[112:115], v[40:43]
    v_mfma_f32_16x16x32_bf16 v[44:47], a[216:219], v[112:115], v[44:47]
    v_mfma_f32_16x16x32_bf16 v[40:43], a[164:167], v[116:119], v[40:43]
    v_mfma_f32_16x16x32_bf16 v[44:47], a[220:223], v[116:119], v[44:47]
    s_nop 4
    v_cvt_pk_bf16_f32 v32, v32, v33
    v_cvt_pk_bf16_f32 v33, v34, v35
    v_cvt_pk_bf16_f32 v34, v36, v37
    v_cvt_pk_bf16_f32 v35, v38, v39
    v_mfma_f32_16x16x32_bf16 v[48:51], v[136:139], v[112:115], v[48:51]
    v_mfma_f32_16x16x32_bf16 v[52:55], v[192:195], v[112:115], v[52:55]
    v_mfma_f32_16x16x32_bf16 v[48:51], v[140:143], v[116:119], v[48:51]
    v_mfma_f32_16x16x32_bf16 v[52:55], v[196:199], v[116:119], v[52:55]
    s_waitcnt vmcnt(0) lgkmcnt(0)
    v_mfma_f32_16x16x32_bf16 v[20:23], v[96:99], v[32:35], 0
    v_mfma_f32_16x16x32_bf16 v[24:27], v[64:67], v[32:35], 0
    v_mfma_f32_16x16x32_bf16 v[28:31], v[80:83], v[32:35], 0
    v_cvt_pk_bf16_f32 v40, v40, v41
    v_cvt_pk_bf16_f32 v41, v42, v43
    v_cvt_pk_bf16_f32 v42, v44, v45
    v_cvt_pk_bf16_f32 v43, v46, v47
    v_mfma_f32_16x16x32_bf16 v[56:59], v[248:251], v[112:115], v[56:59]
    v_mfma_f32_16x16x32_bf16 v[56:59], v[252:255], v[116:119], v[56:59]
    v_mfma_f32_16x16x32_bf16 v[20:23], v[100:103], v[40:43], v[20:23]
    v_mfma_f32_16x16x32_bf16 v[24:27], v[68:71], v[40:43], v[24:27]
    v_mfma_f32_16x16x32_bf16 v[28:31], v[84:87], v[40:43], v[28:31]
    s_nop 1
    v_cvt_pk_bf16_f32 v48, v48, v49
    v_cvt_pk_bf16_f32 v49, v50, v51
    v_cvt_pk_bf16_f32 v50, v52, v53
    v_cvt_pk_bf16_f32 v51, v54, v55
    s_nop 1
    v_mfma_f32_16x16x32_bf16 v[20:23], v[104:107], v[48:51], v[20:23]
    v_mfma_f32_16x16x32_bf16 v[24:27], v[72:75], v[48:51], v[24:27]
    v_mfma_f32_16x16x32_bf16 v[28:31], v[88:91], v[48:51], v[28:31]
    s_nop 1
    v_cvt_pk_bf16_f32 v56, v56, v57
    v_cvt_pk_bf16_f32 v57, v58, v59
    v_mov_b32 v58, 0
    v_mov_b32 v59, 0
    s_nop 1
    v_mfma_f32_16x16x32_bf16 v[20:23], v[108:111], v[56:59], v[20:23]
    v_mfma_f32_16x16x32_bf16 v[24:27], v[76:79], v[56:59], v[24:27]
    v_mfma_f32_16x16x32_bf16 v[28:31], v[92:95], v[56:59], v[28:31]
    s_nop 7
    ds_write_b128 v17, v[20:23] offset:0
    ds_write_b128 v17, v[24:27] offset:1024
    ds_write_b128 v17, v[28:31] offset:2048
    s_waitcnt lgkmcnt(0)
    s_barrier
    s_cmp_lg_u32 s10, 0
    s_cbranch_scc1 Sn_chain_6
    v_add_u32 v17, s37, v15
    ds_read_b128 v[64:67], v17 offset:3072
    ds_read_b128 v[68:71], v17 offset:4096
    ds_read_b128 v[72:75], v17 offset:5120
    ds_read_b128 v[76:79], v17 offset:6144
    ds_read_b128 v[80:83], v17 offset:7168
    ds_read_b128 v[84:87], v17 offset:8192
    ds_read_b128 v[88:91], v17 offset:9216
    ds_read_b128 v[92:95], v17 offset:10240
    ds_read_b128 v[96:99], v17 offset:11264
    s_waitcnt lgkmcnt(6)
    v_pk_add_f32 v[20:21], v[20:21], v[64:65]
    v_pk_add_f32 v[22:23], v[22:23], v[66:67]
    v_pk_add_f32 v[24:25], v[24:25], v[68:69]
    v_pk_add_f32 v[26:27], v[26:27], v[70:71]
    v_pk_add_f32 v[28:29], v[28:29], v[72:73]
    v_pk_add_f32 v[30:31], v[30:31], v[74:75]
    s_waitcnt lgkmcnt(3)
    v_pk_add_f32 v[20:21], v[20:21], v[76:77]
    v_pk_add_f32 v[22:23], v[22:23], v[78:79]
    v_pk_add_f32 v[24:25], v[24:25], v[80:81]
    v_pk_add_f32 v[26:27], v[26:27], v[82:83]
    v_pk_add_f32 v[28:29], v[28:29], v[84:85]
    v_pk_add_f32 v[30:31], v[30:31], v[86:87]
    s_waitcnt lgkmcnt(0)
    v_pk_add_f32 v[20:21], v[20:21], v[88:89]
    v_pk_add_f32 v[22:23], v[22:23], v[90:91]
    v_pk_add_f32 v[24:25], v[24:25], v[92:93]
    v_pk_add_f32 v[26:27], v[26:27], v[94:95]
    v_pk_add_f32 v[28:29], v[28:29], v[96:97]
    v_pk_add_f32 v[30:31], v[30:31], v[98:99]
    v_cndmask_b32 v20, v61, v20, s[40:41]
    v_cndmask_b32 v21, v61, v21, s[40:41]
    v_cndmask_b32 v22, v61, v22, s[40:41]
    v_cndmask_b32 v23, v61, v23, s[40:41]
    v_max3_f32 v104, v24, v25, v26
    v_max3_f32 v105, v27, v28, v29
    v_max3_f32 v106, v30, v31, v20
    v_max3_f32 v107, v21, v22, v23
    v_max3_f32 v104, v104, v105, v106
    v_max_f32 v104, v104, v107
    v_mov_b32 v105, v104
    s_nop 1
    v_permlane16_swap_b32 v105, v104
    s_nop 1
    v_max_f32 v104, v105, v104
    v_mov_b32 v105, v104
    s_nop 1
    v_permlane32_swap_b32 v105, v104
    s_nop 1
    v_max_f32 v104, v105, v104
    v_mul_f32 v104, v62, v104
    v_mov_b32 v105, v104
    v_mov_b32 v63, v62
    v_pk_fma_f32 v[20:21], v[20:21], v[62:63], v[104:105] neg_lo:[0,0,1] neg_hi:[0,0,1]
    v_pk_fma_f32 v[22:23], v[22:23], v[62:63], v[104:105] neg_lo:[0,0,1] neg_hi:[0,0,1]
    v_pk_fma_f32 v[24:25], v[24:25], v[62:63], v[104:105] neg_lo:[0,0,1] neg_hi:[0,0,1]
    v_pk_fma_f32 v[26:27], v[26:27], v[62:63], v[104:105] neg_lo:[0,0,1] neg_hi:[0,0,1]
    v_pk_fma_f32 v[28:29], v[28:29], v[62:63], v[104:105] neg_lo:[0,0,1] neg_hi:[0,0,1]
    v_pk_fma_f32 v[30:31], v[30:31], v[62:63], v[104:105] neg_lo:[0,0,1] neg_hi:[0,0,1]
    v_exp_f32 v20, v20
    v_exp_f32 v21, v21
    v_exp_f32 v22, v22
    v_exp_f32 v23, v23
    v_exp_f32 v24, v24
    v_exp_f32 v25, v25
    v_exp_f32 v26, v26
    v_exp_f32 v27, v27
    v_exp_f32 v28, v28
    v_exp_f32 v29, v29
    v_exp_f32 v30, v30
    v_exp_f32 v31, v31
    s_nop 0
    v_pk_add_f32 v[104:105], v[20:21], v[22:23]
    v_pk_add_f32 v[106:107], v[24:25], v[26:27]
    v_pk_add_f32 v[108:109], v[28:29], v[30:31]
    v_pk_add_f32 v[104:105], v[104:105], v[106:107]
    v_pk_add_f32 v[104:105], v[104:105], v[108:109]
    v_add_f32 v104, v104, v105
    v_mov_b32 v105, v104
    s_nop 1
    v_permlane16_swap_b32 v105, v104
    s_nop 1
    v_add_f32 v104, v105, v104
    v_mov_b32 v105, v104
    s_nop 1
    v_permlane32_swap_b32 v105, v104
    s_nop 1
    v_add_f32 v104, v105, v104
    v_rcp_f32 v104, v104
    s_nop 0
    v_mov_b32 v105, v104
    v_pk_mul_f32 v[20:21], v[20:21], v[104:105]
    v_pk_mul_f32 v[22:23], v[22:23], v[104:105]
    v_pk_mul_f32 v[24:25], v[24:25], v[104:105]
    v_pk_mul_f32 v[26:27], v[26:27], v[104:105]
    v_pk_mul_f32 v[28:29], v[28:29], v[104:105]
    v_pk_mul_f32 v[30:31], v[30:31], v[104:105]
    v_cvt_pk_bf16_f32 v112, v24, v25
    v_cvt_pk_bf16_f32 v113, v26, v27
    v_cvt_pk_bf16_f32 v114, v28, v29
    v_cvt_pk_bf16_f32 v115, v30, v31
    v_cvt_pk_bf16_f32 v116, v20, v21
    v_cvt_pk_bf16_f32 v117, v22, v23
    s_nop 1
    v_mov_b32_dpp v118, v116 row_ror:8 row_mask:0xf bank_mask:0xf
    v_mov_b32_dpp v119, v117 row_ror:8 row_mask:0xf bank_mask:0xf
    v_cndmask_b32 v112, v118, v112, s[42:43]
    v_cndmask_b32 v113, v119, v113, s[42:43]
    v_cndmask_b32 v114, 0, v114, s[42:43]
    v_cndmask_b32 v115, 0, v115, s[42:43]
    s_cmp_eq_u32 s44, 1
    s_cbranch_scc1 pf_chain_9
    global_store_dwordx4 v16, v[112:115], s[34:35] sc1
    s_branch pe_chain_10
pf_chain_9:
    global_store_dwordx4 v16, v[112:115], s[34:35]
pe_chain_10:
    s_nop 1
Sn_chain_6:
    s_add_u32 s30, s30, 8192
    s_addc_u32 s31, s31, 0
    s_add_u32 s32, s32, 28672
    s_addc_u32 s33, s33, 0
    s_add_u32 s34, s34, 16384
    s_addc_u32 s35, s35, 0
    s_xor_b32 s37, s37, 12288
    s_add_u32 s36, s36, 1
    s_cmp_lt_u32 s36, 63
    s_cbranch_scc1 S_chain_5
    s_branch end_chain_1
O_chain_2:
    s_sub_u32 s3, s3, 16
    s_mul_i32 s24, s10, 112
    s_lshl_b32 s25, s3, 1
    s_add_u32 s24, s24, s25
    s_mul_i32 s24, s24, 14336
    s_add_u32 s24, s24, 0x65b3000
    s_add_u32 s76, s4, s24
    s_addc_u32 s77, s5, 0
    s_mul_i32 s26, s10, 28672
    v_add_u32 v12, s26, v9
    s_add_u32 s22, s76, 1204224
    s_addc_u32 s23, s77, 0
    global_load_dwordx4 v[64:67], v9, s[22:23] offset:0
    global_load_dwordx4 v[68:71], v9, s[22:23] offset:1024
    global_load_dwordx4 v[72:75], v9, s[22:23] offset:2048
    global_load_dwordx4 v[76:79], v9, s[22:23] offset:3072
    s_add_u32 s22, s76, 1208320
    s_addc_u32 s23, s77, 0
    global_load_dwordx4 v[80:83], v9, s[22:23] offset:0
    global_load_dwordx4 v[84:87], v9, s[22:23] offset:1024
    global_load_dwordx4 v[88:91], v9, s[22:23] offset:2048
    global_load_dwordx4 v[92:95], v9, s[22:23] offset:3072
    s_add_u32 s22, s76, 1212416
    s_addc_u32 s23, s77, 0
    global_load_dwordx4 v[96:99], v9, s[22:23] offset:0
    global_load_dwordx4 v[100:103], v9, s[22:23] offset:1024
    global_load_dwordx4 v[104:107], v9, s[22:23] offset:2048
    global_load_dwordx4 v[108:111], v9, s[22:23] offset:3072
    s_add_u32 s22, s76, 1216512
    s_addc_u32 s23, s77, 0
    global_load_dwordx4 v[112:115], v9, s[22:23] offset:0
    global_load_dwordx4 v[116:119], v9, s[22:23] offset:1024
    s_waitcnt vmcnt(0)
    ds_write_b128 v12, v[64:67] offset:0
    ds_write_b128 v12, v[68:71] offset:1024
    ds_write_b128 v12, v[72:75] offset:2048
    ds_write_b128 v12, v[76:79] offset:3072
    ds_write_b128 v12, v[80:83] offset:4096
    ds_write_b128 v12, v[84:87] offset:5120
    ds_write_b128 v12, v[88:91] offset:6144
    ds_write_b128 v12, v[92:95] offset:7168
    ds_write_b128 v12, v[96:99] offset:8192
    ds_write_b128 v12, v[100:103] offset:9216
    ds_write_b128 v12, v[104:107] offset:10240
    ds_write_b128 v12, v[108:111] offset:11264
    ds_write_b128 v12, v[112:115] offset:12288
    ds_write_b128 v12, v[116:119] offset:13312
    s_waitcnt lgkmcnt(0)
    s_add_u32 s22, s76, 1218560
    s_addc_u32 s23, s77, 0
    global_load_dwordx4 v[64:67], v9, s[22:23] offset:0
    global_load_dwordx4 v[68:71], v9, s[22:23] offset:1024
    global_load_dwordx4 v[72:75], v9, s[22:23] offset:2048
    global_load_dwordx4 v[76:79], v9, s[22:23] offset:3072
    s_add_u32 s22, s76, 1222656
    s_addc_u32 s23, s77, 0
    global_load_dwordx4 v[80:83], v9, s[22:23] offset:0
    global_load_dwordx4 v[84:87], v9, s[22:23] offset:1024
    global_load_dwordx4 v[88:91], v9, s[22:23] offset:2048
    global_load_dwordx4 v[92:95], v9, s[22:23] offset:3072
    s_add_u32 s22, s76, 1226752
    s_addc_u32 s23, s77, 0
    global_load_dwordx4 v[96:99], v9, s[22:23] offset:0
    global_load_dwordx4 v[100:103], v9, s[22:23] offset:1024
    global_load_dwordx4 v[104:107], v9, s[22:23] offset:2048
    global_load_dwordx4 v[108:111], v9, s[22:23] offset:3072
    s_add_u32 s22, s76, 1230848
    s_addc_u32 s23, s77, 0
    global_load_dwordx4 v[112:115], v9, s[22:23] offset:0
    global_load_dwordx4 v[116:119], v9, s[22:23] offset:1024
    s_waitcnt vmcnt(0)
    ds_write_b128 v12, v[64:67] offset:14336
    ds_write_b128 v12, v[68:71] offset:15360
    ds_write_b128 v12, v[72:75] offset:16384
    ds_write_b128 v12, v[76:79] offset:17408
    ds_write_b128 v12, v[80:83] offset:18432
    ds_write_b128 v12, v[84:87] offset:19456
    ds_write_b128 v12, v[88:91] offset:20480
    ds_write_b128 v12, v[92:95] offset:21504
    ds_write_b128 v12, v[96:99] offset:22528
    ds_write_b128 v12, v[100:103] offset:23552
    ds_write_b128 v12, v[104:107] offset:24576
    ds_write_b128 v12, v[108:111] offset:25600
    ds_write_b128 v12, v[112:115] offset:26624
    ds_write_b128 v12, v[116:119] offset:27648
    s_waitcnt lgkmcnt(0)
    s_add_u32 s22, s76, 0
    s_addc_u32 s23, s77, 0
    global_load_dwordx4 a[0:3], v9, s[22:23] offset:0
    global_load_dwordx4 a[4:7], v9, s[22:23] offset:1024
    global_load_dwordx4 a[8:11], v9, s[22:23] offset:2048
    global_load_dwordx4 a[12:15], v9, s[22:23] offset:3072
    s_add_u32 s22, s76, 4096
    s_addc_u32 s23, s77, 0
    global_load_dwordx4 a[16:19], v9, s[22:23] offset:0
    global_load_dwordx4 a[20:23], v9, s[22:23] offset:1024
    global_load_dwordx4 a[24:27], v9, s[22:23] offset:2048
    global_load_dwordx4 a[28:31], v9, s[22:23] offset:3072
    s_add_u32 s22, s76, 8192
    s_addc_u32 s23, s77, 0
    global_load_dwordx4 a[32:35], v9, s[22:23] offset:0
    global_load_dwordx4 a[36:39], v9, s[22:23] offset:1024
    global_load_dwordx4 a[40:43], v9, s[22:23] offset:2048
    global_load_dwordx4 a[44:47], v9, s[22:23] offset:3072
    s_add_u32 s22, s76, 12288
    s_addc_u32 s23, s77, 0
    global_load_dwordx4 a[48:51], v9, s[22:23] offset:0
    global_load_dwordx4 a[52:55], v9, s[22:23] offset:1024
    s_add_u32 s22, s76, 14336
    s_addc_u32 s23, s77, 0
    global_load_dwordx4 a[56:59], v9, s[22:23] offset:0
    global_load_dwordx4 a[60:63], v9, s[22:23] offset:1024
    global_load_dwordx4 a[64:67], v9, s[22:23] offset:2048
    global_load_dwordx4 a[68:71], v9, s[22:23] offset:3072
    s_add_u32 s22, s76, 18432
    s_addc_u32 s23, s77, 0
    global_load_dwordx4 a[72:75], v9, s[22:23] offset:0
    global_load_dwordx4 a[76:79], v9, s[22:23] offset:1024
    global_load_dwordx4 a[80:83], v9, s[22:23] offset:2048
    global_load_dwordx4 a[84:87], v9, s[22:23] offset:3072
    s_add_u32 s22, s76, 22528
    s_addc_u32 s23, s77, 0
    global_load_dwordx4 a[88:91], v9, s[22:23] offset:0
    global_load_dwordx4 a[92:95], v9, s[22:23] offset:1024
    global_load_dwordx4 a[96:99], v9, s[22:23] offset:2048
    global_load_dwordx4 a[100:103], v9, s[22:23] offset:3072
    s_add_u32 s22, s76, 26624
    s_addc_u32 s23, s77, 0
    global_load_dwordx4 a[104:107], v9, s[22:23] offset:0
    global_load_dwordx4 a[108:111], v9, s[22:23] offset:1024
    s_add_u32 s22, s76, 401408
    s_addc_u32 s23, s77, 0
    global_load_dwordx4 a[112:115], v9, s[22:23] offset:0
    global_load_dwordx4 a[116:119], v9, s[22:23] offset:1024
    global_load_dwordx4 a[120:123], v9, s[22:23] offset:2048
    global_load_dwordx4 a[124:127], v9, s[22:23] offset:3072
    s_add_u32 s22, s76, 405504
    s_addc_u32 s23, s77, 0
    global_load_dwordx4 a[128:131], v9, s[22:23] offset:0
    global_load_dwordx4 a[132:135], v9, s[22:23] offset:1024
    global_load_dwordx4 a[136:139], v9, s[22:23] offset:2048
    global_load_dwordx4 a[140:143], v9, s[22:23] offset:3072
    s_add_u32 s22, s76, 409600
    s_addc_u32 s23, s77, 0
    global_load_dwordx4 a[144:147], v9, s[22:23] offset:0
    global_load_dwordx4 a[148:151], v9, s[22:23] offset:1024
    global_load_dwordx4 a[152:155], v9, s[22:23] offset:2048
    global_load_dwordx4 a[156:159], v9, s[22:23] offset:3072
    s_add_u32 s22, s76, 413696
    s_addc_u32 s23, s77, 0
    global_load_dwordx4 a[160:163], v9, s[22:23] offset:0
    global_load_dwordx4 a[164:167], v9, s[22:23] offset:1024
    s_add_u32 s22, s76, 415744
    s_addc_u32 s23, s77, 0
    global_load_dwordx4 a[168:171], v9, s[22:23] offset:0
    global_load_dwordx4 a[172:175], v9, s[22:23] offset:1024
    global_load_dwordx4 a[176:179], v9, s[22:23] offset:2048
    global_load_dwordx4 a[180:183], v9, s[22:23] offset:3072
    s_add_u32 s22, s76, 419840
    s_addc_u32 s23, s77, 0
    global_load_dwordx4 a[184:187], v9, s[22:23] offset:0
    global_load_dwordx4 a[188:191], v9, s[22:23] offset:1024
    global_load_dwordx4 a[192:195], v9, s[22:23] offset:2048
    global_load_dwordx4 a[196:199], v9, s[22:23] offset:3072
    s_add_u32 s22, s76, 423936
    s_addc_u32 s23, s77, 0
    global_load_dwordx4 a[200:203], v9, s[22:23] offset:0
    global_load_dwordx4 a[204:207], v9, s[22:23] offset:1024
    global_load_dwordx4 a[208:211], v9, s[22:23] offset:2048
    global_load_dwordx4 a[212:215], v9, s[22:23] offset:3072
    s_add_u32 s22, s76, 428032
    s_addc_u32 s23, s77, 0
    global_load_dwordx4 a[216:219], v9, s[22:23] offset:0
    global_load_dwordx4 a[220:223], v9, s[22:23] offset:1024
    s_add_u32 s22, s76, 802816
    s_addc_u32 s23, s77, 0
    global_load_dwordx4 a[224:227], v9, s[22:23] offset:0
    global_load_dwordx4 a[228:231], v9, s[22:23] offset:1024
    global_load_dwordx4 a[232:235], v9, s[22:23] offset:2048
    global_load_dwordx4 a[236:239], v9, s[22:23] offset:3072
    s_add_u32 s22, s76, 806912
    s_addc_u32 s23, s77, 0
    global_load_dwordx4 a[240:243], v9, s[22:23] offset:0
    global_load_dwordx4 a[244:247], v9, s[22:23] offset:1024
    global_load_dwordx4 a[248:251], v9, s[22:23] offset:2048
    global_load_dwordx4 a[252:255], v9, s[22:23] offset:3072
    s_add_u32 s22, s76, 811008
    s_addc_u32 s23, s77, 0
    global_load_dwordx4 v[176:179], v9, s[22:23] offset:0
    global_load_dwordx4 v[180:183], v9, s[22:23] offset:1024
    global_load_dwordx4 v[184:187], v9, s[22:23] offset:2048
    global_load_dwordx4 v[188:191], v9, s[22:23] offset:3072
    s_add_u32 s22, s76, 815104
    s_addc_u32 s23, s77, 0
    global_load_dwordx4 v[192:195], v9, s[22:23] offset:0
    global_load_dwordx4 v[196:199], v9, s[22:23] offset:1024
    s_add_u32 s22, s76, 817152
    s_addc_u32 s23, s77, 0
    global_load_dwordx4 v[200:203], v9, s[22:23] offset:0
    global_load_dwordx4 v[204:207], v9, s[22:23] offset:1024
    global_load_dwordx4 v[208:211], v9, s[22:23] offset:2048
    global_load_dwordx4 v[212:215], v9, s[22:23] offset:3072
    s_add_u32 s22, s76, 821248
    s_addc_u32 s23, s77, 0
    global_load_dwordx4 v[216:219], v9, s[22:23] offset:0
    global_load_dwordx4 v[220:223], v9, s[22:23] offset:1024
    global_load_dwordx4 v[224:227], v9, s[22:23] offset:2048
    global_load_dwordx4 v[228:231], v9, s[22:23] offset:3072
    s_add_u32 s22, s76, 825344
    s_addc_u32 s23, s77, 0
    global_load_dwordx4 v[232:235], v9, s[22:23] offset:0
    global_load_dwordx4 v[236:239], v9, s[22:23] offset:1024
    global_load_dwordx4 v[240:243], v9, s[22:23] offset:2048
    global_load_dwordx4 v[244:247], v9, s[22:23] offset:3072
    s_add_u32 s22, s76, 829440
    s_addc_u32 s23, s77, 0
    global_load_dwordx4 v[248:251], v9, s[22:23] offset:0
    global_load_dwordx4 v[252:255], v9, s[22:23] offset:1024
    s_mul_i32 s24, s10, 112
    s_lshl_b32 s25, s3, 1
    s_add_u32 s24, s24, s25
    s_lshl_b32 s24, s24, 10
    v_add_u32 v20, s24, v9
    v_add_u32 v21, 28672, v20
    v_add_u32 v22, 28672, v21
    v_add_u32 v23, 28672, v22
    s_mul_i32 s24, s10, 56
    s_add_u32 s24, s24, s25
    s_lshl_b32 s24, s24, 9
    v_add_u32 v24, s24, v9
    v_add_u32 v25, 14336, v24
    v_lshrrev_b32 v15, 1, v3
    v_lshlrev_b32 v15, 7, v15
    v_lshl_add_u32 v15, v2, 4, v15
    v_and_b32 v14, 1, v3
    v_lshl_add_u32 v15, v14, 3, v15
    s_lshl_b32 s25, s3, 9
    s_lshl_b32 s26, s10, 8
    s_add_u32 s25, s25, s26
    v_add_u32 v15, s25, v15
    s_lshl_b32 s25, s10, 12
    v_add_u32 v16, s25, v9
    v_lshlrev_b32 v26, 4, v2
    v_lshl_add_u32 v26, v3, 7, v26
    v_add_u32 v63, 4096, v26
    v_mov_b32 v56, 0
    v_mov_b32 v57, 0
    v_mov_b32 v58, 0
    v_mov_b32 v59, 0
    v_mov_b32 v28, 0
    v_mov_b32 v29, 0
    v_mov_b32 v30, 0
    v_mov_b32 v31, 0
    v_min_u32 v60, 29, v1
    v_lshlrev_b32 v60, 2, v60
xp_chain_11:
    global_load_dword v17, v60, s[6:7] sc1
    s_add_u32 s45, s45, 1
    s_cmp_gt_u32 s45, 262144
    s_cbranch_scc1 end_chain_1
    s_waitcnt vmcnt(0)
    v_cmp_eq_u32 vcc, 0, v17
    s_nop 1
    s_cbranch_vccnz xp_chain_11
    v_cmp_ne_u32 vcc, s20, v17
    s_nop 1
    s_cmp_eq_u64 vcc, 0
    s_cselect_b32 s44, 1, 0
    s_lshl_b32 s24, s10, 11
    s_add_u32 s24, s24, 114688
    v_add_u32 v17, s24, v9
    s_lshl_b32 s24, s10, 10
    s_add_u32 s24, s24, 114688
    v_add_u32 v13, s24, v9
    s_add_u32 s30, s4, 0x4c93000
    s_addc_u32 s31, s5, 0
    s_add_u32 s32, s4, 0x3093000
    s_addc_u32 s33, s5, 0
    s_add_u32 s38, s4, 0x5193000
    s_addc_u32 s39, s5, 0
    s_add_u32 s46, s4, 0x4c95000
    s_addc_u32 s47, s5, 0
    s_add_u32 s68, s4, 0x6bd3000
    s_addc_u32 s69, s5, 0
    s_add_u32 s70, s4, 0x6bd5000
    s_addc_u32 s71, s5, 0
    s_add_u32 s74, s4, 0x6bd47fc
    s_addc_u32 s75, s5, 0
    s_add_u32 s34, s4, 0x5093000
    s_addc_u32 s35, s5, 0
    s_mov_b32 s36, 0
    s_mov_b32 s37, 0
    s_waitcnt vmcnt(0)
Ol_chain_12:
poll_chain_15:
    global_load_dwordx4 v[112:115], v5, s[30:31] sc1
    global_load_dwordx4 v[116:119], v6, s[30:31] sc1
    s_add_u32 s45, s45, 1
    s_cmp_gt_u32 s45, 262144
    s_cbranch_scc1 end_chain_1
    s_waitcnt vmcnt(0)
    v_max_u32 v60, v112, v113
    v_max3_u32 v60, v60, v114, v115
    v_max3_u32 v60, v60, v116, v117
    v_max3_u32 v60, v60, v118, v119
    v_cmp_eq_u32 vcc, -1, v60
    s_nop 1
    s_cbranch_vccnz poll_chain_15
    ds_write_b128 v8, v[112:115]
    ds_write_b128 v4, v[116:119]
    s_waitcnt lgkmcnt(0)
    s_barrier
    ds_read_b128 v[64:67], v18 offset:0
    ds_read_b128 v[68:71], v18 offset:1024
    ds_read_b128 v[72:75], v18 offset:2048
    ds_read_b128 v[76:79], v18 offset:3072
    ds_read_b128 v[80:83], v18 offset:4096
    ds_read_b128 v[84:87], v18 offset:5120
    ds_read_b128 v[88:91], v18 offset:6144
    ds_read_b128 v[92:95], v18 offset:7168
    ds_read_b128 v[96:99], v18 offset:8192
    ds_read_b128 v[100:103], v18 offset:9216
    ds_read_b128 v[104:107], v18 offset:10240
    ds_read_b128 v[108:111], v18 offset:11264
    ds_read_b128 v[112:115], v18 offset:12288
    ds_read_b128 v[116:119], v18 offset:13312
    s_cmp_eq_u32 s36, 0
    s_cbranch_scc1 z_chain_16
    s_cmp_lg_u32 s10, 3
    s_cbranch_scc1 ns_chain_17
    v_mov_b32 v60, 0
    v_mov_b32 v61, 1
    s_mov_b64 exec, 1
    global_atomic_add v60, v61, s[74:75] sc1
    s_mov_b64 exec, -1
ns_chain_17:
z_chain_16:
    s_cmp_eq_u32 s36, 63
    s_cbranch_scc1 Ou_chain_14
    s_and_b32 s24, s36, 3
    s_cmp_lg_u32 s24, 0
    s_cbranch_scc1 nf_chain_18
    s_lshl_b32 s24, s36, 4
    v_mov_b32 v60, s24
fp_chain_19:
    global_load_dword v61, v60, s[68:69] sc1
    s_add_u32 s45, s45, 1
    s_cmp_gt_u32 s45, 262144
    s_cbranch_scc1 end_chain_1
    s_waitcnt vmcnt(0)
    v_cmp_gt_u32 vcc, 56, v61
    s_nop 1
    s_cbranch_vccnz fp_chain_19
nf_chain_18:
    global_load_dwordx4 v[120:123], v20, s[32:33] offset:0 sc1
    global_load_dwordx4 v[124:127], v20, s[32:33] offset:1024 sc1
    global_load_dwordx4 v[128:131], v21, s[32:33] offset:0 sc1
    global_load_dwordx4 v[132:135], v21, s[32:33] offset:1024 sc1
    global_load_dwordx4 v[136:139], v22, s[32:33] offset:0 sc1
    global_load_dwordx4 v[140:143], v22, s[32:33] offset:1024 sc1
    global_load_dwordx4 v[144:147], v23, s[32:33] offset:0 sc1
    global_load_dwordx4 v[148:151], v23, s[32:33] offset:1024 sc1
Ou_chain_14:
    s_waitcnt lgkmcnt(13)
    v_mfma_f32_16x16x32_bf16 v[168:171], v[64:67], a[0:3], 0
    s_waitcnt lgkmcnt(12)
    v_mfma_f32_16x16x32_bf16 v[168:171], v[68:71], a[4:7], v[168:171]
    s_waitcnt lgkmcnt(11)
    v_mfma_f32_16x16x32_bf16 v[168:171], v[72:75], a[8:11], v[168:171]
    s_waitcnt lgkmcnt(10)
    v_mfma_f32_16x16x32_bf16 v[168:171], v[76:79], a[12:15], v[168:171]
    s_waitcnt lgkmcnt(9)
    v_mfma_f32_16x16x32_bf16 v[168:171], v[80:83], a[16:19], v[168:171]
    s_waitcnt lgkmcnt(8)
    v_mfma_f32_16x16x32_bf16 v[168:171], v[84:87], a[20:23], v[168:171]
    s_waitcnt lgkmcnt(7)
    v_mfma_f32_16x16x32_bf16 v[168:171], v[88:91], a[24:27], v[168:171]
    s_waitcnt lgkmcnt(6)
    v_mfma_f32_16x16x32_bf16 v[168:171], v[92:95], a[28:31], v[168:171]
    s_waitcnt lgkmcnt(5)
    v_mfma_f32_16x16x32_bf16 v[168:171], v[96:99], a[32:35], v[168:171]
    s_waitcnt lgkmcnt(4)
    v_mfma_f32_16x16x32_bf16 v[168:171], v[100:103], a[36:39], v[168:171]
    s_waitcnt lgkmcnt(3)
    v_mfma_f32_16x16x32_bf16 v[168:171], v[104:107], a[40:43], v[168:171]
    s_waitcnt lgkmcnt(2)
    v_mfma_f32_16x16x32_bf16 v[168:171], v[108:111], a[44:47], v[168:171]
    s_waitcnt lgkmcnt(1)
    v_mfma_f32_16x16x32_bf16 v[168:171], v[112:115], a[48:51], v[168:171]
    s_waitcnt lgkmcnt(0)
    v_mfma_f32_16x16x32_bf16 v[168:171], v[116:119], a[52:55], v[168:171]
    s_cmp_lg_u32 s10, 3
    s_cbranch_scc1 m2_chain_20
    s_cmp_lg_u32 s3, 0
    s_cbranch_scc1 m2_chain_20
    s_mov_b64 exec, s[42:43]
    global_store_dwordx4 v26, v[64:67], s[70:71] offset:0 sc1
    global_store_dwordx4 v26, v[68:71], s[70:71] offset:512 sc1
    global_store_dwordx4 v26, v[72:75], s[70:71] offset:1024 sc1
    global_store_dwordx4 v26, v[76:79], s[70:71] offset:1536 sc1
    global_store_dwordx4 v26, v[80:83], s[70:71] offset:2048 sc1
    global_store_dwordx4 v26, v[84:87], s[70:71] offset:2560 sc1
    global_store_dwordx4 v26, v[88:91], s[70:71] offset:3072 sc1
    global_store_dwordx4 v26, v[92:95], s[70:71] offset:3584 sc1
    global_store_dwordx4 v63, v[96:99], s[70:71] offset:0 sc1
    global_store_dwordx4 v63, v[100:103], s[70:71] offset:512 sc1
    global_store_dwordx4 v63, v[104:107], s[70:71] offset:1024 sc1
    global_store_dwordx4 v63, v[108:111], s[70:71] offset:1536 sc1
    global_store_dwordx4 v63, v[112:115], s[70:71] offset:2048 sc1
    global_store_dwordx4 v63, v[116:119], s[70:71] offset:2560 sc1
    s_mov_b64 exec, -1
m2_chain_20:
    v_mfma_f32_16x16x32_bf16 v[172:175], v[64:67], a[56:59], 0
    v_mfma_f32_16x16x32_bf16 v[172:175], v[68:71], a[60:63], v[172:175]
    v_mfma_f32_16x16x32_bf16 v[172:175], v[72:75], a[64:67], v[172:175]
    v_mfma_f32_16x16x32_bf16 v[172:175], v[76:79], a[68:71], v[172:175]
    v_mfma_f32_16x16x32_bf16 v[172:175], v[80:83], a[72:75], v[172:175]
    v_mfma_f32_16x16x32_bf16 v[172:175], v[84:87], a[76:79], v[172:175]
    v_mfma_f32_16x16x32_bf16 v[172:175], v[88:91], a[80:83], v[172:175]
    v_mfma_f32_16x16x32_bf16 v[172:175], v[92:95], a[84:87], v[172:175]
    v_mfma_f32_16x16x32_bf16 v[172:175], v[96:99], a[88:91], v[172:175]
    v_mfma_f32_16x16x32_bf16 v[172:175], v[100:103], a[92:95], v[172:175]
    v_mfma_f32_16x16x32_bf16 v[172:175], v[104:107], a[96:99], v[172:175]
    v_cvt_pk_bf16_f32 v152, v168, v169
    v_cvt_pk_bf16_f32 v153, v170, v171
    v_mfma_f32_16x16x32_bf16 v[172:175], v[108:111], a[100:103], v[172:175]
    v_mfma_f32_16x16x32_bf16 v[172:175], v[112:115], a[104:107], v[172:175]
    v_mfma_f32_16x16x32_bf16 v[172:175], v[116:119], a[108:111], v[172:175]
    v_mfma_f32_16x16x32_bf16 v[168:171], v[64:67], a[112:115], 0
    v_mfma_f32_16x16x32_bf16 v[168:171], v[68:71], a[116:119], v[168:171]
    v_mfma_f32_16x16x32_bf16 v[168:171], v[72:75], a[120:123], v[168:171]
    v_mfma_f32_16x16x32_bf16 v[168:171], v[76:79], a[124:127], v[168:171]
    v_mfma_f32_16x16x32_bf16 v[168:171], v[80:83], a[128:131], v[168:171]
    v_mfma_f32_16x16x32_bf16 v[168:171], v[84:87], a[132:135], v[168:171]
    v_mfma_f32_16x16x32_bf16 v[168:171], v[88:91], a[136:139], v[168:171]
    v_mfma_f32_16x16x32_bf16 v[168:171], v[92:95], a[140:143], v[168:171]
    v_mfma_f32_16x16x32_bf16 v[168:171], v[96:99], a[144:147], v[168:171]
    v_mfma_f32_16x16x32_bf16 v[168:171], v[100:103], a[148:151], v[168:171]
    v_mfma_f32_16x16x32_bf16 v[168:171], v[104:107], a[152:155], v[168:171]
    v_cvt_pk_bf16_f32 v156, v172, v173
    v_cvt_pk_bf16_f32 v157, v174, v175
    v_mfma_f32_16x16x32_bf16 v[168:171], v[108:111], a[156:159], v[168:171]
    v_mfma_f32_16x16x32_bf16 v[168:171], v[112:115], a[160:163], v[168:171]
    v_mfma_f32_16x16x32_bf16 v[168:171], v[116:119], a[164:167], v[168:171]
    v_mfma_f32_16x16x32_bf16 v[172:175], v[64:67], a[168:171], 0
    v_mfma_f32_16x16x32_bf16 v[172:175], v[68:71], a[172:175], v[172:175]
    v_mfma_f32_16x16x32_bf16 v[172:175], v[72:75], a[176:179], v[172:175]
    v_mfma_f32_16x16x32_bf16 v[172:175], v[76:79], a[180:183], v[172:175]
    v_mfma_f32_16x16x32_bf16 v[172:175], v[80:83], a[184:187], v[172:175]
    v_mfma_f32_16x16x32_bf16 v[172:175], v[84:87], a[188:191], v[172:175]
    v_mfma_f32_16x16x32_bf16 v[172:175], v[88:91], a[192:195], v[172:175]
    v_mfma_f32_16x16x32_bf16 v[172:175], v[92:95], a[196:199], v[172:175]
    v_mfma_f32_16x16x32_bf16 v[172:175], v[96:99], a[200:203], v[172:175]
    v_mfma_f32_16x16x32_bf16 v[172:175], v[100:103], a[204:207], v[172:175]
    v_mfma_f32_16x16x32_bf16 v[172:175], v[104:107], a[208:211], v[172:175]
    v_cvt_pk_bf16_f32 v154, v168, v169
    v_cvt_pk_bf16_f32 v155, v170, v171
    s_mov_b64 exec, s[40:41]
    global_store_dwordx4 v24, v[152:155], s[38:39] offset:0 sc1
    s_mov_b64 exec, -1
    v_mfma_f32_16x16x32_bf16 v[172:175], v[108:111], a[212:215], v[172:175]
    v_mfma_f32_16x16x32_bf16 v[172:175], v[112:115], a[216:219], v[172:175]
    v_mfma_f32_16x16x32_bf16 v[172:175], v[116:119], a[220:223], v[172:175]
    v_mfma_f32_16x16x32_bf16 v[168:171], v[64:67], a[224:227], 0
    v_mfma_f32_16x16x32_bf16 v[168:171], v[68:71], a[228:231], v[168:171]
    v_mfma_f32_16x16x32_bf16 v[168:171], v[72:75], a[232:235], v[168:171]
    v_mfma_f32_16x16x32_bf16 v[168:171], v[76:79], a[236:239], v[168:171]
    v_mfma_f32_16x16x32_bf16 v[168:171], v[80:83], a[240:243], v[168:171]
    v_mfma_f32_16x16x32_bf16 v[168:171], v[84:87], a[244:247], v[168:171]
    v_mfma_f32_16x16x32_bf16 v[168:171], v[88:91], a[248:251], v[168:171]
    v_mfma_f32_16x16x32_bf16 v[168:171], v[92:95], a[252:255], v[168:171]
    v_mfma_f32_16x16x32_bf16 v[168:171], v[96:99], v[176:179], v[168:171]
    v_mfma_f32_16x16x32_bf16 v[168:171], v[100:103], v[180:183], v[168:171]
    v_mfma_f32_16x16x32_bf16 v[168:171], v[104:107], v[184:187], v[168:171]
    v_cvt_pk_bf16_f32 v158, v172, v173
    v_cvt_pk_bf16_f32 v159, v174, v175
    s_mov_b64 exec, s[40:41]
    global_store_dwordx4 v24, v[156:159], s[38:39] offset:512 sc1
    s_mov_b64 exec, -1
    v_mfma_f32_16x16x32_bf16 v[168:171], v[108:111], v[188:191], v[168:171]
    v_mfma_f32_16x16x32_bf16 v[168:171], v[112:115], v[192:195], v[168:171]
    v_mfma_f32_16x16x32_bf16 v[168:171], v[116:119], v[196:199], v[168:171]
    v_mfma_f32_16x16x32_bf16 v[172:175], v[64:67], v[200:203], 0
    v_mfma_f32_16x16x32_bf16 v[172:175], v[68:71], v[204:207], v[172:175]
    v_mfma_f32_16x16x32_bf16 v[172:175], v[72:75], v[208:211], v[172:175]
    v_mfma_f32_16x16x32_bf16 v[172:175], v[76:79], v[212:215], v[172:175]
    v_mfma_f32_16x16x32_bf16 v[172:175], v[80:83], v[216:219], v[172:175]
    v_mfma_f32_16x16x32_bf16 v[172:175], v[84:87], v[220:223], v[172:175]
    v_mfma_f32_16x16x32_bf16 v[172:175], v[88:91], v[224:227], v[172:175]
    v_mfma_f32_16x16x32_bf16 v[172:175], v[92:95], v[228:231], v[172:175]
    v_mfma_f32_16x16x32_bf16 v[172:175], v[96:99], v[232:235], v[172:175]
    v_mfma_f32_16x16x32_bf16 v[172:175], v[100:103], v[236:239], v[172:175]
    v_mfma_f32_16x16x32_bf16 v[172:175], v[104:107], v[240:243], v[172:175]
    v_cvt_pk_bf16_f32 v160, v168, v169
    v_cvt_pk_bf16_f32 v161, v170, v171
    v_mfma_f32_16x16x32_bf16 v[172:175], v[108:111], v[244:247], v[172:175]
    v_mfma_f32_16x16x32_bf16 v[172:175], v[112:115], v[248:251], v[172:175]
    v_mfma_f32_16x16x32_bf16 v[172:175], v[116:119], v[252:255], v[172:175]
    ds_read_b128 v[40:43], v12 offset:0
    ds_read_b128 v[44:47], v12 offset:1024
    ds_read_b128 v[48:51], v12 offset:2048
    ds_read_b128 v[52:55], v12 offset:3072
    s_waitcnt lgkmcnt(3)
    v_mfma_f32_16x16x32_bf16 v[168:171], v[64:67], v[40:43], 0
    ds_read_b128 v[40:43], v12 offset:4096
    s_waitcnt lgkmcnt(3)
    v_mfma_f32_16x16x32_bf16 v[168:171], v[68:71], v[44:47], v[168:171]
    ds_read_b128 v[44:47], v12 offset:5120
    s_waitcnt lgkmcnt(3)
    v_mfma_f32_16x16x32_bf16 v[168:171], v[72:75], v[48:51], v[168:171]
    ds_read_b128 v[48:51], v12 offset:6144
    s_waitcnt lgkmcnt(3)
    v_mfma_f32_16x16x32_bf16 v[168:171], v[76:79], v[52:55], v[168:171]
    ds_read_b128 v[52:55], v12 offset:7168
    s_waitcnt lgkmcnt(3)
    v_mfma_f32_16x16x32_bf16 v[168:171], v[80:83], v[40:43], v[168:171]
    ds_read_b128 v[40:43], v12 offset:8192
    s_waitcnt lgkmcnt(3)
    v_mfma_f32_16x16x32_bf16 v[168:171], v[84:87], v[44:47], v[168:171]
    ds_read_b128 v[44:47], v12 offset:9216
    s_waitcnt lgkmcnt(3)
    v_mfma_f32_16x16x32_bf16 v[168:171], v[88:91], v[48:51], v[168:171]
    ds_read_b128 v[48:51], v12 offset:10240
    s_waitcnt lgkmcnt(3)
    v_mfma_f32_16x16x32_bf16 v[168:171], v[92:95], v[52:55], v[168:171]
    ds_read_b128 v[52:55], v12 offset:11264
    s_waitcnt lgkmcnt(3)
    v_mfma_f32_16x16x32_bf16 v[168:171], v[96:99], v[40:43], v[168:171]
    ds_read_b128 v[40:43], v12 offset:12288
    s_waitcnt lgkmcnt(3)
    v_mfma_f32_16x16x32_bf16 v[168:171], v[100:103], v[44:47], v[168:171]
    ds_read_b128 v[44:47], v12 offset:13312
    s_waitcnt lgkmcnt(3)
    v_mfma_f32_16x16x32_bf16 v[168:171], v[104:107], v[48:51], v[168:171]
    v_cvt_pk_bf16_f32 v164, v172, v173
    v_cvt_pk_bf16_f32 v165, v174, v175
    s_waitcnt lgkmcnt(2)
    v_mfma_f32_16x16x32_bf16 v[168:171], v[108:111], v[52:55], v[168:171]
    s_waitcnt lgkmcnt(1)
    v_mfma_f32_16x16x32_bf16 v[168:171], v[112:115], v[40:43], v[168:171]
    s_waitcnt lgkmcnt(0)
    v_mfma_f32_16x16x32_bf16 v[168:171], v[116:119], v[44:47], v[168:171]
    ds_read_b128 v[40:43], v12 offset:14336
    ds_read_b128 v[44:47], v12 offset:15360
    ds_read_b128 v[48:51], v12 offset:16384
    ds_read_b128 v[52:55], v12 offset:17408
    s_waitcnt lgkmcnt(3)
    v_mfma_f32_16x16x32_bf16 v[172:175], v[64:67], v[40:43], 0
    ds_read_b128 v[40:43], v12 offset:18432
    s_waitcnt lgkmcnt(3)
    v_mfma_f32_16x16x32_bf16 v[172:175], v[68:71], v[44:47], v[172:175]
    ds_read_b128 v[44:47], v12 offset:19456
    s_waitcnt lgkmcnt(3)
    v_mfma_f32_16x16x32_bf16 v[172:175], v[72:75], v[48:51], v[172:175]
    ds_read_b128 v[48:51], v12 offset:20480
    s_waitcnt lgkmcnt(3)
    v_mfma_f32_16x16x32_bf16 v[172:175], v[76:79], v[52:55], v[172:175]
    ds_read_b128 v[52:55], v12 offset:21504
    s_waitcnt lgkmcnt(3)
    v_mfma_f32_16x16x32_bf16 v[172:175], v[80:83], v[40:43], v[172:175]
    ds_read_b128 v[40:43], v12 offset:22528
    s_waitcnt lgkmcnt(3)
    v_mfma_f32_16x16x32_bf16 v[172:175], v[84:87], v[44:47], v[172:175]
    ds_read_b128 v[44:47], v12 offset:23552
    s_waitcnt lgkmcnt(3)
    v_mfma_f32_16x16x32_bf16 v[172:175], v[88:91], v[48:51], v[172:175]
    ds_read_b128 v[48:51], v12 offset:24576
    s_waitcnt lgkmcnt(3)
    v_mfma_f32_16x16x32_bf16 v[172:175], v[92:95], v[52:55], v[172:175]
    ds_read_b128 v[52:55], v12 offset:25600
    s_waitcnt lgkmcnt(3)
    v_mfma_f32_16x16x32_bf16 v[172:175], v[96:99], v[40:43], v[172:175]
    ds_read_b128 v[40:43], v12 offset:26624
    s_waitcnt lgkmcnt(3)
    v_mfma_f32_16x16x32_bf16 v[172:175], v[100:103], v[44:47], v[172:175]
    ds_read_b128 v[44:47], v12 offset:27648
    s_waitcnt lgkmcnt(3)
    v_mfma_f32_16x16x32_bf16 v[172:175], v[104:107], v[48:51], v[172:175]
    v_cvt_pk_bf16_f32 v162, v168, v169
    v_cvt_pk_bf16_f32 v163, v170, v171
    s_mov_b64 exec, s[40:41]
    global_store_dwordx4 v25, v[160:163], s[38:39] offset:0 sc1
    s_mov_b64 exec, -1
    s_waitcnt lgkmcnt(2)
    v_mfma_f32_16x16x32_bf16 v[172:175], v[108:111], v[52:55], v[172:175]
    s_waitcnt lgkmcnt(1)
    v_mfma_f32_16x16x32_bf16 v[172:175], v[112:115], v[40:43], v[172:175]
    s_waitcnt lgkmcnt(0)
    v_mfma_f32_16x16x32_bf16 v[172:175], v[116:119], v[44:47], v[172:175]
    s_nop 9
    v_cvt_pk_bf16_f32 v166, v172, v173
    v_cvt_pk_bf16_f32 v167, v174, v175
    s_mov_b64 exec, s[40:41]
    global_store_dwordx4 v25, v[164:167], s[38:39] offset:512 sc1
    s_mov_b64 exec, -1
    s_cmp_lg_u32 s36, 63
    s_cbranch_scc1 go_chain_21
    s_waitcnt vmcnt(0)
    s_barrier
    s_add_u32 s74, s74, 4
    s_addc_u32 s75, s75, 0
    s_cmp_lg_u32 s10, 3
    s_cbranch_scc1 ns_chain_22
    v_mov_b32 v60, 0
    v_mov_b32 v61, 1
    s_mov_b64 exec, 1
    global_atomic_add v60, v61, s[74:75] sc1
    s_mov_b64 exec, -1
ns_chain_22:
    s_add_u32 s91, s3, 224
    s_branch end_chain_1
go_chain_21:
    v_add_u32 v14, s37, v17
    v_add_u32 v27, s37, v13
poll_chain_23:
    global_load_dwordx4 v[64:67], v16, s[34:35] offset:0 sc1
    global_load_dwordx4 v[68:71], v16, s[34:35] offset:1024 sc1
    global_load_dwordx4 v[72:75], v16, s[34:35] offset:2048 sc1
    global_load_dwordx4 v[76:79], v16, s[34:35] offset:3072 sc1
    s_add_u32 s45, s45, 1
    s_cmp_gt_u32 s45, 262144
    s_cbranch_scc1 end_chain_1
    s_waitcnt vmcnt(0)
    v_max_u32 v60, v64, v65
    v_max3_u32 v60, v60, v66, v67
    v_max3_u32 v60, v60, v68, v69
    v_max3_u32 v60, v60, v70, v71
    v_max3_u32 v60, v60, v72, v73
    v_max3_u32 v60, v60, v74, v75
    v_max3_u32 v60, v60, v76, v77
    v_max3_u32 v60, v60, v78, v79
    v_cmp_eq_u32 vcc, -1, v60
    s_nop 1
    s_cbranch_vccnz poll_chain_23
    v_mov_b32_dpp v56, v64 row_ror:8 row_mask:0xf bank_mask:0xf
    v_mov_b32_dpp v57, v65 row_ror:8 row_mask:0xf bank_mask:0xf
    v_mov_b32_dpp v58, v68 row_ror:8 row_mask:0xf bank_mask:0xf
    v_mov_b32_dpp v59, v69 row_ror:8 row_mask:0xf bank_mask:0xf
    v_mov_b32_dpp v28, v72 row_ror:8 row_mask:0xf bank_mask:0xf
    v_mov_b32_dpp v29, v73 row_ror:8 row_mask:0xf bank_mask:0xf
    v_mov_b32_dpp v30, v76 row_ror:8 row_mask:0xf bank_mask:0xf
    v_mov_b32_dpp v31, v77 row_ror:8 row_mask:0xf bank_mask:0xf
    v_mfma_f32_16x16x32_bf16 v[32:35], v[120:123], v[64:67], 0
    v_mfma_f32_16x16x32_bf16 v[36:39], v[124:127], v[64:67], 0
    v_mfma_f32_16x16x32_bf16 v[32:35], v[128:131], v[68:71], v[32:35]
    v_mfma_f32_16x16x32_bf16 v[36:39], v[132:135], v[68:71], v[36:39]
    v_mfma_f32_16x16x32_bf16 v[32:35], v[136:139], v[72:75], v[32:35]
    v_mfma_f32_16x16x32_bf16 v[36:39], v[140:143], v[72:75], v[36:39]
    v_mfma_f32_16x16x32_bf16 v[32:35], v[144:147], v[76:79], v[32:35]
    v_mfma_f32_16x16x32_bf16 v[36:39], v[148:151], v[76:79], v[36:39]
    v_mfma_f32_16x16x32_bf16 v[32:35], v[152:155], v[56:59], v[32:35]
    v_mfma_f32_16x16x32_bf16 v[36:39], v[156:159], v[56:59], v[36:39]
    v_mfma_f32_16x16x32_bf16 v[32:35], v[160:163], v[28:31], v[32:35]
    v_mfma_f32_16x16x32_bf16 v[36:39], v[164:167], v[28:31], v[36:39]
    s_nop 7
    ds_write_b128 v14, v[32:35]
    ds_write_b128 v14, v[36:39] offset:1024
    s_waitcnt lgkmcnt(0)
    s_barrier
    s_cmp_ge_u32 s10, 2
    s_cbranch_scc1 On_chain_13
    ds_read_b128 v[40:43], v27 offset:0
    ds_read_b128 v[44:47], v27 offset:2048
    ds_read_b128 v[48:51], v27 offset:4096
    ds_read_b128 v[52:55], v27 offset:6144
    s_waitcnt lgkmcnt(2)
    v_pk_add_f32 v[40:41], v[40:41], v[44:45]
    v_pk_add_f32 v[42:43], v[42:43], v[46:47]
    s_waitcnt lgkmcnt(0)
    v_pk_add_f32 v[48:49], v[48:49], v[52:53]
    v_pk_add_f32 v[50:51], v[50:51], v[54:55]
    v_pk_add_f32 v[40:41], v[40:41], v[48:49]
    v_pk_add_f32 v[42:43], v[42:43], v[50:51]
    v_cvt_pk_bf16_f32 v44, v40, v41
    v_cvt_pk_bf16_f32 v45, v42, v43
    s_mov_b64 exec, s[42:43]
    s_cmp_eq_u32 s44, 1
    s_cbranch_scc1 pf_chain_24
    global_store_dwordx2 v15, v[44:45], s[46:47] sc1
    s_branch pe_chain_25
pf_chain_24:
    global_store_dwordx2 v15, v[44:45], s[46:47]
pe_chain_25:
    s_mov_b64 exec, -1
On_chain_13:
    s_add_u32 s30, s30, 8192
    s_addc_u32 s31, s31, 0
    s_add_u32 s46, s46, 8192
    s_addc_u32 s47, s47, 0
    s_add_u32 s70, s70, 8192
    s_addc_u32 s71, s71, 0
    s_add_u32 s74, s74, 4
    s_addc_u32 s75, s75, 0
    s_add_u32 s32, s32, 458752
    s_addc_u32 s33, s33, 0
    s_add_u32 s34, s34, 16384
    s_addc_u32 s35, s35, 0
    s_add_u32 s38, s38, 114688
    s_addc_u32 s39, s39, 0
    s_xor_b32 s37, s37, 8192
    s_add_u32 s36, s36, 1
    s_branch Ol_chain_12
pf_chain_4:
    s_load_dwordx2 s[4:5], s[0:1], 128
    v_lshrrev_b32 v2, 6, v0
    s_nop 0
    v_readfirstlane_b32 s10, v2
    s_mov_b32 s92, 0
    s_mov_b32 s36, 0
    s_waitcnt lgkmcnt(0)
    s_add_u32 s66, s4, 0x3093000
    s_addc_u32 s67, s5, 0
    s_add_u32 s68, s4, 0x4d13000
    s_addc_u32 s69, s5, 0
    s_add_u32 s30, s4, 0x4c93000
    s_addc_u32 s31, s5, 0
pl_chain_26:
    s_and_b32 s24, s36, 3
    s_cmp_lg_u32 s24, 0
    s_cbranch_scc1 nw_chain_27
    s_lshl_b32 s62, s36, 4
    s_cmp_lg_u32 s10, 0
    s_cbranch_scc1 wo_chain_32
    s_add_u32 s94, s4, 0x6bd3000
    s_addc_u32 s95, s5, 0
    v_mov_b32 v10, s62
wc_chain_30:
    global_load_dword v11, v10, s[94:95] sc1
    s_add_u32 s92, s92, 1
    s_cmp_gt_u32 s92, 524288
    s_cbranch_scc1 wd_chain_31
    s_waitcnt vmcnt(0)
    v_cmp_gt_u32 vcc, 56, v11
    s_nop 1
    s_cbranch_vccz wd_chain_31
    s_sleep 2
    s_branch wc_chain_30
wd_chain_31:
wo_chain_32:
    s_barrier
nw_chain_27:
    s_mul_i32 s64, s36, 458752
    v_and_b32 v10, 63, v0
    v_lshlrev_b32 v10, 7, v10
    s_mul_i32 s93, s10, 114688
    s_add_u32 s93, s93, s64
    v_add_u32 v10, s93, v10
    global_load_dword v255, v10, s[66:67]
    v_add_u32 v10, 8192, v10
    global_load_dword v255, v10, s[66:67]
    v_add_u32 v10, 8192, v10
    global_load_dword v255, v10, s[66:67]
    v_add_u32 v10, 8192, v10
    global_load_dword v255, v10, s[66:67]
    v_add_u32 v10, 8192, v10
    global_load_dword v255, v10, s[66:67]
    v_add_u32 v10, 8192, v10
    global_load_dword v255, v10, s[66:67]
    v_add_u32 v10, 8192, v10
    global_load_dword v255, v10, s[66:67]
    v_add_u32 v10, 8192, v10
    global_load_dword v255, v10, s[66:67]
    v_add_u32 v10, 8192, v10
    global_load_dword v255, v10, s[66:67]
    v_add_u32 v10, 8192, v10
    global_load_dword v255, v10, s[66:67]
    v_add_u32 v10, 8192, v10
    global_load_dword v255, v10, s[66:67]
    v_add_u32 v10, 8192, v10
    global_load_dword v255, v10, s[66:67]
    v_add_u32 v10, 8192, v10
    global_load_dword v255, v10, s[66:67]
    v_add_u32 v10, 8192, v10
    global_load_dword v255, v10, s[66:67]
    s_mul_i32 s64, s36, 28672
    v_and_b32 v10, 63, v0
    v_lshlrev_b32 v10, 7, v10
    s_mul_i32 s93, s10, 7168
    s_add_u32 s93, s93, s64
    v_add_u32 v10, s93, v10
    v_and_b32 v11, 63, v0
    v_cmp_gt_u32 vcc, 56, v11
    s_and_saveexec_b64 s[88:89], vcc
    global_load_dword v255, v10, s[68:69]
    s_mov_b64 exec, s[88:89]
    s_cmp_lt_u32 s36, 2
    s_cbranch_scc1 npc_chain_28
    s_sub_u32 s24, s36, 1
    s_lshl_b32 s24, s24, 13
    v_mov_b32 v10, s24
pp_chain_29:
    global_load_dword v11, v10, s[30:31] sc1
    s_add_u32 s92, s92, 1
    s_cmp_gt_u32 s92, 262144
    s_cbranch_scc1 end_chain_1
    s_waitcnt vmcnt(0)
    v_cmp_eq_u32 vcc, -1, v11
    s_nop 1
    s_cbranch_vccz npc_chain_28
    s_sleep 8
    s_branch pp_chain_29
npc_chain_28:
    s_add_u32 s36, s36, 1
    s_cmp_lt_u32 s36, 63
    s_cbranch_scc1 pl_chain_26
    s_branch end_chain_1
wk_chain_3:
    s_cmp_ge_u32 s2, 256
    s_cbranch_scc1 end_chain_1
    s_lshr_b32 s3, s2, 3
    s_sub_u32 s90, s2, s3
    s_sub_u32 s90, s90, 1
    s_mov_b32 s91, s90
    s_mov_b32 s92, 0
    s_load_dwordx2 s[4:5], s[0:1], 128
    s_waitcnt lgkmcnt(0)
    s_sub_u32 s90, s91, 0
    s_cmp_ge_u32 s90, 224
    s_cbranch_scc1 sk_chain_34
wl_chain_33:
    s_mov_b32 s2, s90
    s_cmp_ge_u32 s2, 896
    s_cbranch_scc1 end_g4_1
    s_load_dwordx2 s[4:5], s[0:1], 128
    s_mov_b32 s20, 0
    s_mov_b32 s21, s2
    s_mul_i32 s23, s21, 1171
    s_lshr_b32 s23, s23, 16
    s_mul_i32 s22, s23, 56
    s_sub_u32 s22, s21, s22
    v_and_b32 v1, 63, v0
    v_lshrrev_b32 v2, 6, v0
    s_nop 0
    v_readfirstlane_b32 s24, v2
    s_waitcnt lgkmcnt(0)
    s_add_u32 s6, s4, 0xe73000
    s_addc_u32 s7, s5, 0
    s_add_u32 s8, s4, 0x3000
    s_addc_u32 s9, s5, 0
    s_add_u32 s10, s4, 0x3093000
    s_addc_u32 s11, s5, 0
    s_lshr_b32 s25, s24, 1
    s_and_b32 s26, s24, 1
    v_lshrrev_b32 v2, 3, v0
    v_and_b32 v3, 7, v0
    v_lshlrev_b32 v3, 4, v3
    s_mul_i32 s27, s22, 128
    s_mul_i32 s28, s23, 128
    s_mov_b32 s29, 896
    s_mov_b32 s30, 896
    v_add_u32 v4, s27, v2
    v_mul_lo_u32 v4, v4, s29
    v_add_u32 v8, v4, v3
    v_add_u32 v9, 28672, v8
    v_add_u32 v10, 28672, v9
    v_add_u32 v11, 28672, v10
    v_add_u32 v4, s28, v2
    v_mul_lo_u32 v4, v4, s30
    v_add_u32 v12, v4, v3
    v_add_u32 v13, 28672, v12
    v_add_u32 v14, 28672, v13
    v_add_u32 v15, 28672, v14
    v_mul_u32_u24 v4, 144, v2
    v_add_u32 v16, v4, v3
    v_add_u32 v17, 18432, v16
    v_and_b32 v4, 31, v1
    v_lshrrev_b32 v5, 5, v1
    v_lshlrev_b32 v5, 4, v5
    s_mul_i32 s31, s25, 64
    v_add_u32 v6, s31, v4
    v_mul_u32_u24 v6, 144, v6
    v_add_u32 v18, v6, v5
    s_mul_i32 s31, s26, 64
    v_add_u32 v6, s31, v4
    v_mul_u32_u24 v6, 144, v6
    v_add_u32 v6, v6, v5
    v_add_u32 v19, 18432, v6
    v_accvgpr_write_b32 a0, 0
    v_accvgpr_write_b32 a1, 0
    v_accvgpr_write_b32 a2, 0
    v_accvgpr_write_b32 a3, 0
    v_accvgpr_write_b32 a4, 0
    v_accvgpr_write_b32 a5, 0
    v_accvgpr_write_b32 a6, 0
    v_accvgpr_write_b32 a7, 0
    v_accvgpr_write_b32 a8, 0
    v_accvgpr_write_b32 a9, 0
    v_accvgpr_write_b32 a10, 0
    v_accvgpr_write_b32 a11, 0
    v_accvgpr_write_b32 a12, 0
    v_accvgpr_write_b32 a13, 0
    v_accvgpr_write_b32 a14, 0
    v_accvgpr_write_b32 a15, 0
    v_accvgpr_write_b32 a16, 0
    v_accvgpr_write_b32 a17, 0
    v_accvgpr_write_b32 a18, 0
    v_accvgpr_write_b32 a19, 0
    v_accvgpr_write_b32 a20, 0
    v_accvgpr_write_b32 a21, 0
    v_accvgpr_write_b32 a22, 0
    v_accvgpr_write_b32 a23, 0
    v_accvgpr_write_b32 a24, 0
    v_accvgpr_write_b32 a25, 0
    v_accvgpr_write_b32 a26, 0
    v_accvgpr_write_b32 a27, 0
    v_accvgpr_write_b32 a28, 0
    v_accvgpr_write_b32 a29, 0
    v_accvgpr_write_b32 a30, 0
    v_accvgpr_write_b32 a31, 0
    v_accvgpr_write_b32 a32, 0
    v_accvgpr_write_b32 a33, 0
    v_accvgpr_write_b32 a34, 0
    v_accvgpr_write_b32 a35, 0
    v_accvgpr_write_b32 a36, 0
    v_accvgpr_write_b32 a37, 0
    v_accvgpr_write_b32 a38, 0
    v_accvgpr_write_b32 a39, 0
    v_accvgpr_write_b32 a40, 0
    v_accvgpr_write_b32 a41, 0
    v_accvgpr_write_b32 a42, 0
    v_accvgpr_write_b32 a43, 0
    v_accvgpr_write_b32 a44, 0
    v_accvgpr_write_b32 a45, 0
    v_accvgpr_write_b32 a46, 0
    v_accvgpr_write_b32 a47, 0
    v_accvgpr_write_b32 a48, 0
    v_accvgpr_write_b32 a49, 0
    v_accvgpr_write_b32 a50, 0
    v_accvgpr_write_b32 a51, 0
    v_accvgpr_write_b32 a52, 0
    v_accvgpr_write_b32 a53, 0
    v_accvgpr_write_b32 a54, 0
    v_accvgpr_write_b32 a55, 0
    v_accvgpr_write_b32 a56, 0
    v_accvgpr_write_b32 a57, 0
    v_accvgpr_write_b32 a58, 0
    v_accvgpr_write_b32 a59, 0
    v_accvgpr_write_b32 a60, 0
    v_accvgpr_write_b32 a61, 0
    v_accvgpr_write_b32 a62, 0
    v_accvgpr_write_b32 a63, 0
    v_add_u32 v22, 36864, v18
    v_add_u32 v23, 36864, v19
    v_add_u32 v20, 36864, v16
    v_add_u32 v21, 36864, v17
    global_load_dwordx4 v[28:31], v8, s[6:7]
    global_load_dwordx4 v[32:35], v9, s[6:7]
    global_load_dwordx4 v[36:39], v10, s[6:7]
    global_load_dwordx4 v[40:43], v11, s[6:7]
    global_load_dwordx4 v[44:47], v12, s[8:9]
    global_load_dwordx4 v[48:51], v13, s[8:9]
    global_load_dwordx4 v[52:55], v14, s[8:9]
    global_load_dwordx4 v[56:59], v15, s[8:9]
    s_add_u32 s6, s6, 128
    s_addc_u32 s7, s7, 0
    s_add_u32 s8, s8, 128
    s_addc_u32 s9, s9, 0
    global_load_dwordx4 v[60:63], v8, s[6:7]
    global_load_dwordx4 v[64:67], v9, s[6:7]
    global_load_dwordx4 v[68:71], v10, s[6:7]
    global_load_dwordx4 v[72:75], v11, s[6:7]
    global_load_dwordx4 v[76:79], v12, s[8:9]
    global_load_dwordx4 v[80:83], v13, s[8:9]
    global_load_dwordx4 v[84:87], v14, s[8:9]
    global_load_dwordx4 v[88:91], v15, s[8:9]
    s_add_u32 s6, s6, 128
    s_addc_u32 s7, s7, 0
    s_add_u32 s8, s8, 128
    s_addc_u32 s9, s9, 0
    global_load_dwordx4 v[92:95], v8, s[6:7]
    global_load_dwordx4 v[96:99], v9, s[6:7]
    global_load_dwordx4 v[100:103], v10, s[6:7]
    global_load_dwordx4 v[104:107], v11, s[6:7]
    global_load_dwordx4 v[108:111], v12, s[8:9]
    global_load_dwordx4 v[112:115], v13, s[8:9]
    global_load_dwordx4 v[116:119], v14, s[8:9]
    global_load_dwordx4 v[120:123], v15, s[8:9]
    s_add_u32 s6, s6, 128
    s_addc_u32 s7, s7, 0
    s_add_u32 s8, s8, 128
    s_addc_u32 s9, s9, 0
    s_waitcnt vmcnt(16)
    ds_write_b128 v16, v[28:31] offset:0
    ds_write_b128 v16, v[32:35] offset:4608
    ds_write_b128 v16, v[36:39] offset:9216
    ds_write_b128 v16, v[40:43] offset:13824
    ds_write_b128 v17, v[44:47] offset:0
    ds_write_b128 v17, v[48:51] offset:4608
    ds_write_b128 v17, v[52:55] offset:9216
    ds_write_b128 v17, v[56:59] offset:13824
    s_waitcnt lgkmcnt(0)
    s_barrier
    global_load_dwordx4 v[28:31], v8, s[6:7]
    global_load_dwordx4 v[32:35], v9, s[6:7]
    global_load_dwordx4 v[36:39], v10, s[6:7]
    global_load_dwordx4 v[40:43], v11, s[6:7]
    global_load_dwordx4 v[44:47], v12, s[8:9]
    global_load_dwordx4 v[48:51], v13, s[8:9]
    global_load_dwordx4 v[52:55], v14, s[8:9]
    global_load_dwordx4 v[56:59], v15, s[8:9]
    s_add_u32 s6, s6, 128
    s_addc_u32 s7, s7, 0
    s_add_u32 s8, s8, 128
    s_addc_u32 s9, s9, 0
    ds_read_b128 v[124:127], v18 offset:0
    ds_read_b128 v[128:131], v18 offset:4608
    ds_read_b128 v[132:135], v19 offset:0
    ds_read_b128 v[136:139], v19 offset:4608
    ds_read_b128 v[140:143], v18 offset:32
    ds_read_b128 v[144:147], v18 offset:4640
    ds_read_b128 v[148:151], v19 offset:32
    ds_read_b128 v[152:155], v19 offset:4640
    s_waitcnt lgkmcnt(4)
    v_mfma_f32_32x32x16_bf16 a[0:15], v[132:135], v[124:127], a[0:15]
    v_mfma_f32_32x32x16_bf16 a[16:31], v[136:139], v[124:127], a[16:31]
    v_mfma_f32_32x32x16_bf16 a[32:47], v[132:135], v[128:131], a[32:47]
    v_mfma_f32_32x32x16_bf16 a[48:63], v[136:139], v[128:131], a[48:63]
    ds_read_b128 v[124:127], v18 offset:64
    ds_read_b128 v[128:131], v18 offset:4672
    ds_read_b128 v[132:135], v19 offset:64
    ds_read_b128 v[136:139], v19 offset:4672
    s_waitcnt lgkmcnt(4)
    v_mfma_f32_32x32x16_bf16 a[0:15], v[148:151], v[140:143], a[0:15]
    v_mfma_f32_32x32x16_bf16 a[16:31], v[152:155], v[140:143], a[16:31]
    v_mfma_f32_32x32x16_bf16 a[32:47], v[148:151], v[144:147], a[32:47]
    v_mfma_f32_32x32x16_bf16 a[48:63], v[152:155], v[144:147], a[48:63]
    ds_read_b128 v[140:143], v18 offset:96
    ds_read_b128 v[144:147], v18 offset:4704
    ds_read_b128 v[148:151], v19 offset:96
    ds_read_b128 v[152:155], v19 offset:4704
    s_waitcnt lgkmcnt(4)
    v_mfma_f32_32x32x16_bf16 a[0:15], v[132:135], v[124:127], a[0:15]
    v_mfma_f32_32x32x16_bf16 a[16:31], v[136:139], v[124:127], a[16:31]
    v_mfma_f32_32x32x16_bf16 a[32:47], v[132:135], v[128:131], a[32:47]
    v_mfma_f32_32x32x16_bf16 a[48:63], v[136:139], v[128:131], a[48:63]
    s_waitcnt lgkmcnt(0)
    v_mfma_f32_32x32x16_bf16 a[0:15], v[148:151], v[140:143], a[0:15]
    v_mfma_f32_32x32x16_bf16 a[16:31], v[152:155], v[140:143], a[16:31]
    v_mfma_f32_32x32x16_bf16 a[32:47], v[148:151], v[144:147], a[32:47]
    v_mfma_f32_32x32x16_bf16 a[48:63], v[152:155], v[144:147], a[48:63]
    s_waitcnt vmcnt(16)
    ds_write_b128 v20, v[60:63] offset:0
    ds_write_b128 v20, v[64:67] offset:4608
    ds_write_b128 v20, v[68:71] offset:9216
    ds_write_b128 v20, v[72:75] offset:13824
    ds_write_b128 v21, v[76:79] offset:0
    ds_write_b128 v21, v[80:83] offset:4608
    ds_write_b128 v21, v[84:87] offset:9216
    ds_write_b128 v21, v[88:91] offset:13824
    s_waitcnt lgkmcnt(0)
    s_barrier
    global_load_dwordx4 v[60:63], v8, s[6:7]
    global_load_dwordx4 v[64:67], v9, s[6:7]
    global_load_dwordx4 v[68:71], v10, s[6:7]
    global_load_dwordx4 v[72:75], v11, s[6:7]
    global_load_dwordx4 v[76:79], v12, s[8:9]
    global_load_dwordx4 v[80:83], v13, s[8:9]
    global_load_dwordx4 v[84:87], v14, s[8:9]
    global_load_dwordx4 v[88:91], v15, s[8:9]
    s_add_u32 s6, s6, 128
    s_addc_u32 s7, s7, 0
    s_add_u32 s8, s8, 128
    s_addc_u32 s9, s9, 0
    ds_read_b128 v[124:127], v22 offset:0
    ds_read_b128 v[128:131], v22 offset:4608
    ds_read_b128 v[132:135], v23 offset:0
    ds_read_b128 v[136:139], v23 offset:4608
    ds_read_b128 v[140:143], v22 offset:32
    ds_read_b128 v[144:147], v22 offset:4640
    ds_read_b128 v[148:151], v23 offset:32
    ds_read_b128 v[152:155], v23 offset:4640
    s_waitcnt lgkmcnt(4)
    v_mfma_f32_32x32x16_bf16 a[0:15], v[132:135], v[124:127], a[0:15]
    v_mfma_f32_32x32x16_bf16 a[16:31], v[136:139], v[124:127], a[16:31]
    v_mfma_f32_32x32x16_bf16 a[32:47], v[132:135], v[128:131], a[32:47]
    v_mfma_f32_32x32x16_bf16 a[48:63], v[136:139], v[128:131], a[48:63]
    ds_read_b128 v[124:127], v22 offset:64
    ds_read_b128 v[128:131], v22 offset:4672
    ds_read_b128 v[132:135], v23 offset:64
    ds_read_b128 v[136:139], v23 offset:4672
    s_waitcnt lgkmcnt(4)
    v_mfma_f32_32x32x16_bf16 a[0:15], v[148:151], v[140:143], a[0:15]
    v_mfma_f32_32x32x16_bf16 a[16:31], v[152:155], v[140:143], a[16:31]
    v_mfma_f32_32x32x16_bf16 a[32:47], v[148:151], v[144:147], a[32:47]
    v_mfma_f32_32x32x16_bf16 a[48:63], v[152:155], v[144:147], a[48:63]
    ds_read_b128 v[140:143], v22 offset:96
    ds_read_b128 v[144:147], v22 offset:4704
    ds_read_b128 v[148:151], v23 offset:96
    ds_read_b128 v[152:155], v23 offset:4704
    s_waitcnt lgkmcnt(4)
    v_mfma_f32_32x32x16_bf16 a[0:15], v[132:135], v[124:127], a[0:15]
    v_mfma_f32_32x32x16_bf16 a[16:31], v[136:139], v[124:127], a[16:31]
    v_mfma_f32_32x32x16_bf16 a[32:47], v[132:135], v[128:131], a[32:47]
    v_mfma_f32_32x32x16_bf16 a[48:63], v[136:139], v[128:131], a[48:63]
    s_waitcnt lgkmcnt(0)
    v_mfma_f32_32x32x16_bf16 a[0:15], v[148:151], v[140:143], a[0:15]
    v_mfma_f32_32x32x16_bf16 a[16:31], v[152:155], v[140:143], a[16:31]
    v_mfma_f32_32x32x16_bf16 a[32:47], v[148:151], v[144:147], a[32:47]
    v_mfma_f32_32x32x16_bf16 a[48:63], v[152:155], v[144:147], a[48:63]
    s_waitcnt vmcnt(16)
    ds_write_b128 v16, v[92:95] offset:0
    ds_write_b128 v16, v[96:99] offset:4608
    ds_write_b128 v16, v[100:103] offset:9216
    ds_write_b128 v16, v[104:107] offset:13824
    ds_write_b128 v17, v[108:111] offset:0
    ds_write_b128 v17, v[112:115] offset:4608
    ds_write_b128 v17, v[116:119] offset:9216
    ds_write_b128 v17, v[120:123] offset:13824
    s_waitcnt lgkmcnt(0)
    s_barrier
    global_load_dwordx4 v[92:95], v8, s[6:7]
    global_load_dwordx4 v[96:99], v9, s[6:7]
    global_load_dwordx4 v[100:103], v10, s[6:7]
    global_load_dwordx4 v[104:107], v11, s[6:7]
    global_load_dwordx4 v[108:111], v12, s[8:9]
    global_load_dwordx4 v[112:115], v13, s[8:9]
    global_load_dwordx4 v[116:119], v14, s[8:9]
    global_load_dwordx4 v[120:123], v15, s[8:9]
    s_add_u32 s6, s6, 128
    s_addc_u32 s7, s7, 0
    s_add_u32 s8, s8, 128
    s_addc_u32 s9, s9, 0
    ds_read_b128 v[124:127], v18 offset:0
    ds_read_b128 v[128:131], v18 offset:4608
    ds_read_b128 v[132:135], v19 offset:0
    ds_read_b128 v[136:139], v19 offset:4608
    ds_read_b128 v[140:143], v18 offset:32
    ds_read_b128 v[144:147], v18 offset:4640
    ds_read_b128 v[148:151], v19 offset:32
    ds_read_b128 v[152:155], v19 offset:4640
    s_waitcnt lgkmcnt(4)
    v_mfma_f32_32x32x16_bf16 a[0:15], v[132:135], v[124:127], a[0:15]
    v_mfma_f32_32x32x16_bf16 a[16:31], v[136:139], v[124:127], a[16:31]
    v_mfma_f32_32x32x16_bf16 a[32:47], v[132:135], v[128:131], a[32:47]
    v_mfma_f32_32x32x16_bf16 a[48:63], v[136:139], v[128:131], a[48:63]
    ds_read_b128 v[124:127], v18 offset:64
    ds_read_b128 v[128:131], v18 offset:4672
    ds_read_b128 v[132:135], v19 offset:64
    ds_read_b128 v[136:139], v19 offset:4672
    s_waitcnt lgkmcnt(4)
    v_mfma_f32_32x32x16_bf16 a[0:15], v[148:151], v[140:143], a[0:15]
    v_mfma_f32_32x32x16_bf16 a[16:31], v[152:155], v[140:143], a[16:31]
    v_mfma_f32_32x32x16_bf16 a[32:47], v[148:151], v[144:147], a[32:47]
    v_mfma_f32_32x32x16_bf16 a[48:63], v[152:155], v[144:147], a[48:63]
    ds_read_b128 v[140:143], v18 offset:96
    ds_read_b128 v[144:147], v18 offset:4704
    ds_read_b128 v[148:151], v19 offset:96
    ds_read_b128 v[152:155], v19 offset:4704
    s_waitcnt lgkmcnt(4)
    v_mfma_f32_32x32x16_bf16 a[0:15], v[132:135], v[124:127], a[0:15]
    v_mfma_f32_32x32x16_bf16 a[16:31], v[136:139], v[124:127], a[16:31]
    v_mfma_f32_32x32x16_bf16 a[32:47], v[132:135], v[128:131], a[32:47]
    v_mfma_f32_32x32x16_bf16 a[48:63], v[136:139], v[128:131], a[48:63]
    s_waitcnt lgkmcnt(0)
    v_mfma_f32_32x32x16_bf16 a[0:15], v[148:151], v[140:143], a[0:15]
    v_mfma_f32_32x32x16_bf16 a[16:31], v[152:155], v[140:143], a[16:31]
    v_mfma_f32_32x32x16_bf16 a[32:47], v[148:151], v[144:147], a[32:47]
    v_mfma_f32_32x32x16_bf16 a[48:63], v[152:155], v[144:147], a[48:63]
    s_waitcnt vmcnt(16)
    ds_write_b128 v20, v[28:31] offset:0
    ds_write_b128 v20, v[32:35] offset:4608
    ds_write_b128 v20, v[36:39] offset:9216
    ds_write_b128 v20, v[40:43] offset:13824
    ds_write_b128 v21, v[44:47] offset:0
    ds_write_b128 v21, v[48:51] offset:4608
    ds_write_b128 v21, v[52:55] offset:9216
    ds_write_b128 v21, v[56:59] offset:13824
    s_waitcnt lgkmcnt(0)
    s_barrier
    global_load_dwordx4 v[28:31], v8, s[6:7]
    global_load_dwordx4 v[32:35], v9, s[6:7]
    global_load_dwordx4 v[36:39], v10, s[6:7]
    global_load_dwordx4 v[40:43], v11, s[6:7]
    global_load_dwordx4 v[44:47], v12, s[8:9]
    global_load_dwordx4 v[48:51], v13, s[8:9]
    global_load_dwordx4 v[52:55], v14, s[8:9]
    global_load_dwordx4 v[56:59], v15, s[8:9]
    s_add_u32 s6, s6, 128
    s_addc_u32 s7, s7, 0
    s_add_u32 s8, s8, 128
    s_addc_u32 s9, s9, 0
    ds_read_b128 v[124:127], v22 offset:0
    ds_read_b128 v[128:131], v22 offset:4608
    ds_read_b128 v[132:135], v23 offset:0
    ds_read_b128 v[136:139], v23 offset:4608
    ds_read_b128 v[140:143], v22 offset:32
    ds_read_b128 v[144:147], v22 offset:4640
    ds_read_b128 v[148:151], v23 offset:32
    ds_read_b128 v[152:155], v23 offset:4640
    s_waitcnt lgkmcnt(4)
    v_mfma_f32_32x32x16_bf16 a[0:15], v[132:135], v[124:127], a[0:15]
    v_mfma_f32_32x32x16_bf16 a[16:31], v[136:139], v[124:127], a[16:31]
    v_mfma_f32_32x32x16_bf16 a[32:47], v[132:135], v[128:131], a[32:47]
    v_mfma_f32_32x32x16_bf16 a[48:63], v[136:139], v[128:131], a[48:63]
    ds_read_b128 v[124:127], v22 offset:64
    ds_read_b128 v[128:131], v22 offset:4672
    ds_read_b128 v[132:135], v23 offset:64
    ds_read_b128 v[136:139], v23 offset:4672
    s_waitcnt lgkmcnt(4)
    v_mfma_f32_32x32x16_bf16 a[0:15], v[148:151], v[140:143], a[0:15]
    v_mfma_f32_32x32x16_bf16 a[16:31], v[152:155], v[140:143], a[16:31]
    v_mfma_f32_32x32x16_bf16 a[32:47], v[148:151], v[144:147], a[32:47]
    v_mfma_f32_32x32x16_bf16 a[48:63], v[152:155], v[144:147], a[48:63]
    ds_read_b128 v[140:143], v22 offset:96
    ds_read_b128 v[144:147], v22 offset:4704
    ds_read_b128 v[148:151], v23 offset:96
    ds_read_b128 v[152:155], v23 offset:4704
    s_waitcnt lgkmcnt(4)
    v_mfma_f32_32x32x16_bf16 a[0:15], v[132:135], v[124:127], a[0:15]
    v_mfma_f32_32x32x16_bf16 a[16:31], v[136:139], v[124:127], a[16:31]
    v_mfma_f32_32x32x16_bf16 a[32:47], v[132:135], v[128:131], a[32:47]
    v_mfma_f32_32x32x16_bf16 a[48:63], v[136:139], v[128:131], a[48:63]
    s_waitcnt lgkmcnt(0)
    v_mfma_f32_32x32x16_bf16 a[0:15], v[148:151], v[140:143], a[0:15]
    v_mfma_f32_32x32x16_bf16 a[16:31], v[152:155], v[140:143], a[16:31]
    v_mfma_f32_32x32x16_bf16 a[32:47], v[148:151], v[144:147], a[32:47]
    v_mfma_f32_32x32x16_bf16 a[48:63], v[152:155], v[144:147], a[48:63]
    s_waitcnt vmcnt(16)
    ds_write_b128 v16, v[60:63] offset:0
    ds_write_b128 v16, v[64:67] offset:4608
    ds_write_b128 v16, v[68:71] offset:9216
    ds_write_b128 v16, v[72:75] offset:13824
    ds_write_b128 v17, v[76:79] offset:0
    ds_write_b128 v17, v[80:83] offset:4608
    ds_write_b128 v17, v[84:87] offset:9216
    ds_write_b128 v17, v[88:91] offset:13824
    s_waitcnt lgkmcnt(0)
    s_barrier
    ds_read_b128 v[124:127], v18 offset:0
    ds_read_b128 v[128:131], v18 offset:4608
    ds_read_b128 v[132:135], v19 offset:0
    ds_read_b128 v[136:139], v19 offset:4608
    ds_read_b128 v[140:143], v18 offset:32
    ds_read_b128 v[144:147], v18 offset:4640
    ds_read_b128 v[148:151], v19 offset:32
    ds_read_b128 v[152:155], v19 offset:4640
    s_waitcnt lgkmcnt(4)
    v_mfma_f32_32x32x16_bf16 a[0:15], v[132:135], v[124:127], a[0:15]
    v_mfma_f32_32x32x16_bf16 a[16:31], v[136:139], v[124:127], a[16:31]
    v_mfma_f32_32x32x16_bf16 a[32:47], v[132:135], v[128:131], a[32:47]
    v_mfma_f32_32x32x16_bf16 a[48:63], v[136:139], v[128:131], a[48:63]
    ds_read_b128 v[124:127], v18 offset:64
    ds_read_b128 v[128:131], v18 offset:4672
    ds_read_b128 v[132:135], v19 offset:64
    ds_read_b128 v[136:139], v19 offset:4672
    s_waitcnt lgkmcnt(4)
    v_mfma_f32_32x32x16_bf16 a[0:15], v[148:151], v[140:143], a[0:15]
    v_mfma_f32_32x32x16_bf16 a[16:31], v[152:155], v[140:143], a[16:31]
    v_mfma_f32_32x32x16_bf16 a[32:47], v[148:151], v[144:147], a[32:47]
    v_mfma_f32_32x32x16_bf16 a[48:63], v[152:155], v[144:147], a[48:63]
    ds_read_b128 v[140:143], v18 offset:96
    ds_read_b128 v[144:147], v18 offset:4704
    ds_read_b128 v[148:151], v19 offset:96
    ds_read_b128 v[152:155], v19 offset:4704
    s_waitcnt lgkmcnt(4)
    v_mfma_f32_32x32x16_bf16 a[0:15], v[132:135], v[124:127], a[0:15]
    v_mfma_f32_32x32x16_bf16 a[16:31], v[136:139], v[124:127], a[16:31]
    v_mfma_f32_32x32x16_bf16 a[32:47], v[132:135], v[128:131], a[32:47]
    v_mfma_f32_32x32x16_bf16 a[48:63], v[136:139], v[128:131], a[48:63]
    s_waitcnt lgkmcnt(0)
    v_mfma_f32_32x32x16_bf16 a[0:15], v[148:151], v[140:143], a[0:15]
    v_mfma_f32_32x32x16_bf16 a[16:31], v[152:155], v[140:143], a[16:31]
    v_mfma_f32_32x32x16_bf16 a[32:47], v[148:151], v[144:147], a[32:47]
    v_mfma_f32_32x32x16_bf16 a[48:63], v[152:155], v[144:147], a[48:63]
    s_waitcnt vmcnt(8)
    ds_write_b128 v20, v[92:95] offset:0
    ds_write_b128 v20, v[96:99] offset:4608
    ds_write_b128 v20, v[100:103] offset:9216
    ds_write_b128 v20, v[104:107] offset:13824
    ds_write_b128 v21, v[108:111] offset:0
    ds_write_b128 v21, v[112:115] offset:4608
    ds_write_b128 v21, v[116:119] offset:9216
    ds_write_b128 v21, v[120:123] offset:13824
    s_waitcnt lgkmcnt(0)
    s_barrier
    ds_read_b128 v[124:127], v22 offset:0
    ds_read_b128 v[128:131], v22 offset:4608
    ds_read_b128 v[132:135], v23 offset:0
    ds_read_b128 v[136:139], v23 offset:4608
    ds_read_b128 v[140:143], v22 offset:32
    ds_read_b128 v[144:147], v22 offset:4640
    ds_read_b128 v[148:151], v23 offset:32
    ds_read_b128 v[152:155], v23 offset:4640
    s_waitcnt lgkmcnt(4)
    v_mfma_f32_32x32x16_bf16 a[0:15], v[132:135], v[124:127], a[0:15]
    v_mfma_f32_32x32x16_bf16 a[16:31], v[136:139], v[124:127], a[16:31]
    v_mfma_f32_32x32x16_bf16 a[32:47], v[132:135], v[128:131], a[32:47]
    v_mfma_f32_32x32x16_bf16 a[48:63], v[136:139], v[128:131], a[48:63]
    ds_read_b128 v[124:127], v22 offset:64
    ds_read_b128 v[128:131], v22 offset:4672
    ds_read_b128 v[132:135], v23 offset:64
    ds_read_b128 v[136:139], v23 offset:4672
    s_waitcnt lgkmcnt(4)
    v_mfma_f32_32x32x16_bf16 a[0:15], v[148:151], v[140:143], a[0:15]
    v_mfma_f32_32x32x16_bf16 a[16:31], v[152:155], v[140:143], a[16:31]
    v_mfma_f32_32x32x16_bf16 a[32:47], v[148:151], v[144:147], a[32:47]
    v_mfma_f32_32x32x16_bf16 a[48:63], v[152:155], v[144:147], a[48:63]
    ds_read_b128 v[140:143], v22 offset:96
    ds_read_b128 v[144:147], v22 offset:4704
    ds_read_b128 v[148:151], v23 offset:96
    ds_read_b128 v[152:155], v23 offset:4704
    s_waitcnt lgkmcnt(4)
    v_mfma_f32_32x32x16_bf16 a[0:15], v[132:135], v[124:127], a[0:15]
    v_mfma_f32_32x32x16_bf16 a[16:31], v[136:139], v[124:127], a[16:31]
    v_mfma_f32_32x32x16_bf16 a[32:47], v[132:135], v[128:131], a[32:47]
    v_mfma_f32_32x32x16_bf16 a[48:63], v[136:139], v[128:131], a[48:63]
    s_waitcnt lgkmcnt(0)
    v_mfma_f32_32x32x16_bf16 a[0:15], v[148:151], v[140:143], a[0:15]
    v_mfma_f32_32x32x16_bf16 a[16:31], v[152:155], v[140:143], a[16:31]
    v_mfma_f32_32x32x16_bf16 a[32:47], v[148:151], v[144:147], a[32:47]
    v_mfma_f32_32x32x16_bf16 a[48:63], v[152:155], v[144:147], a[48:63]
    s_waitcnt vmcnt(0)
    ds_write_b128 v16, v[28:31] offset:0
    ds_write_b128 v16, v[32:35] offset:4608
    ds_write_b128 v16, v[36:39] offset:9216
    ds_write_b128 v16, v[40:43] offset:13824
    ds_write_b128 v17, v[44:47] offset:0
    ds_write_b128 v17, v[48:51] offset:4608
    ds_write_b128 v17, v[52:55] offset:9216
    ds_write_b128 v17, v[56:59] offset:13824
    s_waitcnt lgkmcnt(0)
    s_barrier
    ds_read_b128 v[124:127], v18 offset:0
    ds_read_b128 v[128:131], v18 offset:4608
    ds_read_b128 v[132:135], v19 offset:0
    ds_read_b128 v[136:139], v19 offset:4608
    ds_read_b128 v[140:143], v18 offset:32
    ds_read_b128 v[144:147], v18 offset:4640
    ds_read_b128 v[148:151], v19 offset:32
    ds_read_b128 v[152:155], v19 offset:4640
    s_waitcnt lgkmcnt(4)
    v_mfma_f32_32x32x16_bf16 a[0:15], v[132:135], v[124:127], a[0:15]
    v_mfma_f32_32x32x16_bf16 a[16:31], v[136:139], v[124:127], a[16:31]
    v_mfma_f32_32x32x16_bf16 a[32:47], v[132:135], v[128:131], a[32:47]
    v_mfma_f32_32x32x16_bf16 a[48:63], v[136:139], v[128:131], a[48:63]
    ds_read_b128 v[124:127], v18 offset:64
    ds_read_b128 v[128:131], v18 offset:4672
    ds_read_b128 v[132:135], v19 offset:64
    ds_read_b128 v[136:139], v19 offset:4672
    s_waitcnt lgkmcnt(4)
    v_mfma_f32_32x32x16_bf16 a[0:15], v[148:151], v[140:143], a[0:15]
    v_mfma_f32_32x32x16_bf16 a[16:31], v[152:155], v[140:143], a[16:31]
    v_mfma_f32_32x32x16_bf16 a[32:47], v[148:151], v[144:147], a[32:47]
    v_mfma_f32_32x32x16_bf16 a[48:63], v[152:155], v[144:147], a[48:63]
    ds_read_b128 v[140:143], v18 offset:96
    ds_read_b128 v[144:147], v18 offset:4704
    ds_read_b128 v[148:151], v19 offset:96
    ds_read_b128 v[152:155], v19 offset:4704
    s_waitcnt lgkmcnt(4)
    v_mfma_f32_32x32x16_bf16 a[0:15], v[132:135], v[124:127], a[0:15]
    v_mfma_f32_32x32x16_bf16 a[16:31], v[136:139], v[124:127], a[16:31]
    v_mfma_f32_32x32x16_bf16 a[32:47], v[132:135], v[128:131], a[32:47]
    v_mfma_f32_32x32x16_bf16 a[48:63], v[136:139], v[128:131], a[48:63]
    s_waitcnt lgkmcnt(0)
    v_mfma_f32_32x32x16_bf16 a[0:15], v[148:151], v[140:143], a[0:15]
    v_mfma_f32_32x32x16_bf16 a[16:31], v[152:155], v[140:143], a[16:31]
    v_mfma_f32_32x32x16_bf16 a[32:47], v[148:151], v[144:147], a[32:47]
    v_mfma_f32_32x32x16_bf16 a[48:63], v[152:155], v[144:147], a[48:63]
    s_nop 15
    v_and_b32 v4, 31, v1
    v_lshrrev_b32 v5, 5, v1
    s_mul_i32 s31, s25, 64
    s_add_u32 s31, s31, s27
    v_add_u32 v4, s31, v4
    s_mul_i32 s36, s26, 64
    s_add_u32 s36, s36, s28
    v_lshlrev_b32 v5, 2, v5
    v_add_u32 v5, s36, v5
    s_mov_b32 s37, 4096
    v_mul_lo_u32 v6, v4, s37
    v_lshl_add_u32 v6, v5, 1, v6
    s_lshr_b32 s38, s36, 5
    s_mul_i32 s38, s38, 448
    v_lshrrev_b32 v6, 4, v4
    v_add_u32 v6, s38, v6
    v_lshlrev_b32 v6, 6, v6
    v_and_b32 v7, 15, v4
    v_add_u32 v6, v6, v7
    v_lshrrev_b32 v7, 5, v1
    v_lshl_add_u32 v6, v7, 4, v6
    v_lshlrev_b32 v6, 4, v6
    v_accvgpr_read_b32 v28, a0
    v_accvgpr_read_b32 v29, a1
    v_accvgpr_read_b32 v30, a2
    v_accvgpr_read_b32 v31, a3
    v_cvt_pk_bf16_f32 v32, v28, v29
    v_cvt_pk_bf16_f32 v33, v30, v31
    global_store_dwordx2 v6, v[32:33], s[10:11] offset:0 sc1
    v_accvgpr_read_b32 v44, a4
    v_accvgpr_read_b32 v45, a5
    v_accvgpr_read_b32 v46, a6
    v_accvgpr_read_b32 v47, a7
    v_cvt_pk_bf16_f32 v48, v44, v45
    v_cvt_pk_bf16_f32 v49, v46, v47
    global_store_dwordx2 v6, v[48:49], s[10:11] offset:512 sc1
    v_accvgpr_read_b32 v60, a8
    v_accvgpr_read_b32 v61, a9
    v_accvgpr_read_b32 v62, a10
    v_accvgpr_read_b32 v63, a11
    v_cvt_pk_bf16_f32 v64, v60, v61
    v_cvt_pk_bf16_f32 v65, v62, v63
    global_store_dwordx2 v6, v[64:65], s[10:11] offset:8 sc1
    v_accvgpr_read_b32 v76, a12
    v_accvgpr_read_b32 v77, a13
    v_accvgpr_read_b32 v78, a14
    v_accvgpr_read_b32 v79, a15
    v_cvt_pk_bf16_f32 v80, v76, v77
    v_cvt_pk_bf16_f32 v81, v78, v79
    global_store_dwordx2 v6, v[80:81], s[10:11] offset:520 sc1
    v_accvgpr_read_b32 v28, a16
    v_accvgpr_read_b32 v29, a17
    v_accvgpr_read_b32 v30, a18
    v_accvgpr_read_b32 v31, a19
    v_cvt_pk_bf16_f32 v32, v28, v29
    v_cvt_pk_bf16_f32 v33, v30, v31
    v_add_u32 v7, 458752, v6
    global_store_dwordx2 v7, v[32:33], s[10:11] offset:0 sc1
    v_accvgpr_read_b32 v44, a20
    v_accvgpr_read_b32 v45, a21
    v_accvgpr_read_b32 v46, a22
    v_accvgpr_read_b32 v47, a23
    v_cvt_pk_bf16_f32 v48, v44, v45
    v_cvt_pk_bf16_f32 v49, v46, v47
    v_add_u32 v7, 458752, v6
    global_store_dwordx2 v7, v[48:49], s[10:11] offset:512 sc1
    v_accvgpr_read_b32 v60, a24
    v_accvgpr_read_b32 v61, a25
    v_accvgpr_read_b32 v62, a26
    v_accvgpr_read_b32 v63, a27
    v_cvt_pk_bf16_f32 v64, v60, v61
    v_cvt_pk_bf16_f32 v65, v62, v63
    v_add_u32 v7, 458752, v6
    global_store_dwordx2 v7, v[64:65], s[10:11] offset:8 sc1
    v_accvgpr_read_b32 v76, a28
    v_accvgpr_read_b32 v77, a29
    v_accvgpr_read_b32 v78, a30
    v_accvgpr_read_b32 v79, a31
    v_cvt_pk_bf16_f32 v80, v76, v77
    v_cvt_pk_bf16_f32 v81, v78, v79
    v_add_u32 v7, 458752, v6
    global_store_dwordx2 v7, v[80:81], s[10:11] offset:520 sc1
    v_add_u32 v6, 2048, v6
    v_accvgpr_read_b32 v28, a32
    v_accvgpr_read_b32 v29, a33
    v_accvgpr_read_b32 v30, a34
    v_accvgpr_read_b32 v31, a35
    v_cvt_pk_bf16_f32 v32, v28, v29
    v_cvt_pk_bf16_f32 v33, v30, v31
    global_store_dwordx2 v6, v[32:33], s[10:11] offset:0 sc1
    v_accvgpr_read_b32 v44, a36
    v_accvgpr_read_b32 v45, a37
    v_accvgpr_read_b32 v46, a38
    v_accvgpr_read_b32 v47, a39
    v_cvt_pk_bf16_f32 v48, v44, v45
    v_cvt_pk_bf16_f32 v49, v46, v47
    global_store_dwordx2 v6, v[48:49], s[10:11] offset:512 sc1
    v_accvgpr_read_b32 v60, a40
    v_accvgpr_read_b32 v61, a41
    v_accvgpr_read_b32 v62, a42
    v_accvgpr_read_b32 v63, a43
    v_cvt_pk_bf16_f32 v64, v60, v61
    v_cvt_pk_bf16_f32 v65, v62, v63
    global_store_dwordx2 v6, v[64:65], s[10:11] offset:8 sc1
    v_accvgpr_read_b32 v76, a44
    v_accvgpr_read_b32 v77, a45
    v_accvgpr_read_b32 v78, a46
    v_accvgpr_read_b32 v79, a47
    v_cvt_pk_bf16_f32 v80, v76, v77
    v_cvt_pk_bf16_f32 v81, v78, v79
    global_store_dwordx2 v6, v[80:81], s[10:11] offset:520 sc1
    v_accvgpr_read_b32 v28, a48
    v_accvgpr_read_b32 v29, a49
    v_accvgpr_read_b32 v30, a50
    v_accvgpr_read_b32 v31, a51
    v_cvt_pk_bf16_f32 v32, v28, v29
    v_cvt_pk_bf16_f32 v33, v30, v31
    v_add_u32 v7, 458752, v6
    global_store_dwordx2 v7, v[32:33], s[10:11] offset:0 sc1
    v_accvgpr_read_b32 v44, a52
    v_accvgpr_read_b32 v45, a53
    v_accvgpr_read_b32 v46, a54
    v_accvgpr_read_b32 v47, a55
    v_cvt_pk_bf16_f32 v48, v44, v45
    v_cvt_pk_bf16_f32 v49, v46, v47
    v_add_u32 v7, 458752, v6
    global_store_dwordx2 v7, v[48:49], s[10:11] offset:512 sc1
    v_accvgpr_read_b32 v60, a56
    v_accvgpr_read_b32 v61, a57
    v_accvgpr_read_b32 v62, a58
    v_accvgpr_read_b32 v63, a59
    v_cvt_pk_bf16_f32 v64, v60, v61
    v_cvt_pk_bf16_f32 v65, v62, v63
    v_add_u32 v7, 458752, v6
    global_store_dwordx2 v7, v[64:65], s[10:11] offset:8 sc1
    v_accvgpr_read_b32 v76, a60
    v_accvgpr_read_b32 v77, a61
    v_accvgpr_read_b32 v78, a62
    v_accvgpr_read_b32 v79, a63
    v_cvt_pk_bf16_f32 v80, v76, v77
    v_cvt_pk_bf16_f32 v81, v78, v79
    v_add_u32 v7, 458752, v6
    global_store_dwordx2 v7, v[80:81], s[10:11] offset:520 sc1
    s_lshl_b32 s23, s23, 6
    s_waitcnt vmcnt(0)
    s_barrier
    s_add_u32 s94, s4, 0x6bd3000
    s_addc_u32 s95, s5, 0
    v_mov_b32 v2, s23
    v_mov_b32 v3, 1
    v_cmp_eq_u32 vcc, 0, v0
    s_and_saveexec_b64 s[88:89], vcc
    s_cbranch_execz sg_g4_5
    global_atomic_add v2, v3, s[94:95] sc1
sg_g4_5:
    s_mov_b64 exec, s[88:89]
end_g4_1:
    s_barrier
    s_add_u32 s90, s90, 224
    s_cmp_lt_u32 s90, 896
    s_cbranch_scc1 wl_chain_33
sk_chain_34:
    s_sub_u32 s90, s91, 0
    s_cmp_ge_u32 s90, 224
    s_cbranch_scc1 sk_chain_36
wl_chain_35:
    s_mov_b32 s2, s90
    s_cmp_ge_u32 s2, 896
    s_cbranch_scc1 end_g3_1
    s_load_dwordx2 s[4:5], s[0:1], 128
    s_mov_b32 s20, 0
    s_mov_b32 s21, s2
    s_mul_i32 s22, s21, 1171
    s_lshr_b32 s22, s22, 16
    s_mul_i32 s23, s22, 56
    s_sub_u32 s23, s21, s23
    v_and_b32 v1, 63, v0
    v_lshrrev_b32 v2, 6, v0
    s_nop 0
    v_readfirstlane_b32 s24, v2
    s_waitcnt lgkmcnt(0)
    s_add_u32 s6, s4, 0x3000
    s_addc_u32 s7, s5, 0
    s_add_u32 s8, s4, 0x853000
    s_addc_u32 s9, s5, 0
    s_add_u32 s10, s4, 0x1493000
    s_addc_u32 s11, s5, 0
    s_lshr_b32 s25, s24, 1
    s_and_b32 s26, s24, 1
    v_lshrrev_b32 v2, 3, v0
    v_and_b32 v3, 7, v0
    v_lshlrev_b32 v3, 4, v3
    s_mul_i32 s27, s22, 128
    s_mul_i32 s28, s23, 128
    s_mov_b32 s29, 896
    s_mov_b32 s30, 896
    v_add_u32 v4, s27, v2
    v_mul_lo_u32 v4, v4, s29
    v_add_u32 v8, v4, v3
    v_add_u32 v9, 28672, v8
    v_add_u32 v10, 28672, v9
    v_add_u32 v11, 28672, v10
    v_add_u32 v4, s28, v2
    v_mul_lo_u32 v4, v4, s30
    v_add_u32 v12, v4, v3
    v_add_u32 v13, 28672, v12
    v_add_u32 v14, 28672, v13
    v_add_u32 v15, 28672, v14
    v_mul_u32_u24 v4, 144, v2
    v_add_u32 v16, v4, v3
    v_add_u32 v17, 18432, v16
    v_and_b32 v4, 31, v1
    v_lshrrev_b32 v5, 5, v1
    v_lshlrev_b32 v5, 4, v5
    s_mul_i32 s31, s25, 64
    v_add_u32 v6, s31, v4
    v_mul_u32_u24 v6, 144, v6
    v_add_u32 v18, v6, v5
    s_mul_i32 s31, s26, 64
    v_add_u32 v6, s31, v4
    v_mul_u32_u24 v6, 144, v6
    v_add_u32 v6, v6, v5
    v_add_u32 v19, 18432, v6
    v_accvgpr_write_b32 a0, 0
    v_accvgpr_write_b32 a1, 0
    v_accvgpr_write_b32 a2, 0
    v_accvgpr_write_b32 a3, 0
    v_accvgpr_write_b32 a4, 0
    v_accvgpr_write_b32 a5, 0
    v_accvgpr_write_b32 a6, 0
    v_accvgpr_write_b32 a7, 0
    v_accvgpr_write_b32 a8, 0
    v_accvgpr_write_b32 a9, 0
    v_accvgpr_write_b32 a10, 0
    v_accvgpr_write_b32 a11, 0
    v_accvgpr_write_b32 a12, 0
    v_accvgpr_write_b32 a13, 0
    v_accvgpr_write_b32 a14, 0
    v_accvgpr_write_b32 a15, 0
    v_accvgpr_write_b32 a16, 0
    v_accvgpr_write_b32 a17, 0
    v_accvgpr_write_b32 a18, 0
    v_accvgpr_write_b32 a19, 0
    v_accvgpr_write_b32 a20, 0
    v_accvgpr_write_b32 a21, 0
    v_accvgpr_write_b32 a22, 0
    v_accvgpr_write_b32 a23, 0
    v_accvgpr_write_b32 a24, 0
    v_accvgpr_write_b32 a25, 0
    v_accvgpr_write_b32 a26, 0
    v_accvgpr_write_b32 a27, 0
    v_accvgpr_write_b32 a28, 0
    v_accvgpr_write_b32 a29, 0
    v_accvgpr_write_b32 a30, 0
    v_accvgpr_write_b32 a31, 0
    v_accvgpr_write_b32 a32, 0
    v_accvgpr_write_b32 a33, 0
    v_accvgpr_write_b32 a34, 0
    v_accvgpr_write_b32 a35, 0
    v_accvgpr_write_b32 a36, 0
    v_accvgpr_write_b32 a37, 0
    v_accvgpr_write_b32 a38, 0
    v_accvgpr_write_b32 a39, 0
    v_accvgpr_write_b32 a40, 0
    v_accvgpr_write_b32 a41, 0
    v_accvgpr_write_b32 a42, 0
    v_accvgpr_write_b32 a43, 0
    v_accvgpr_write_b32 a44, 0
    v_accvgpr_write_b32 a45, 0
    v_accvgpr_write_b32 a46, 0
    v_accvgpr_write_b32 a47, 0
    v_accvgpr_write_b32 a48, 0
    v_accvgpr_write_b32 a49, 0
    v_accvgpr_write_b32 a50, 0
    v_accvgpr_write_b32 a51, 0
    v_accvgpr_write_b32 a52, 0
    v_accvgpr_write_b32 a53, 0
    v_accvgpr_write_b32 a54, 0
    v_accvgpr_write_b32 a55, 0
    v_accvgpr_write_b32 a56, 0
    v_accvgpr_write_b32 a57, 0
    v_accvgpr_write_b32 a58, 0
    v_accvgpr_write_b32 a59, 0
    v_accvgpr_write_b32 a60, 0
    v_accvgpr_write_b32 a61, 0
    v_accvgpr_write_b32 a62, 0
    v_accvgpr_write_b32 a63, 0
    v_add_u32 v22, 36864, v18
    v_add_u32 v23, 36864, v19
    v_add_u32 v20, 36864, v16
    v_add_u32 v21, 36864, v17
    global_load_dwordx4 v[28:31], v8, s[6:7]
    global_load_dwordx4 v[32:35], v9, s[6:7]
    global_load_dwordx4 v[36:39], v10, s[6:7]
    global_load_dwordx4 v[40:43], v11, s[6:7]
    global_load_dwordx4 v[44:47], v12, s[8:9]
    global_load_dwordx4 v[48:51], v13, s[8:9]
    global_load_dwordx4 v[52:55], v14, s[8:9]
    global_load_dwordx4 v[56:59], v15, s[8:9]
    s_add_u32 s6, s6, 128
    s_addc_u32 s7, s7, 0
    s_add_u32 s8, s8, 128
    s_addc_u32 s9, s9, 0
    global_load_dwordx4 v[60:63], v8, s[6:7]
    global_load_dwordx4 v[64:67], v9, s[6:7]
    global_load_dwordx4 v[68:71], v10, s[6:7]
    global_load_dwordx4 v[72:75], v11, s[6:7]
    global_load_dwordx4 v[76:79], v12, s[8:9]
    global_load_dwordx4 v[80:83], v13, s[8:9]
    global_load_dwordx4 v[84:87], v14, s[8:9]
    global_load_dwordx4 v[88:91], v15, s[8:9]
    s_add_u32 s6, s6, 128
    s_addc_u32 s7, s7, 0
    s_add_u32 s8, s8, 128
    s_addc_u32 s9, s9, 0
    global_load_dwordx4 v[92:95], v8, s[6:7]
    global_load_dwordx4 v[96:99], v9, s[6:7]
    global_load_dwordx4 v[100:103], v10, s[6:7]
    global_load_dwordx4 v[104:107], v11, s[6:7]
    global_load_dwordx4 v[108:111], v12, s[8:9]
    global_load_dwordx4 v[112:115], v13, s[8:9]
    global_load_dwordx4 v[116:119], v14, s[8:9]
    global_load_dwordx4 v[120:123], v15, s[8:9]
    s_add_u32 s6, s6, 128
    s_addc_u32 s7, s7, 0
    s_add_u32 s8, s8, 128
    s_addc_u32 s9, s9, 0
    s_waitcnt vmcnt(16)
    ds_write_b128 v16, v[28:31] offset:0
    ds_write_b128 v16, v[32:35] offset:4608
    ds_write_b128 v16, v[36:39] offset:9216
    ds_write_b128 v16, v[40:43] offset:13824
    ds_write_b128 v17, v[44:47] offset:0
    ds_write_b128 v17, v[48:51] offset:4608
    ds_write_b128 v17, v[52:55] offset:9216
    ds_write_b128 v17, v[56:59] offset:13824
    s_waitcnt lgkmcnt(0)
    s_barrier
    global_load_dwordx4 v[28:31], v8, s[6:7]
    global_load_dwordx4 v[32:35], v9, s[6:7]
    global_load_dwordx4 v[36:39], v10, s[6:7]
    global_load_dwordx4 v[40:43], v11, s[6:7]
    global_load_dwordx4 v[44:47], v12, s[8:9]
    global_load_dwordx4 v[48:51], v13, s[8:9]
    global_load_dwordx4 v[52:55], v14, s[8:9]
    global_load_dwordx4 v[56:59], v15, s[8:9]
    s_add_u32 s6, s6, 128
    s_addc_u32 s7, s7, 0
    s_add_u32 s8, s8, 128
    s_addc_u32 s9, s9, 0
    ds_read_b128 v[124:127], v18 offset:0
    ds_read_b128 v[128:131], v18 offset:4608
    ds_read_b128 v[132:135], v19 offset:0
    ds_read_b128 v[136:139], v19 offset:4608
    ds_read_b128 v[140:143], v18 offset:32
    ds_read_b128 v[144:147], v18 offset:4640
    ds_read_b128 v[148:151], v19 offset:32
    ds_read_b128 v[152:155], v19 offset:4640
    s_waitcnt lgkmcnt(4)
    v_mfma_f32_32x32x16_bf16 a[0:15], v[132:135], v[124:127], a[0:15]
    v_mfma_f32_32x32x16_bf16 a[16:31], v[136:139], v[124:127], a[16:31]
    v_mfma_f32_32x32x16_bf16 a[32:47], v[132:135], v[128:131], a[32:47]
    v_mfma_f32_32x32x16_bf16 a[48:63], v[136:139], v[128:131], a[48:63]
    ds_read_b128 v[124:127], v18 offset:64
    ds_read_b128 v[128:131], v18 offset:4672
    ds_read_b128 v[132:135], v19 offset:64
    ds_read_b128 v[136:139], v19 offset:4672
    s_waitcnt lgkmcnt(4)
    v_mfma_f32_32x32x16_bf16 a[0:15], v[148:151], v[140:143], a[0:15]
    v_mfma_f32_32x32x16_bf16 a[16:31], v[152:155], v[140:143], a[16:31]
    v_mfma_f32_32x32x16_bf16 a[32:47], v[148:151], v[144:147], a[32:47]
    v_mfma_f32_32x32x16_bf16 a[48:63], v[152:155], v[144:147], a[48:63]
    ds_read_b128 v[140:143], v18 offset:96
    ds_read_b128 v[144:147], v18 offset:4704
    ds_read_b128 v[148:151], v19 offset:96
    ds_read_b128 v[152:155], v19 offset:4704
    s_waitcnt lgkmcnt(4)
    v_mfma_f32_32x32x16_bf16 a[0:15], v[132:135], v[124:127], a[0:15]
    v_mfma_f32_32x32x16_bf16 a[16:31], v[136:139], v[124:127], a[16:31]
    v_mfma_f32_32x32x16_bf16 a[32:47], v[132:135], v[128:131], a[32:47]
    v_mfma_f32_32x32x16_bf16 a[48:63], v[136:139], v[128:131], a[48:63]
    s_waitcnt lgkmcnt(0)
    v_mfma_f32_32x32x16_bf16 a[0:15], v[148:151], v[140:143], a[0:15]
    v_mfma_f32_32x32x16_bf16 a[16:31], v[152:155], v[140:143], a[16:31]
    v_mfma_f32_32x32x16_bf16 a[32:47], v[148:151], v[144:147], a[32:47]
    v_mfma_f32_32x32x16_bf16 a[48:63], v[152:155], v[144:147], a[48:63]
    s_waitcnt vmcnt(16)
    ds_write_b128 v20, v[60:63] offset:0
    ds_write_b128 v20, v[64:67] offset:4608
    ds_write_b128 v20, v[68:71] offset:9216
    ds_write_b128 v20, v[72:75] offset:13824
    ds_write_b128 v21, v[76:79] offset:0
    ds_write_b128 v21, v[80:83] offset:4608
    ds_write_b128 v21, v[84:87] offset:9216
    ds_write_b128 v21, v[88:91] offset:13824
    s_waitcnt lgkmcnt(0)
    s_barrier
    global_load_dwordx4 v[60:63], v8, s[6:7]
    global_load_dwordx4 v[64:67], v9, s[6:7]
    global_load_dwordx4 v[68:71], v10, s[6:7]
    global_load_dwordx4 v[72:75], v11, s[6:7]
    global_load_dwordx4 v[76:79], v12, s[8:9]
    global_load_dwordx4 v[80:83], v13, s[8:9]
    global_load_dwordx4 v[84:87], v14, s[8:9]
    global_load_dwordx4 v[88:91], v15, s[8:9]
    s_add_u32 s6, s6, 128
    s_addc_u32 s7, s7, 0
    s_add_u32 s8, s8, 128
    s_addc_u32 s9, s9, 0
    ds_read_b128 v[124:127], v22 offset:0
    ds_read_b128 v[128:131], v22 offset:4608
    ds_read_b128 v[132:135], v23 offset:0
    ds_read_b128 v[136:139], v23 offset:4608
    ds_read_b128 v[140:143], v22 offset:32
    ds_read_b128 v[144:147], v22 offset:4640
    ds_read_b128 v[148:151], v23 offset:32
    ds_read_b128 v[152:155], v23 offset:4640
    s_waitcnt lgkmcnt(4)
    v_mfma_f32_32x32x16_bf16 a[0:15], v[132:135], v[124:127], a[0:15]
    v_mfma_f32_32x32x16_bf16 a[16:31], v[136:139], v[124:127], a[16:31]
    v_mfma_f32_32x32x16_bf16 a[32:47], v[132:135], v[128:131], a[32:47]
    v_mfma_f32_32x32x16_bf16 a[48:63], v[136:139], v[128:131], a[48:63]
    ds_read_b128 v[124:127], v22 offset:64
    ds_read_b128 v[128:131], v22 offset:4672
    ds_read_b128 v[132:135], v23 offset:64
    ds_read_b128 v[136:139], v23 offset:4672
    s_waitcnt lgkmcnt(4)
    v_mfma_f32_32x32x16_bf16 a[0:15], v[148:151], v[140:143], a[0:15]
    v_mfma_f32_32x32x16_bf16 a[16:31], v[152:155], v[140:143], a[16:31]
    v_mfma_f32_32x32x16_bf16 a[32:47], v[148:151], v[144:147], a[32:47]
    v_mfma_f32_32x32x16_bf16 a[48:63], v[152:155], v[144:147], a[48:63]
    ds_read_b128 v[140:143], v22 offset:96
    ds_read_b128 v[144:147], v22 offset:4704
    ds_read_b128 v[148:151], v23 offset:96
    ds_read_b128 v[152:155], v23 offset:4704
    s_waitcnt lgkmcnt(4)
    v_mfma_f32_32x32x16_bf16 a[0:15], v[132:135], v[124:127], a[0:15]
    v_mfma_f32_32x32x16_bf16 a[16:31], v[136:139], v[124:127], a[16:31]
    v_mfma_f32_32x32x16_bf16 a[32:47], v[132:135], v[128:131], a[32:47]
    v_mfma_f32_32x32x16_bf16 a[48:63], v[136:139], v[128:131], a[48:63]
    s_waitcnt lgkmcnt(0)
    v_mfma_f32_32x32x16_bf16 a[0:15], v[148:151], v[140:143], a[0:15]
    v_mfma_f32_32x32x16_bf16 a[16:31], v[152:155], v[140:143], a[16:31]
    v_mfma_f32_32x32x16_bf16 a[32:47], v[148:151], v[144:147], a[32:47]
    v_mfma_f32_32x32x16_bf16 a[48:63], v[152:155], v[144:147], a[48:63]
    s_waitcnt vmcnt(16)
    ds_write_b128 v16, v[92:95] offset:0
    ds_write_b128 v16, v[96:99] offset:4608
    ds_write_b128 v16, v[100:103] offset:9216
    ds_write_b128 v16, v[104:107] offset:13824
    ds_write_b128 v17, v[108:111] offset:0
    ds_write_b128 v17, v[112:115] offset:4608
    ds_write_b128 v17, v[116:119] offset:9216
    ds_write_b128 v17, v[120:123] offset:13824
    s_waitcnt lgkmcnt(0)
    s_barrier
    global_load_dwordx4 v[92:95], v8, s[6:7]
    global_load_dwordx4 v[96:99], v9, s[6:7]
    global_load_dwordx4 v[100:103], v10, s[6:7]
    global_load_dwordx4 v[104:107], v11, s[6:7]
    global_load_dwordx4 v[108:111], v12, s[8:9]
    global_load_dwordx4 v[112:115], v13, s[8:9]
    global_load_dwordx4 v[116:119], v14, s[8:9]
    global_load_dwordx4 v[120:123], v15, s[8:9]
    s_add_u32 s6, s6, 128
    s_addc_u32 s7, s7, 0
    s_add_u32 s8, s8, 128
    s_addc_u32 s9, s9, 0
    ds_read_b128 v[124:127], v18 offset:0
    ds_read_b128 v[128:131], v18 offset:4608
    ds_read_b128 v[132:135], v19 offset:0
    ds_read_b128 v[136:139], v19 offset:4608
    ds_read_b128 v[140:143], v18 offset:32
    ds_read_b128 v[144:147], v18 offset:4640
    ds_read_b128 v[148:151], v19 offset:32
    ds_read_b128 v[152:155], v19 offset:4640
    s_waitcnt lgkmcnt(4)
    v_mfma_f32_32x32x16_bf16 a[0:15], v[132:135], v[124:127], a[0:15]
    v_mfma_f32_32x32x16_bf16 a[16:31], v[136:139], v[124:127], a[16:31]
    v_mfma_f32_32x32x16_bf16 a[32:47], v[132:135], v[128:131], a[32:47]
    v_mfma_f32_32x32x16_bf16 a[48:63], v[136:139], v[128:131], a[48:63]
    ds_read_b128 v[124:127], v18 offset:64
    ds_read_b128 v[128:131], v18 offset:4672
    ds_read_b128 v[132:135], v19 offset:64
    ds_read_b128 v[136:139], v19 offset:4672
    s_waitcnt lgkmcnt(4)
    v_mfma_f32_32x32x16_bf16 a[0:15], v[148:151], v[140:143], a[0:15]
    v_mfma_f32_32x32x16_bf16 a[16:31], v[152:155], v[140:143], a[16:31]
    v_mfma_f32_32x32x16_bf16 a[32:47], v[148:151], v[144:147], a[32:47]
    v_mfma_f32_32x32x16_bf16 a[48:63], v[152:155], v[144:147], a[48:63]
    ds_read_b128 v[140:143], v18 offset:96
    ds_read_b128 v[144:147], v18 offset:4704
    ds_read_b128 v[148:151], v19 offset:96
    ds_read_b128 v[152:155], v19 offset:4704
    s_waitcnt lgkmcnt(4)
    v_mfma_f32_32x32x16_bf16 a[0:15], v[132:135], v[124:127], a[0:15]
    v_mfma_f32_32x32x16_bf16 a[16:31], v[136:139], v[124:127], a[16:31]
    v_mfma_f32_32x32x16_bf16 a[32:47], v[132:135], v[128:131], a[32:47]
    v_mfma_f32_32x32x16_bf16 a[48:63], v[136:139], v[128:131], a[48:63]
    s_waitcnt lgkmcnt(0)
    v_mfma_f32_32x32x16_bf16 a[0:15], v[148:151], v[140:143], a[0:15]
    v_mfma_f32_32x32x16_bf16 a[16:31], v[152:155], v[140:143], a[16:31]
    v_mfma_f32_32x32x16_bf16 a[32:47], v[148:151], v[144:147], a[32:47]
    v_mfma_f32_32x32x16_bf16 a[48:63], v[152:155], v[144:147], a[48:63]
    s_waitcnt vmcnt(16)
    ds_write_b128 v20, v[28:31] offset:0
    ds_write_b128 v20, v[32:35] offset:4608
    ds_write_b128 v20, v[36:39] offset:9216
    ds_write_b128 v20, v[40:43] offset:13824
    ds_write_b128 v21, v[44:47] offset:0
    ds_write_b128 v21, v[48:51] offset:4608
    ds_write_b128 v21, v[52:55] offset:9216
    ds_write_b128 v21, v[56:59] offset:13824
    s_waitcnt lgkmcnt(0)
    s_barrier
    global_load_dwordx4 v[28:31], v8, s[6:7]
    global_load_dwordx4 v[32:35], v9, s[6:7]
    global_load_dwordx4 v[36:39], v10, s[6:7]
    global_load_dwordx4 v[40:43], v11, s[6:7]
    global_load_dwordx4 v[44:47], v12, s[8:9]
    global_load_dwordx4 v[48:51], v13, s[8:9]
    global_load_dwordx4 v[52:55], v14, s[8:9]
    global_load_dwordx4 v[56:59], v15, s[8:9]
    s_add_u32 s6, s6, 128
    s_addc_u32 s7, s7, 0
    s_add_u32 s8, s8, 128
    s_addc_u32 s9, s9, 0
    ds_read_b128 v[124:127], v22 offset:0
    ds_read_b128 v[128:131], v22 offset:4608
    ds_read_b128 v[132:135], v23 offset:0
    ds_read_b128 v[136:139], v23 offset:4608
    ds_read_b128 v[140:143], v22 offset:32
    ds_read_b128 v[144:147], v22 offset:4640
    ds_read_b128 v[148:151], v23 offset:32
    ds_read_b128 v[152:155], v23 offset:4640
    s_waitcnt lgkmcnt(4)
    v_mfma_f32_32x32x16_bf16 a[0:15], v[132:135], v[124:127], a[0:15]
    v_mfma_f32_32x32x16_bf16 a[16:31], v[136:139], v[124:127], a[16:31]
    v_mfma_f32_32x32x16_bf16 a[32:47], v[132:135], v[128:131], a[32:47]
    v_mfma_f32_32x32x16_bf16 a[48:63], v[136:139], v[128:131], a[48:63]
    ds_read_b128 v[124:127], v22 offset:64
    ds_read_b128 v[128:131], v22 offset:4672
    ds_read_b128 v[132:135], v23 offset:64
    ds_read_b128 v[136:139], v23 offset:4672
    s_waitcnt lgkmcnt(4)
    v_mfma_f32_32x32x16_bf16 a[0:15], v[148:151], v[140:143], a[0:15]
    v_mfma_f32_32x32x16_bf16 a[16:31], v[152:155], v[140:143], a[16:31]
    v_mfma_f32_32x32x16_bf16 a[32:47], v[148:151], v[144:147], a[32:47]
    v_mfma_f32_32x32x16_bf16 a[48:63], v[152:155], v[144:147], a[48:63]
    ds_read_b128 v[140:143], v22 offset:96
    ds_read_b128 v[144:147], v22 offset:4704
    ds_read_b128 v[148:151], v23 offset:96
    ds_read_b128 v[152:155], v23 offset:4704
    s_waitcnt lgkmcnt(4)
    v_mfma_f32_32x32x16_bf16 a[0:15], v[132:135], v[124:127], a[0:15]
    v_mfma_f32_32x32x16_bf16 a[16:31], v[136:139], v[124:127], a[16:31]
    v_mfma_f32_32x32x16_bf16 a[32:47], v[132:135], v[128:131], a[32:47]
    v_mfma_f32_32x32x16_bf16 a[48:63], v[136:139], v[128:131], a[48:63]
    s_waitcnt lgkmcnt(0)
    v_mfma_f32_32x32x16_bf16 a[0:15], v[148:151], v[140:143], a[0:15]
    v_mfma_f32_32x32x16_bf16 a[16:31], v[152:155], v[140:143], a[16:31]
    v_mfma_f32_32x32x16_bf16 a[32:47], v[148:151], v[144:147], a[32:47]
    v_mfma_f32_32x32x16_bf16 a[48:63], v[152:155], v[144:147], a[48:63]
    s_waitcnt vmcnt(16)
    ds_write_b128 v16, v[60:63] offset:0
    ds_write_b128 v16, v[64:67] offset:4608
    ds_write_b128 v16, v[68:71] offset:9216
    ds_write_b128 v16, v[72:75] offset:13824
    ds_write_b128 v17, v[76:79] offset:0
    ds_write_b128 v17, v[80:83] offset:4608
    ds_write_b128 v17, v[84:87] offset:9216
    ds_write_b128 v17, v[88:91] offset:13824
    s_waitcnt lgkmcnt(0)
    s_barrier
    ds_read_b128 v[124:127], v18 offset:0
    ds_read_b128 v[128:131], v18 offset:4608
    ds_read_b128 v[132:135], v19 offset:0
    ds_read_b128 v[136:139], v19 offset:4608
    ds_read_b128 v[140:143], v18 offset:32
    ds_read_b128 v[144:147], v18 offset:4640
    ds_read_b128 v[148:151], v19 offset:32
    ds_read_b128 v[152:155], v19 offset:4640
    s_waitcnt lgkmcnt(4)
    v_mfma_f32_32x32x16_bf16 a[0:15], v[132:135], v[124:127], a[0:15]
    v_mfma_f32_32x32x16_bf16 a[16:31], v[136:139], v[124:127], a[16:31]
    v_mfma_f32_32x32x16_bf16 a[32:47], v[132:135], v[128:131], a[32:47]
    v_mfma_f32_32x32x16_bf16 a[48:63], v[136:139], v[128:131], a[48:63]
    ds_read_b128 v[124:127], v18 offset:64
    ds_read_b128 v[128:131], v18 offset:4672
    ds_read_b128 v[132:135], v19 offset:64
    ds_read_b128 v[136:139], v19 offset:4672
    s_waitcnt lgkmcnt(4)
    v_mfma_f32_32x32x16_bf16 a[0:15], v[148:151], v[140:143], a[0:15]
    v_mfma_f32_32x32x16_bf16 a[16:31], v[152:155], v[140:143], a[16:31]
    v_mfma_f32_32x32x16_bf16 a[32:47], v[148:151], v[144:147], a[32:47]
    v_mfma_f32_32x32x16_bf16 a[48:63], v[152:155], v[144:147], a[48:63]
    ds_read_b128 v[140:143], v18 offset:96
    ds_read_b128 v[144:147], v18 offset:4704
    ds_read_b128 v[148:151], v19 offset:96
    ds_read_b128 v[152:155], v19 offset:4704
    s_waitcnt lgkmcnt(4)
    v_mfma_f32_32x32x16_bf16 a[0:15], v[132:135], v[124:127], a[0:15]
    v_mfma_f32_32x32x16_bf16 a[16:31], v[136:139], v[124:127], a[16:31]
    v_mfma_f32_32x32x16_bf16 a[32:47], v[132:135], v[128:131], a[32:47]
    v_mfma_f32_32x32x16_bf16 a[48:63], v[136:139], v[128:131], a[48:63]
    s_waitcnt lgkmcnt(0)
    v_mfma_f32_32x32x16_bf16 a[0:15], v[148:151], v[140:143], a[0:15]
    v_mfma_f32_32x32x16_bf16 a[16:31], v[152:155], v[140:143], a[16:31]
    v_mfma_f32_32x32x16_bf16 a[32:47], v[148:151], v[144:147], a[32:47]
    v_mfma_f32_32x32x16_bf16 a[48:63], v[152:155], v[144:147], a[48:63]
    s_waitcnt vmcnt(8)
    ds_write_b128 v20, v[92:95] offset:0
    ds_write_b128 v20, v[96:99] offset:4608
    ds_write_b128 v20, v[100:103] offset:9216
    ds_write_b128 v20, v[104:107] offset:13824
    ds_write_b128 v21, v[108:111] offset:0
    ds_write_b128 v21, v[112:115] offset:4608
    ds_write_b128 v21, v[116:119] offset:9216
    ds_write_b128 v21, v[120:123] offset:13824
    s_waitcnt lgkmcnt(0)
    s_barrier
    ds_read_b128 v[124:127], v22 offset:0
    ds_read_b128 v[128:131], v22 offset:4608
    ds_read_b128 v[132:135], v23 offset:0
    ds_read_b128 v[136:139], v23 offset:4608
    ds_read_b128 v[140:143], v22 offset:32
    ds_read_b128 v[144:147], v22 offset:4640
    ds_read_b128 v[148:151], v23 offset:32
    ds_read_b128 v[152:155], v23 offset:4640
    s_waitcnt lgkmcnt(4)
    v_mfma_f32_32x32x16_bf16 a[0:15], v[132:135], v[124:127], a[0:15]
    v_mfma_f32_32x32x16_bf16 a[16:31], v[136:139], v[124:127], a[16:31]
    v_mfma_f32_32x32x16_bf16 a[32:47], v[132:135], v[128:131], a[32:47]
    v_mfma_f32_32x32x16_bf16 a[48:63], v[136:139], v[128:131], a[48:63]
    ds_read_b128 v[124:127], v22 offset:64
    ds_read_b128 v[128:131], v22 offset:4672
    ds_read_b128 v[132:135], v23 offset:64
    ds_read_b128 v[136:139], v23 offset:4672
    s_waitcnt lgkmcnt(4)
    v_mfma_f32_32x32x16_bf16 a[0:15], v[148:151], v[140:143], a[0:15]
    v_mfma_f32_32x32x16_bf16 a[16:31], v[152:155], v[140:143], a[16:31]
    v_mfma_f32_32x32x16_bf16 a[32:47], v[148:151], v[144:147], a[32:47]
    v_mfma_f32_32x32x16_bf16 a[48:63], v[152:155], v[144:147], a[48:63]
    ds_read_b128 v[140:143], v22 offset:96
    ds_read_b128 v[144:147], v22 offset:4704
    ds_read_b128 v[148:151], v23 offset:96
    ds_read_b128 v[152:155], v23 offset:4704
    s_waitcnt lgkmcnt(4)
    v_mfma_f32_32x32x16_bf16 a[0:15], v[132:135], v[124:127], a[0:15]
    v_mfma_f32_32x32x16_bf16 a[16:31], v[136:139], v[124:127], a[16:31]
    v_mfma_f32_32x32x16_bf16 a[32:47], v[132:135], v[128:131], a[32:47]
    v_mfma_f32_32x32x16_bf16 a[48:63], v[136:139], v[128:131], a[48:63]
    s_waitcnt lgkmcnt(0)
    v_mfma_f32_32x32x16_bf16 a[0:15], v[148:151], v[140:143], a[0:15]
    v_mfma_f32_32x32x16_bf16 a[16:31], v[152:155], v[140:143], a[16:31]
    v_mfma_f32_32x32x16_bf16 a[32:47], v[148:151], v[144:147], a[32:47]
    v_mfma_f32_32x32x16_bf16 a[48:63], v[152:155], v[144:147], a[48:63]
    s_waitcnt vmcnt(0)
    ds_write_b128 v16, v[28:31] offset:0
    ds_write_b128 v16, v[32:35] offset:4608
    ds_write_b128 v16, v[36:39] offset:9216
    ds_write_b128 v16, v[40:43] offset:13824
    ds_write_b128 v17, v[44:47] offset:0
    ds_write_b128 v17, v[48:51] offset:4608
    ds_write_b128 v17, v[52:55] offset:9216
    ds_write_b128 v17, v[56:59] offset:13824
    s_waitcnt lgkmcnt(0)
    s_barrier
    ds_read_b128 v[124:127], v18 offset:0
    ds_read_b128 v[128:131], v18 offset:4608
    ds_read_b128 v[132:135], v19 offset:0
    ds_read_b128 v[136:139], v19 offset:4608
    ds_read_b128 v[140:143], v18 offset:32
    ds_read_b128 v[144:147], v18 offset:4640
    ds_read_b128 v[148:151], v19 offset:32
    ds_read_b128 v[152:155], v19 offset:4640
    s_waitcnt lgkmcnt(4)
    v_mfma_f32_32x32x16_bf16 a[0:15], v[132:135], v[124:127], a[0:15]
    v_mfma_f32_32x32x16_bf16 a[16:31], v[136:139], v[124:127], a[16:31]
    v_mfma_f32_32x32x16_bf16 a[32:47], v[132:135], v[128:131], a[32:47]
    v_mfma_f32_32x32x16_bf16 a[48:63], v[136:139], v[128:131], a[48:63]
    ds_read_b128 v[124:127], v18 offset:64
    ds_read_b128 v[128:131], v18 offset:4672
    ds_read_b128 v[132:135], v19 offset:64
    ds_read_b128 v[136:139], v19 offset:4672
    s_waitcnt lgkmcnt(4)
    v_mfma_f32_32x32x16_bf16 a[0:15], v[148:151], v[140:143], a[0:15]
    v_mfma_f32_32x32x16_bf16 a[16:31], v[152:155], v[140:143], a[16:31]
    v_mfma_f32_32x32x16_bf16 a[32:47], v[148:151], v[144:147], a[32:47]
    v_mfma_f32_32x32x16_bf16 a[48:63], v[152:155], v[144:147], a[48:63]
    ds_read_b128 v[140:143], v18 offset:96
    ds_read_b128 v[144:147], v18 offset:4704
    ds_read_b128 v[148:151], v19 offset:96
    ds_read_b128 v[152:155], v19 offset:4704
    s_waitcnt lgkmcnt(4)
    v_mfma_f32_32x32x16_bf16 a[0:15], v[132:135], v[124:127], a[0:15]
    v_mfma_f32_32x32x16_bf16 a[16:31], v[136:139], v[124:127], a[16:31]
    v_mfma_f32_32x32x16_bf16 a[32:47], v[132:135], v[128:131], a[32:47]
    v_mfma_f32_32x32x16_bf16 a[48:63], v[136:139], v[128:131], a[48:63]
    s_waitcnt lgkmcnt(0)
    v_mfma_f32_32x32x16_bf16 a[0:15], v[148:151], v[140:143], a[0:15]
    v_mfma_f32_32x32x16_bf16 a[16:31], v[152:155], v[140:143], a[16:31]
    v_mfma_f32_32x32x16_bf16 a[32:47], v[148:151], v[144:147], a[32:47]
    v_mfma_f32_32x32x16_bf16 a[48:63], v[152:155], v[144:147], a[48:63]
    s_nop 15
    v_and_b32 v4, 31, v1
    v_lshrrev_b32 v5, 5, v1
    s_mul_i32 s31, s25, 64
    s_add_u32 s31, s31, s27
    v_add_u32 v4, s31, v4
    s_mul_i32 s36, s26, 64
    s_add_u32 s36, s36, s28
    v_lshlrev_b32 v5, 2, v5
    v_add_u32 v5, s36, v5
    s_mov_b32 s37, 14336
    v_mul_lo_u32 v6, v4, s37
    v_lshl_add_u32 v6, v5, 1, v6
    v_lshrrev_b32 v6, 4, v4
    v_mul_u32_u24 v6, 224, v6
    s_lshr_b32 s38, s36, 5
    v_add_u32 v6, s38, v6
    v_lshlrev_b32 v6, 6, v6
    v_and_b32 v7, 15, v4
    v_add_u32 v6, v6, v7
    v_lshlrev_b32 v6, 4, v6
    v_lshrrev_b32 v7, 5, v1
    v_lshl_add_u32 v6, v7, 3, v6
    v_accvgpr_read_b32 v28, a0
    v_accvgpr_read_b32 v29, a1
    v_accvgpr_read_b32 v30, a2
    v_accvgpr_read_b32 v31, a3
    v_cvt_pk_bf16_f32 v32, v28, v29
    v_cvt_pk_bf16_f32 v33, v30, v31
    global_store_dwordx2 v6, v[32:33], s[10:11] offset:0 sc1
    v_accvgpr_read_b32 v44, a4
    v_accvgpr_read_b32 v45, a5
    v_accvgpr_read_b32 v46, a6
    v_accvgpr_read_b32 v47, a7
    v_cvt_pk_bf16_f32 v48, v44, v45
    v_cvt_pk_bf16_f32 v49, v46, v47
    global_store_dwordx2 v6, v[48:49], s[10:11] offset:256 sc1
    v_accvgpr_read_b32 v60, a8
    v_accvgpr_read_b32 v61, a9
    v_accvgpr_read_b32 v62, a10
    v_accvgpr_read_b32 v63, a11
    v_cvt_pk_bf16_f32 v64, v60, v61
    v_cvt_pk_bf16_f32 v65, v62, v63
    global_store_dwordx2 v6, v[64:65], s[10:11] offset:512 sc1
    v_accvgpr_read_b32 v76, a12
    v_accvgpr_read_b32 v77, a13
    v_accvgpr_read_b32 v78, a14
    v_accvgpr_read_b32 v79, a15
    v_cvt_pk_bf16_f32 v80, v76, v77
    v_cvt_pk_bf16_f32 v81, v78, v79
    global_store_dwordx2 v6, v[80:81], s[10:11] offset:768 sc1
    v_accvgpr_read_b32 v28, a16
    v_accvgpr_read_b32 v29, a17
    v_accvgpr_read_b32 v30, a18
    v_accvgpr_read_b32 v31, a19
    v_cvt_pk_bf16_f32 v32, v28, v29
    v_cvt_pk_bf16_f32 v33, v30, v31
    global_store_dwordx2 v6, v[32:33], s[10:11] offset:1024 sc1
    v_accvgpr_read_b32 v44, a20
    v_accvgpr_read_b32 v45, a21
    v_accvgpr_read_b32 v46, a22
    v_accvgpr_read_b32 v47, a23
    v_cvt_pk_bf16_f32 v48, v44, v45
    v_cvt_pk_bf16_f32 v49, v46, v47
    global_store_dwordx2 v6, v[48:49], s[10:11] offset:1280 sc1
    v_accvgpr_read_b32 v60, a24
    v_accvgpr_read_b32 v61, a25
    v_accvgpr_read_b32 v62, a26
    v_accvgpr_read_b32 v63, a27
    v_cvt_pk_bf16_f32 v64, v60, v61
    v_cvt_pk_bf16_f32 v65, v62, v63
    global_store_dwordx2 v6, v[64:65], s[10:11] offset:1536 sc1
    v_accvgpr_read_b32 v76, a28
    v_accvgpr_read_b32 v77, a29
    v_accvgpr_read_b32 v78, a30
    v_accvgpr_read_b32 v79, a31
    v_cvt_pk_bf16_f32 v80, v76, v77
    v_cvt_pk_bf16_f32 v81, v78, v79
    global_store_dwordx2 v6, v[80:81], s[10:11] offset:1792 sc1
    v_add_u32 v6, 458752, v6
    v_accvgpr_read_b32 v28, a32
    v_accvgpr_read_b32 v29, a33
    v_accvgpr_read_b32 v30, a34
    v_accvgpr_read_b32 v31, a35
    v_cvt_pk_bf16_f32 v32, v28, v29
    v_cvt_pk_bf16_f32 v33, v30, v31
    global_store_dwordx2 v6, v[32:33], s[10:11] offset:0 sc1
    v_accvgpr_read_b32 v44, a36
    v_accvgpr_read_b32 v45, a37
    v_accvgpr_read_b32 v46, a38
    v_accvgpr_read_b32 v47, a39
    v_cvt_pk_bf16_f32 v48, v44, v45
    v_cvt_pk_bf16_f32 v49, v46, v47
    global_store_dwordx2 v6, v[48:49], s[10:11] offset:256 sc1
    v_accvgpr_read_b32 v60, a40
    v_accvgpr_read_b32 v61, a41
    v_accvgpr_read_b32 v62, a42
    v_accvgpr_read_b32 v63, a43
    v_cvt_pk_bf16_f32 v64, v60, v61
    v_cvt_pk_bf16_f32 v65, v62, v63
    global_store_dwordx2 v6, v[64:65], s[10:11] offset:512 sc1
    v_accvgpr_read_b32 v76, a44
    v_accvgpr_read_b32 v77, a45
    v_accvgpr_read_b32 v78, a46
    v_accvgpr_read_b32 v79, a47
    v_cvt_pk_bf16_f32 v80, v76, v77
    v_cvt_pk_bf16_f32 v81, v78, v79
    global_store_dwordx2 v6, v[80:81], s[10:11] offset:768 sc1
    v_accvgpr_read_b32 v28, a48
    v_accvgpr_read_b32 v29, a49
    v_accvgpr_read_b32 v30, a50
    v_accvgpr_read_b32 v31, a51
    v_cvt_pk_bf16_f32 v32, v28, v29
    v_cvt_pk_bf16_f32 v33, v30, v31
    global_store_dwordx2 v6, v[32:33], s[10:11] offset:1024 sc1
    v_accvgpr_read_b32 v44, a52
    v_accvgpr_read_b32 v45, a53
    v_accvgpr_read_b32 v46, a54
    v_accvgpr_read_b32 v47, a55
    v_cvt_pk_bf16_f32 v48, v44, v45
    v_cvt_pk_bf16_f32 v49, v46, v47
    global_store_dwordx2 v6, v[48:49], s[10:11] offset:1280 sc1
    v_accvgpr_read_b32 v60, a56
    v_accvgpr_read_b32 v61, a57
    v_accvgpr_read_b32 v62, a58
    v_accvgpr_read_b32 v63, a59
    v_cvt_pk_bf16_f32 v64, v60, v61
    v_cvt_pk_bf16_f32 v65, v62, v63
    global_store_dwordx2 v6, v[64:65], s[10:11] offset:1536 sc1
    v_accvgpr_read_b32 v76, a60
    v_accvgpr_read_b32 v77, a61
    v_accvgpr_read_b32 v78, a62
    v_accvgpr_read_b32 v79, a63
    v_cvt_pk_bf16_f32 v80, v76, v77
    v_cvt_pk_bf16_f32 v81, v78, v79
    global_store_dwordx2 v6, v[80:81], s[10:11] offset:1792 sc1
    s_lshl_b32 s22, s22, 6
    s_waitcnt vmcnt(0)
    s_barrier
    s_add_u32 s94, s4, 0x6bd3400
    s_addc_u32 s95, s5, 0
    v_mov_b32 v2, s22
    v_mov_b32 v3, 1
    v_cmp_eq_u32 vcc, 0, v0
    s_and_saveexec_b64 s[88:89], vcc
    s_cbranch_execz sg_g3_5
    global_atomic_add v2, v3, s[94:95] sc1
sg_g3_5:
    s_mov_b64 exec, s[88:89]
end_g3_1:
    s_barrier
    s_add_u32 s90, s90, 224
    s_cmp_lt_u32 s90, 896
    s_cbranch_scc1 wl_chain_35
sk_chain_36:
    s_sub_u32 s90, s91, 0
    s_cmp_ge_u32 s90, 128
    s_cbranch_scc1 sk_chain_38
wl_chain_37:
    s_mov_b32 s2, s90
    s_cmp_ge_u32 s2, 128
    s_cbranch_scc1 end_attn_1
    s_and_b32 s60, s2, 1
    s_lshr_b32 s2, s2, 1
    s_load_dwordx2 s[4:5], s[0:1], 128
    s_load_dwordx2 s[6:7], s[0:1], 0
    v_and_b32 v1, 63, v0
    v_lshrrev_b32 v2, 6, v0
    s_nop 0
    v_readfirstlane_b32 s10, v2
    v_and_b32 v2, 15, v1
    v_lshrrev_b32 v3, 4, v1
    v_lshlrev_b32 v9, 4, v1
    v_add_u32 v5, 4096, v9
    v_add_u32 v6, 8192, v9
    v_add_u32 v7, 12288, v9
    v_cmp_gt_u32 s[40:41], 32, v1
    v_lshlrev_b32 v10, 2, v3
    v_add_u32 v11, 0, v10
    v_cmp_le_u32 s[42:43], v11, v2
    v_add_u32 v11, 1, v10
    v_cmp_le_u32 s[44:45], v11, v2
    v_add_u32 v11, 2, v10
    v_cmp_le_u32 s[46:47], v11, v2
    v_add_u32 v11, 3, v10
    v_cmp_le_u32 s[48:49], v11, v2
    s_waitcnt lgkmcnt(0)
    s_lshr_b32 s62, s2, 2
    s_lshl_b32 s62, s62, 6
    s_lshl_b32 s63, s2, 2
    s_cmp_lg_u32 s10, 0
    s_cbranch_scc1 wo_attn_4
    s_add_u32 s94, s4, 0x6bd3400
    s_addc_u32 s95, s5, 0
    v_mov_b32 v10, s62
wc_attn_2:
    global_load_dword v11, v10, s[94:95] sc1
    s_add_u32 s92, s92, 1
    s_cmp_gt_u32 s92, 524288
    s_cbranch_scc1 wd_attn_3
    s_waitcnt vmcnt(0)
    v_cmp_gt_u32 vcc, 56, v11
    s_nop 1
    s_cbranch_vccz wd_attn_3
    s_sleep 2
    s_branch wc_attn_2
wd_attn_3:
wo_attn_4:
    s_barrier
    s_cmp_lg_u32 s10, 0
    s_cbranch_scc1 wo_attn_7
    s_add_u32 s94, s4, 0x6bd3000
    s_addc_u32 s95, s5, 0
    v_mov_b32 v10, s62
wc_attn_5:
    global_load_dword v11, v10, s[94:95] sc1
    s_add_u32 s92, s92, 1
    s_cmp_gt_u32 s92, 524288
    s_cbranch_scc1 wd_attn_6
    s_waitcnt vmcnt(0)
    v_cmp_gt_u32 vcc, 56, v11
    s_nop 1
    s_cbranch_vccz wd_attn_6
    s_sleep 2
    s_branch wc_attn_5
wd_attn_6:
    buffer_inv sc1
    s_waitcnt vmcnt(0)
wo_attn_7:
    s_barrier
    s_lshl_b32 s20, s2, 13
    s_add_u32 s20, s20, 0x6bd5000
    v_and_b32 v14, 7, v1
    v_lshlrev_b32 v14, 4, v14
    v_lshl_add_u32 v14, v3, 7, v14
    v_add_u32 v15, 4096, v14
    s_add_u32 s30, s4, s20
    s_addc_u32 s31, s5, 0
    s_mul_i32 s20, s2, 28672
    s_add_u32 s20, s20, 0x4ed3000
    s_add_u32 s32, s4, s20
    s_addc_u32 s33, s5, 0
    s_add_u32 s34, s32, 14336
    s_addc_u32 s35, s33, 0
    s_mul_i32 s20, s2, 458752
    s_mul_i32 s21, s10, 57344
    s_add_u32 s20, s20, s21
    s_mul_i32 s21, s60, 229376
    s_add_u32 s20, s20, s21
    s_add_u32 s20, s20, 0x1493000
    s_add_u32 s36, s4, s20
    s_addc_u32 s37, s5, 0
    s_lshl_b32 s20, s10, 12
    v_add_u32 v12, s20, v9
    s_lshl_b32 s20, s10, 11
    s_add_u32 s20, s20, 16384
    v_add_u32 v13, s20, v9
    s_mul_i32 s20, s2, 458752
    s_mul_i32 s21, s10, 7168
    s_add_u32 s20, s20, s21
    s_add_u32 s20, s20, 0x3093000
    s_add_u32 s52, s4, s20
    s_addc_u32 s53, s5, 0
    s_mul_i32 s20, s2, 114688
    s_lshr_b32 s21, s21, 1
    s_add_u32 s20, s20, s21
    v_and_b32 v16, 31, v1
    v_lshlrev_b32 v16, 4, v16
    s_add_u32 s20, s20, 0x5193000
    s_add_u32 s50, s4, s20
    s_addc_u32 s51, s5, 0
    v_mov_b32 v60, 0xf149f2ca
    v_mov_b32 v61, 0x3fb8aa3b
    s_cmp_eq_u32 s60, 1
    s_cbranch_scc1 it1_attn_8
    global_load_dwordx4 v[120:123], v9, s[32:33] offset:0
    global_load_dwordx4 v[124:127], v9, s[32:33] offset:1024
    global_load_dwordx4 v[128:131], v9, s[32:33] offset:2048
    global_load_dwordx4 v[132:135], v9, s[32:33] offset:3072
    global_load_dwordx4 v[136:139], v5, s[32:33] offset:0
    global_load_dwordx4 v[140:143], v5, s[32:33] offset:1024
    global_load_dwordx4 v[144:147], v5, s[32:33] offset:2048
    global_load_dwordx4 v[148:151], v5, s[32:33] offset:3072
    global_load_dwordx4 v[152:155], v6, s[32:33] offset:0
    global_load_dwordx4 v[156:159], v6, s[32:33] offset:1024
    global_load_dwordx4 v[160:163], v6, s[32:33] offset:2048
    global_load_dwordx4 v[164:167], v6, s[32:33] offset:3072
    global_load_dwordx4 v[168:171], v7, s[32:33] offset:0
    global_load_dwordx4 v[172:175], v7, s[32:33] offset:1024
    s_add_u32 s38, s36, 0
    s_addc_u32 s39, s37, 0
    global_load_dwordx4 a[0:3], v9, s[38:39] offset:0
    global_load_dwordx4 a[4:7], v9, s[38:39] offset:1024
    global_load_dwordx4 a[8:11], v9, s[38:39] offset:2048
    global_load_dwordx4 a[12:15], v9, s[38:39] offset:3072
    global_load_dwordx4 a[16:19], v5, s[38:39] offset:0
    global_load_dwordx4 a[20:23], v5, s[38:39] offset:1024
    global_load_dwordx4 a[24:27], v5, s[38:39] offset:2048
    global_load_dwordx4 a[28:31], v5, s[38:39] offset:3072
    global_load_dwordx4 a[32:35], v6, s[38:39] offset:0
    global_load_dwordx4 a[36:39], v6, s[38:39] offset:1024
    global_load_dwordx4 a[40:43], v6, s[38:39] offset:2048
    global_load_dwordx4 a[44:47], v6, s[38:39] offset:3072
    global_load_dwordx4 a[48:51], v7, s[38:39] offset:0
    global_load_dwordx4 a[52:55], v7, s[38:39] offset:1024
    s_add_u32 s38, s36, 14336
    s_addc_u32 s39, s37, 0
    global_load_dwordx4 a[56:59], v9, s[38:39] offset:0
    global_load_dwordx4 a[60:63], v9, s[38:39] offset:1024
    global_load_dwordx4 a[64:67], v9, s[38:39] offset:2048
    global_load_dwordx4 a[68:71], v9, s[38:39] offset:3072
    global_load_dwordx4 a[72:75], v5, s[38:39] offset:0
    global_load_dwordx4 a[76:79], v5, s[38:39] offset:1024
    global_load_dwordx4 a[80:83], v5, s[38:39] offset:2048
    global_load_dwordx4 a[84:87], v5, s[38:39] offset:3072
    global_load_dwordx4 a[88:91], v6, s[38:39] offset:0
    global_load_dwordx4 a[92:95], v6, s[38:39] offset:1024
    global_load_dwordx4 a[96:99], v6, s[38:39] offset:2048
    global_load_dwordx4 a[100:103], v6, s[38:39] offset:3072
    global_load_dwordx4 a[104:107], v7, s[38:39] offset:0
    global_load_dwordx4 a[108:111], v7, s[38:39] offset:1024
    s_add_u32 s38, s36, 28672
    s_addc_u32 s39, s37, 0
    global_load_dwordx4 a[112:115], v9, s[38:39] offset:0
    global_load_dwordx4 a[116:119], v9, s[38:39] offset:1024
    global_load_dwordx4 a[120:123], v9, s[38:39] offset:2048
    global_load_dwordx4 a[124:127], v9, s[38:39] offset:3072
    global_load_dwordx4 a[128:131], v5, s[38:39] offset:0
    global_load_dwordx4 a[132:135], v5, s[38:39] offset:1024
    global_load_dwordx4 a[136:139], v5, s[38:39] offset:2048
    global_load_dwordx4 a[140:143], v5, s[38:39] offset:3072
    global_load_dwordx4 a[144:147], v6, s[38:39] offset:0
    global_load_dwordx4 a[148:151], v6, s[38:39] offset:1024
    global_load_dwordx4 a[152:155], v6, s[38:39] offset:2048
    global_load_dwordx4 a[156:159], v6, s[38:39] offset:3072
    global_load_dwordx4 a[160:163], v7, s[38:39] offset:0
    global_load_dwordx4 a[164:167], v7, s[38:39] offset:1024
    s_add_u32 s38, s36, 43008
    s_addc_u32 s39, s37, 0
    global_load_dwordx4 a[168:171], v9, s[38:39] offset:0
    global_load_dwordx4 a[172:175], v9, s[38:39] offset:1024
    global_load_dwordx4 a[176:179], v9, s[38:39] offset:2048
    global_load_dwordx4 a[180:183], v9, s[38:39] offset:3072
    global_load_dwordx4 a[184:187], v5, s[38:39] offset:0
    global_load_dwordx4 a[188:191], v5, s[38:39] offset:1024
    global_load_dwordx4 a[192:195], v5, s[38:39] offset:2048
    global_load_dwordx4 a[196:199], v5, s[38:39] offset:3072
    global_load_dwordx4 a[200:203], v6, s[38:39] offset:0
    global_load_dwordx4 a[204:207], v6, s[38:39] offset:1024
    global_load_dwordx4 a[208:211], v6, s[38:39] offset:2048
    global_load_dwordx4 a[212:215], v6, s[38:39] offset:3072
    global_load_dwordx4 a[216:219], v7, s[38:39] offset:0
    global_load_dwordx4 a[220:223], v7, s[38:39] offset:1024
    s_cmp_lt_u32 s2, 3
    s_cbranch_scc1 np_attn_10
    s_sub_u32 s64, s63, 12
    s_cmp_lg_u32 s10, 0
    s_cbranch_scc1 wo_attn_13
    s_add_u32 s94, s4, 0x6bd4800
    s_addc_u32 s95, s5, 0
    v_mov_b32 v10, s64
wc_attn_11:
    global_load_dword v11, v10, s[94:95] sc1
    s_add_u32 s92, s92, 1
    s_cmp_gt_u32 s92, 524288
    s_cbranch_scc1 wd_attn_12
    s_waitcnt vmcnt(0)
    v_cmp_gt_u32 vcc, 14, v11
    s_nop 1
    s_cbranch_vccz wd_attn_12
    s_sleep 2
    s_branch wc_attn_11
wd_attn_12:
wo_attn_13:
    s_barrier
np_attn_10:
    s_mul_i32 s64, s2, 458752
    s_add_u32 s66, s4, 0x3093000
    s_addc_u32 s67, s5, 0
    v_and_b32 v10, 63, v0
    v_lshlrev_b32 v10, 7, v10
    s_mul_i32 s93, s10, 114688
    s_add_u32 s93, s93, s64
    v_add_u32 v10, s93, v10
    global_load_dword v255, v10, s[66:67]
    v_add_u32 v10, 8192, v10
    global_load_dword v255, v10, s[66:67]
    v_add_u32 v10, 8192, v10
    global_load_dword v255, v10, s[66:67]
    v_add_u32 v10, 8192, v10
    global_load_dword v255, v10, s[66:67]
    v_add_u32 v10, 8192, v10
    global_load_dword v255, v10, s[66:67]
    v_add_u32 v10, 8192, v10
    global_load_dword v255, v10, s[66:67]
    v_add_u32 v10, 8192, v10
    global_load_dword v255, v10, s[66:67]
    v_add_u32 v10, 8192, v10
    global_load_dword v255, v10, s[66:67]
    v_add_u32 v10, 8192, v10
    global_load_dword v255, v10, s[66:67]
    v_add_u32 v10, 8192, v10
    global_load_dword v255, v10, s[66:67]
    v_add_u32 v10, 8192, v10
    global_load_dword v255, v10, s[66:67]
    v_add_u32 v10, 8192, v10
    global_load_dword v255, v10, s[66:67]
    v_add_u32 v10, 8192, v10
    global_load_dword v255, v10, s[66:67]
    v_add_u32 v10, 8192, v10
    global_load_dword v255, v10, s[66:67]
    s_cmp_lg_u32 s10, 0
    s_cbranch_scc1 wo_attn_16
    s_add_u32 s94, s4, 0x6bd4800
    s_addc_u32 s95, s5, 0
    v_mov_b32 v10, s63
wc_attn_14:
    global_load_dword v11, v10, s[94:95] sc1
    s_add_u32 s92, s92, 1
    s_cmp_gt_u32 s92, 524288
    s_cbranch_scc1 wd_attn_15
    s_waitcnt vmcnt(0)
    v_cmp_gt_u32 vcc, 14, v11
    s_nop 1
    s_cbranch_vccz wd_attn_15
    s_sleep 2
    s_branch wc_attn_14
wd_attn_15:
    buffer_inv sc1
    s_waitcnt vmcnt(0)
wo_attn_16:
    s_barrier
    global_load_dwordx4 v[64:67], v14, s[30:31] offset:0
    global_load_dwordx4 v[68:71], v14, s[30:31] offset:512
    global_load_dwordx4 v[72:75], v14, s[30:31] offset:1024
    global_load_dwordx4 v[76:79], v14, s[30:31] offset:1536
    global_load_dwordx4 v[80:83], v14, s[30:31] offset:2048
    global_load_dwordx4 v[84:87], v14, s[30:31] offset:2560
    global_load_dwordx4 v[88:91], v14, s[30:31] offset:3072
    global_load_dwordx4 v[92:95], v14, s[30:31] offset:3584
    global_load_dwordx4 v[96:99], v15, s[30:31] offset:0
    global_load_dwordx4 v[100:103], v15, s[30:31] offset:512
    global_load_dwordx4 v[104:107], v15, s[30:31] offset:1024
    global_load_dwordx4 v[108:111], v15, s[30:31] offset:1536
    global_load_dwordx4 v[112:115], v15, s[30:31] offset:2048
    global_load_dwordx4 v[116:119], v15, s[30:31] offset:2560
    s_waitcnt vmcnt(0)
    v_mfma_f32_16x16x32_bf16 v[32:35], v[64:67], a[0:3], 0
    v_mfma_f32_16x16x32_bf16 v[36:39], v[120:123], a[0:3], 0
    v_mfma_f32_16x16x32_bf16 v[32:35], v[68:71], a[4:7], v[32:35]
    v_mfma_f32_16x16x32_bf16 v[36:39], v[124:127], a[4:7], v[36:39]
    v_mfma_f32_16x16x32_bf16 v[32:35], v[72:75], a[8:11], v[32:35]
    v_mfma_f32_16x16x32_bf16 v[36:39], v[128:131], a[8:11], v[36:39]
    v_mfma_f32_16x16x32_bf16 v[32:35], v[76:79], a[12:15], v[32:35]
    v_mfma_f32_16x16x32_bf16 v[36:39], v[132:135], a[12:15], v[36:39]
    v_mfma_f32_16x16x32_bf16 v[32:35], v[80:83], a[16:19], v[32:35]
    v_mfma_f32_16x16x32_bf16 v[36:39], v[136:139], a[16:19], v[36:39]
    v_mfma_f32_16x16x32_bf16 v[32:35], v[84:87], a[20:23], v[32:35]
    v_mfma_f32_16x16x32_bf16 v[36:39], v[140:143], a[20:23], v[36:39]
    v_mfma_f32_16x16x32_bf16 v[32:35], v[88:91], a[24:27], v[32:35]
    v_mfma_f32_16x16x32_bf16 v[36:39], v[144:147], a[24:27], v[36:39]
    v_mfma_f32_16x16x32_bf16 v[32:35], v[92:95], a[28:31], v[32:35]
    v_mfma_f32_16x16x32_bf16 v[36:39], v[148:151], a[28:31], v[36:39]
    v_mfma_f32_16x16x32_bf16 v[32:35], v[96:99], a[32:35], v[32:35]
    v_mfma_f32_16x16x32_bf16 v[36:39], v[152:155], a[32:35], v[36:39]
    v_mfma_f32_16x16x32_bf16 v[32:35], v[100:103], a[36:39], v[32:35]
    v_mfma_f32_16x16x32_bf16 v[36:39], v[156:159], a[36:39], v[36:39]
    v_mfma_f32_16x16x32_bf16 v[32:35], v[104:107], a[40:43], v[32:35]
    v_mfma_f32_16x16x32_bf16 v[36:39], v[160:163], a[40:43], v[36:39]
    v_mfma_f32_16x16x32_bf16 v[32:35], v[108:111], a[44:47], v[32:35]
    v_mfma_f32_16x16x32_bf16 v[36:39], v[164:167], a[44:47], v[36:39]
    v_mfma_f32_16x16x32_bf16 v[32:35], v[112:115], a[48:51], v[32:35]
    v_mfma_f32_16x16x32_bf16 v[36:39], v[168:171], a[48:51], v[36:39]
    v_mfma_f32_16x16x32_bf16 v[32:35], v[116:119], a[52:55], v[32:35]
    v_mfma_f32_16x16x32_bf16 v[36:39], v[172:175], a[52:55], v[36:39]
    s_nop 9
    v_cndmask_b32 v32, v60, v32, s[40:41]
    v_cndmask_b32 v33, v60, v33, s[40:41]
    v_cndmask_b32 v34, v60, v34, s[40:41]
    v_cndmask_b32 v35, v60, v35, s[40:41]
    v_cndmask_b32 v36, v60, v36, s[42:43]
    v_cndmask_b32 v37, v60, v37, s[44:45]
    v_cndmask_b32 v38, v60, v38, s[46:47]
    v_cndmask_b32 v39, v60, v39, s[48:49]
    v_max3_f32 v44, v32, v33, v34
    v_max3_f32 v44, v44, v35, v36
    v_max3_f32 v44, v44, v37, v38
    v_max_f32 v44, v44, v39
    v_mov_b32 v45, v44
    s_nop 1
    v_permlane16_swap_b32 v45, v44
    s_nop 1
    v_max_f32 v44, v45, v44
    v_mov_b32 v45, v44
    s_nop 1
    v_permlane32_swap_b32 v45, v44
    s_nop 1
    v_max_f32 v44, v45, v44
    v_mul_f32 v44, v61, v44
    v_fma_f32 v32, v32, v61, -v44
    v_fma_f32 v33, v33, v61, -v44
    v_fma_f32 v34, v34, v61, -v44
    v_fma_f32 v35, v35, v61, -v44
    v_fma_f32 v36, v36, v61, -v44
    v_fma_f32 v37, v37, v61, -v44
    v_fma_f32 v38, v38, v61, -v44
    v_fma_f32 v39, v39, v61, -v44
    v_exp_f32 v32, v32
    v_exp_f32 v33, v33
    v_exp_f32 v34, v34
    v_exp_f32 v35, v35
    v_exp_f32 v36, v36
    v_exp_f32 v37, v37
    v_exp_f32 v38, v38
    v_exp_f32 v39, v39
    s_nop 0
    v_add_f32 v44, v32, v33
    v_add_f32 v44, v44, v34
    v_add_f32 v44, v44, v35
    v_add_f32 v44, v44, v36
    v_add_f32 v44, v44, v37
    v_add_f32 v44, v44, v38
    v_add_f32 v44, v44, v39
    v_mov_b32 v45, v44
    s_nop 1
    v_permlane16_swap_b32 v45, v44
    s_nop 1
    v_add_f32 v44, v45, v44
    v_mov_b32 v45, v44
    s_nop 1
    v_permlane32_swap_b32 v45, v44
    s_nop 1
    v_add_f32 v44, v45, v44
    v_rcp_f32 v44, v44
    s_nop 0
    v_mul_f32 v32, v32, v44
    v_mul_f32 v33, v33, v44
    v_mul_f32 v34, v34, v44
    v_mul_f32 v35, v35, v44
    v_mul_f32 v36, v36, v44
    v_mul_f32 v37, v37, v44
    v_mul_f32 v38, v38, v44
    v_mul_f32 v39, v39, v44
    v_cvt_pk_bf16_f32 v48, v36, v37
    v_cvt_pk_bf16_f32 v49, v38, v39
    v_mov_b32 v50, 0
    v_mov_b32 v51, 0
    v_cvt_pk_bf16_f32 v52, v32, v33
    v_cvt_pk_bf16_f32 v53, v34, v35
    ds_write_b128 v12, v[48:51] offset:0
    ds_write_b64 v13, v[52:53] offset:0
    s_waitcnt lgkmcnt(0)
    v_mfma_f32_16x16x32_bf16 v[32:35], v[64:67], a[56:59], 0
    v_mfma_f32_16x16x32_bf16 v[36:39], v[120:123], a[56:59], 0
    v_mfma_f32_16x16x32_bf16 v[32:35], v[68:71], a[60:63], v[32:35]
    v_mfma_f32_16x16x32_bf16 v[36:39], v[124:127], a[60:63], v[36:39]
    v_mfma_f32_16x16x32_bf16 v[32:35], v[72:75], a[64:67], v[32:35]
    v_mfma_f32_16x16x32_bf16 v[36:39], v[128:131], a[64:67], v[36:39]
    v_mfma_f32_16x16x32_bf16 v[32:35], v[76:79], a[68:71], v[32:35]
    v_mfma_f32_16x16x32_bf16 v[36:39], v[132:135], a[68:71], v[36:39]
    v_mfma_f32_16x16x32_bf16 v[32:35], v[80:83], a[72:75], v[32:35]
    v_mfma_f32_16x16x32_bf16 v[36:39], v[136:139], a[72:75], v[36:39]
    v_mfma_f32_16x16x32_bf16 v[32:35], v[84:87], a[76:79], v[32:35]
    v_mfma_f32_16x16x32_bf16 v[36:39], v[140:143], a[76:79], v[36:39]
    v_mfma_f32_16x16x32_bf16 v[32:35], v[88:91], a[80:83], v[32:35]
    v_mfma_f32_16x16x32_bf16 v[36:39], v[144:147], a[80:83], v[36:39]
    v_mfma_f32_16x16x32_bf16 v[32:35], v[92:95], a[84:87], v[32:35]
    v_mfma_f32_16x16x32_bf16 v[36:39], v[148:151], a[84:87], v[36:39]
    v_mfma_f32_16x16x32_bf16 v[32:35], v[96:99], a[88:91], v[32:35]
    v_mfma_f32_16x16x32_bf16 v[36:39], v[152:155], a[88:91], v[36:39]
    v_mfma_f32_16x16x32_bf16 v[32:35], v[100:103], a[92:95], v[32:35]
    v_mfma_f32_16x16x32_bf16 v[36:39], v[156:159], a[92:95], v[36:39]
    v_mfma_f32_16x16x32_bf16 v[32:35], v[104:107], a[96:99], v[32:35]
    v_mfma_f32_16x16x32_bf16 v[36:39], v[160:163], a[96:99], v[36:39]
    v_mfma_f32_16x16x32_bf16 v[32:35], v[108:111], a[100:103], v[32:35]
    v_mfma_f32_16x16x32_bf16 v[36:39], v[164:167], a[100:103], v[36:39]
    v_mfma_f32_16x16x32_bf16 v[32:35], v[112:115], a[104:107], v[32:35]
    v_mfma_f32_16x16x32_bf16 v[36:39], v[168:171], a[104:107], v[36:39]
    v_mfma_f32_16x16x32_bf16 v[32:35], v[116:119], a[108:111], v[32:35]
    v_mfma_f32_16x16x32_bf16 v[36:39], v[172:175], a[108:111], v[36:39]
    s_nop 9
    v_cndmask_b32 v32, v60, v32, s[40:41]
    v_cndmask_b32 v33, v60, v33, s[40:41]
    v_cndmask_b32 v34, v60, v34, s[40:41]
    v_cndmask_b32 v35, v60, v35, s[40:41]
    v_cndmask_b32 v36, v60, v36, s[42:43]
    v_cndmask_b32 v37, v60, v37, s[44:45]
    v_cndmask_b32 v38, v60, v38, s[46:47]
    v_cndmask_b32 v39, v60, v39, s[48:49]
    v_max3_f32 v44, v32, v33, v34
    v_max3_f32 v44, v44, v35, v36
    v_max3_f32 v44, v44, v37, v38
    v_max_f32 v44, v44, v39
    v_mov_b32 v45, v44
    s_nop 1
    v_permlane16_swap_b32 v45, v44
    s_nop 1
    v_max_f32 v44, v45, v44
    v_mov_b32 v45, v44
    s_nop 1
    v_permlane32_swap_b32 v45, v44
    s_nop 1
    v_max_f32 v44, v45, v44
    v_mul_f32 v44, v61, v44
    v_fma_f32 v32, v32, v61, -v44
    v_fma_f32 v33, v33, v61, -v44
    v_fma_f32 v34, v34, v61, -v44
    v_fma_f32 v35, v35, v61, -v44
    v_fma_f32 v36, v36, v61, -v44
    v_fma_f32 v37, v37, v61, -v44
    v_fma_f32 v38, v38, v61, -v44
    v_fma_f32 v39, v39, v61, -v44
    v_exp_f32 v32, v32
    v_exp_f32 v33, v33
    v_exp_f32 v34, v34
    v_exp_f32 v35, v35
    v_exp_f32 v36, v36
    v_exp_f32 v37, v37
    v_exp_f32 v38, v38
    v_exp_f32 v39, v39
    s_nop 0
    v_add_f32 v44, v32, v33
    v_add_f32 v44, v44, v34
    v_add_f32 v44, v44, v35
    v_add_f32 v44, v44, v36
    v_add_f32 v44, v44, v37
    v_add_f32 v44, v44, v38
    v_add_f32 v44, v44, v39
    v_mov_b32 v45, v44
    s_nop 1
    v_permlane16_swap_b32 v45, v44
    s_nop 1
    v_add_f32 v44, v45, v44
    v_mov_b32 v45, v44
    s_nop 1
    v_permlane32_swap_b32 v45, v44
    s_nop 1
    v_add_f32 v44, v45, v44
    v_rcp_f32 v44, v44
    s_nop 0
    v_mul_f32 v32, v32, v44
    v_mul_f32 v33, v33, v44
    v_mul_f32 v34, v34, v44
    v_mul_f32 v35, v35, v44
    v_mul_f32 v36, v36, v44
    v_mul_f32 v37, v37, v44
    v_mul_f32 v38, v38, v44
    v_mul_f32 v39, v39, v44
    v_cvt_pk_bf16_f32 v48, v36, v37
    v_cvt_pk_bf16_f32 v49, v38, v39
    v_mov_b32 v50, 0
    v_mov_b32 v51, 0
    v_cvt_pk_bf16_f32 v52, v32, v33
    v_cvt_pk_bf16_f32 v53, v34, v35
    ds_write_b128 v12, v[48:51] offset:1024
    ds_write_b64 v13, v[52:53] offset:8
    s_waitcnt lgkmcnt(0)
    v_mfma_f32_16x16x32_bf16 v[32:35], v[64:67], a[112:115], 0
    v_mfma_f32_16x16x32_bf16 v[36:39], v[120:123], a[112:115], 0
    v_mfma_f32_16x16x32_bf16 v[32:35], v[68:71], a[116:119], v[32:35]
    v_mfma_f32_16x16x32_bf16 v[36:39], v[124:127], a[116:119], v[36:39]
    v_mfma_f32_16x16x32_bf16 v[32:35], v[72:75], a[120:123], v[32:35]
    v_mfma_f32_16x16x32_bf16 v[36:39], v[128:131], a[120:123], v[36:39]
    v_mfma_f32_16x16x32_bf16 v[32:35], v[76:79], a[124:127], v[32:35]
    v_mfma_f32_16x16x32_bf16 v[36:39], v[132:135], a[124:127], v[36:39]
    v_mfma_f32_16x16x32_bf16 v[32:35], v[80:83], a[128:131], v[32:35]
    v_mfma_f32_16x16x32_bf16 v[36:39], v[136:139], a[128:131], v[36:39]
    v_mfma_f32_16x16x32_bf16 v[32:35], v[84:87], a[132:135], v[32:35]
    v_mfma_f32_16x16x32_bf16 v[36:39], v[140:143], a[132:135], v[36:39]
    v_mfma_f32_16x16x32_bf16 v[32:35], v[88:91], a[136:139], v[32:35]
    v_mfma_f32_16x16x32_bf16 v[36:39], v[144:147], a[136:139], v[36:39]
    v_mfma_f32_16x16x32_bf16 v[32:35], v[92:95], a[140:143], v[32:35]
    v_mfma_f32_16x16x32_bf16 v[36:39], v[148:151], a[140:143], v[36:39]
    v_mfma_f32_16x16x32_bf16 v[32:35], v[96:99], a[144:147], v[32:35]
    v_mfma_f32_16x16x32_bf16 v[36:39], v[152:155], a[144:147], v[36:39]
    v_mfma_f32_16x16x32_bf16 v[32:35], v[100:103], a[148:151], v[32:35]
    v_mfma_f32_16x16x32_bf16 v[36:39], v[156:159], a[148:151], v[36:39]
    v_mfma_f32_16x16x32_bf16 v[32:35], v[104:107], a[152:155], v[32:35]
    v_mfma_f32_16x16x32_bf16 v[36:39], v[160:163], a[152:155], v[36:39]
    v_mfma_f32_16x16x32_bf16 v[32:35], v[108:111], a[156:159], v[32:35]
    v_mfma_f32_16x16x32_bf16 v[36:39], v[164:167], a[156:159], v[36:39]
    v_mfma_f32_16x16x32_bf16 v[32:35], v[112:115], a[160:163], v[32:35]
    v_mfma_f32_16x16x32_bf16 v[36:39], v[168:171], a[160:163], v[36:39]
    v_mfma_f32_16x16x32_bf16 v[32:35], v[116:119], a[164:167], v[32:35]
    v_mfma_f32_16x16x32_bf16 v[36:39], v[172:175], a[164:167], v[36:39]
    s_nop 9
    v_cndmask_b32 v32, v60, v32, s[40:41]
    v_cndmask_b32 v33, v60, v33, s[40:41]
    v_cndmask_b32 v34, v60, v34, s[40:41]
    v_cndmask_b32 v35, v60, v35, s[40:41]
    v_cndmask_b32 v36, v60, v36, s[42:43]
    v_cndmask_b32 v37, v60, v37, s[44:45]
    v_cndmask_b32 v38, v60, v38, s[46:47]
    v_cndmask_b32 v39, v60, v39, s[48:49]
    v_max3_f32 v44, v32, v33, v34
    v_max3_f32 v44, v44, v35, v36
    v_max3_f32 v44, v44, v37, v38
    v_max_f32 v44, v44, v39
    v_mov_b32 v45, v44
    s_nop 1
    v_permlane16_swap_b32 v45, v44
    s_nop 1
    v_max_f32 v44, v45, v44
    v_mov_b32 v45, v44
    s_nop 1
    v_permlane32_swap_b32 v45, v44
    s_nop 1
    v_max_f32 v44, v45, v44
    v_mul_f32 v44, v61, v44
    v_fma_f32 v32, v32, v61, -v44
    v_fma_f32 v33, v33, v61, -v44
    v_fma_f32 v34, v34, v61, -v44
    v_fma_f32 v35, v35, v61, -v44
    v_fma_f32 v36, v36, v61, -v44
    v_fma_f32 v37, v37, v61, -v44
    v_fma_f32 v38, v38, v61, -v44
    v_fma_f32 v39, v39, v61, -v44
    v_exp_f32 v32, v32
    v_exp_f32 v33, v33
    v_exp_f32 v34, v34
    v_exp_f32 v35, v35
    v_exp_f32 v36, v36
    v_exp_f32 v37, v37
    v_exp_f32 v38, v38
    v_exp_f32 v39, v39
    s_nop 0
    v_add_f32 v44, v32, v33
    v_add_f32 v44, v44, v34
    v_add_f32 v44, v44, v35
    v_add_f32 v44, v44, v36
    v_add_f32 v44, v44, v37
    v_add_f32 v44, v44, v38
    v_add_f32 v44, v44, v39
    v_mov_b32 v45, v44
    s_nop 1
    v_permlane16_swap_b32 v45, v44
    s_nop 1
    v_add_f32 v44, v45, v44
    v_mov_b32 v45, v44
    s_nop 1
    v_permlane32_swap_b32 v45, v44
    s_nop 1
    v_add_f32 v44, v45, v44
    v_rcp_f32 v44, v44
    s_nop 0
    v_mul_f32 v32, v32, v44
    v_mul_f32 v33, v33, v44
    v_mul_f32 v34, v34, v44
    v_mul_f32 v35, v35, v44
    v_mul_f32 v36, v36, v44
    v_mul_f32 v37, v37, v44
    v_mul_f32 v38, v38, v44
    v_mul_f32 v39, v39, v44
    v_cvt_pk_bf16_f32 v48, v36, v37
    v_cvt_pk_bf16_f32 v49, v38, v39
    v_mov_b32 v50, 0
    v_mov_b32 v51, 0
    v_cvt_pk_bf16_f32 v52, v32, v33
    v_cvt_pk_bf16_f32 v53, v34, v35
    ds_write_b128 v12, v[48:51] offset:2048
    ds_write_b64 v13, v[52:53] offset:1024
    s_waitcnt lgkmcnt(0)
    v_mfma_f32_16x16x32_bf16 v[32:35], v[64:67], a[168:171], 0
    v_mfma_f32_16x16x32_bf16 v[36:39], v[120:123], a[168:171], 0
    v_mfma_f32_16x16x32_bf16 v[32:35], v[68:71], a[172:175], v[32:35]
    v_mfma_f32_16x16x32_bf16 v[36:39], v[124:127], a[172:175], v[36:39]
    v_mfma_f32_16x16x32_bf16 v[32:35], v[72:75], a[176:179], v[32:35]
    v_mfma_f32_16x16x32_bf16 v[36:39], v[128:131], a[176:179], v[36:39]
    v_mfma_f32_16x16x32_bf16 v[32:35], v[76:79], a[180:183], v[32:35]
    v_mfma_f32_16x16x32_bf16 v[36:39], v[132:135], a[180:183], v[36:39]
    v_mfma_f32_16x16x32_bf16 v[32:35], v[80:83], a[184:187], v[32:35]
    v_mfma_f32_16x16x32_bf16 v[36:39], v[136:139], a[184:187], v[36:39]
    v_mfma_f32_16x16x32_bf16 v[32:35], v[84:87], a[188:191], v[32:35]
    v_mfma_f32_16x16x32_bf16 v[36:39], v[140:143], a[188:191], v[36:39]
    v_mfma_f32_16x16x32_bf16 v[32:35], v[88:91], a[192:195], v[32:35]
    v_mfma_f32_16x16x32_bf16 v[36:39], v[144:147], a[192:195], v[36:39]
    v_mfma_f32_16x16x32_bf16 v[32:35], v[92:95], a[196:199], v[32:35]
    v_mfma_f32_16x16x32_bf16 v[36:39], v[148:151], a[196:199], v[36:39]
    v_mfma_f32_16x16x32_bf16 v[32:35], v[96:99], a[200:203], v[32:35]
    v_mfma_f32_16x16x32_bf16 v[36:39], v[152:155], a[200:203], v[36:39]
    v_mfma_f32_16x16x32_bf16 v[32:35], v[100:103], a[204:207], v[32:35]
    v_mfma_f32_16x16x32_bf16 v[36:39], v[156:159], a[204:207], v[36:39]
    v_mfma_f32_16x16x32_bf16 v[32:35], v[104:107], a[208:211], v[32:35]
    v_mfma_f32_16x16x32_bf16 v[36:39], v[160:163], a[208:211], v[36:39]
    v_mfma_f32_16x16x32_bf16 v[32:35], v[108:111], a[212:215], v[32:35]
    v_mfma_f32_16x16x32_bf16 v[36:39], v[164:167], a[212:215], v[36:39]
    v_mfma_f32_16x16x32_bf16 v[32:35], v[112:115], a[216:219], v[32:35]
    v_mfma_f32_16x16x32_bf16 v[36:39], v[168:171], a[216:219], v[36:39]
    v_mfma_f32_16x16x32_bf16 v[32:35], v[116:119], a[220:223], v[32:35]
    v_mfma_f32_16x16x32_bf16 v[36:39], v[172:175], a[220:223], v[36:39]
    s_nop 9
    v_cndmask_b32 v32, v60, v32, s[40:41]
    v_cndmask_b32 v33, v60, v33, s[40:41]
    v_cndmask_b32 v34, v60, v34, s[40:41]
    v_cndmask_b32 v35, v60, v35, s[40:41]
    v_cndmask_b32 v36, v60, v36, s[42:43]
    v_cndmask_b32 v37, v60, v37, s[44:45]
    v_cndmask_b32 v38, v60, v38, s[46:47]
    v_cndmask_b32 v39, v60, v39, s[48:49]
    v_max3_f32 v44, v32, v33, v34
    v_max3_f32 v44, v44, v35, v36
    v_max3_f32 v44, v44, v37, v38
    v_max_f32 v44, v44, v39
    v_mov_b32 v45, v44
    s_nop 1
    v_permlane16_swap_b32 v45, v44
    s_nop 1
    v_max_f32 v44, v45, v44
    v_mov_b32 v45, v44
    s_nop 1
    v_permlane32_swap_b32 v45, v44
    s_nop 1
    v_max_f32 v44, v45, v44
    v_mul_f32 v44, v61, v44
    v_fma_f32 v32, v32, v61, -v44
    v_fma_f32 v33, v33, v61, -v44
    v_fma_f32 v34, v34, v61, -v44
    v_fma_f32 v35, v35, v61, -v44
    v_fma_f32 v36, v36, v61, -v44
    v_fma_f32 v37, v37, v61, -v44
    v_fma_f32 v38, v38, v61, -v44
    v_fma_f32 v39, v39, v61, -v44
    v_exp_f32 v32, v32
    v_exp_f32 v33, v33
    v_exp_f32 v34, v34
    v_exp_f32 v35, v35
    v_exp_f32 v36, v36
    v_exp_f32 v37, v37
    v_exp_f32 v38, v38
    v_exp_f32 v39, v39
    s_nop 0
    v_add_f32 v44, v32, v33
    v_add_f32 v44, v44, v34
    v_add_f32 v44, v44, v35
    v_add_f32 v44, v44, v36
    v_add_f32 v44, v44, v37
    v_add_f32 v44, v44, v38
    v_add_f32 v44, v44, v39
    v_mov_b32 v45, v44
    s_nop 1
    v_permlane16_swap_b32 v45, v44
    s_nop 1
    v_add_f32 v44, v45, v44
    v_mov_b32 v45, v44
    s_nop 1
    v_permlane32_swap_b32 v45, v44
    s_nop 1
    v_add_f32 v44, v45, v44
    v_rcp_f32 v44, v44
    s_nop 0
    v_mul_f32 v32, v32, v44
    v_mul_f32 v33, v33, v44
    v_mul_f32 v34, v34, v44
    v_mul_f32 v35, v35, v44
    v_mul_f32 v36, v36, v44
    v_mul_f32 v37, v37, v44
    v_mul_f32 v38, v38, v44
    v_mul_f32 v39, v39, v44
    v_cvt_pk_bf16_f32 v48, v36, v37
    v_cvt_pk_bf16_f32 v49, v38, v39
    v_mov_b32 v50, 0
    v_mov_b32 v51, 0
    v_cvt_pk_bf16_f32 v52, v32, v33
    v_cvt_pk_bf16_f32 v53, v34, v35
    ds_write_b128 v12, v[48:51] offset:3072
    ds_write_b64 v13, v[52:53] offset:1032
    s_waitcnt lgkmcnt(0)
    s_add_u32 s38, s52, 0
    s_addc_u32 s39, s53, 0
    global_load_dwordx4 v[96:99], v9, s[38:39] offset:0
    global_load_dwordx4 v[100:103], v9, s[38:39] offset:1024
    global_load_dwordx4 v[104:107], v9, s[38:39] offset:2048
    global_load_dwordx4 v[108:111], v9, s[38:39] offset:3072
    global_load_dwordx4 v[112:115], v5, s[38:39] offset:0
    global_load_dwordx4 v[116:119], v5, s[38:39] offset:1024
    global_load_dwordx4 v[120:123], v5, s[38:39] offset:2048
    s_add_u32 s38, s52, 28672
    s_addc_u32 s39, s53, 0
    global_load_dwordx4 v[124:127], v9, s[38:39] offset:0
    global_load_dwordx4 v[128:131], v9, s[38:39] offset:1024
    global_load_dwordx4 v[132:135], v9, s[38:39] offset:2048
    global_load_dwordx4 v[136:139], v9, s[38:39] offset:3072
    global_load_dwordx4 v[140:143], v5, s[38:39] offset:0
    global_load_dwordx4 v[144:147], v5, s[38:39] offset:1024
    global_load_dwordx4 v[148:151], v5, s[38:39] offset:2048
    s_add_u32 s38, s52, 57344
    s_addc_u32 s39, s53, 0
    global_load_dwordx4 v[152:155], v9, s[38:39] offset:0
    global_load_dwordx4 v[156:159], v9, s[38:39] offset:1024
    global_load_dwordx4 v[160:163], v9, s[38:39] offset:2048
    global_load_dwordx4 v[164:167], v9, s[38:39] offset:3072
    global_load_dwordx4 v[168:171], v5, s[38:39] offset:0
    global_load_dwordx4 v[172:175], v5, s[38:39] offset:1024
    global_load_dwordx4 v[176:179], v5, s[38:39] offset:2048
    s_barrier
    ds_read_b128 v[224:227], v9 offset:0
    s_add_u32 s38, s52, 86016
    s_addc_u32 s39, s53, 0
    global_load_dwordx4 v[180:183], v9, s[38:39] offset:0
    global_load_dwordx4 v[184:187], v9, s[38:39] offset:1024
    global_load_dwordx4 v[188:191], v9, s[38:39] offset:2048
    global_load_dwordx4 v[192:195], v9, s[38:39] offset:3072
    global_load_dwordx4 v[196:199], v5, s[38:39] offset:0
    global_load_dwordx4 v[200:203], v5, s[38:39] offset:1024
    global_load_dwordx4 v[204:207], v5, s[38:39] offset:2048
    s_add_u32 s38, s50, 0
    s_addc_u32 s39, s51, 0
    global_load_dwordx4 a[0:3], v16, s[38:39] offset:0
    global_load_dwordx4 a[4:7], v16, s[38:39] offset:512
    global_load_dwordx4 a[8:11], v16, s[38:39] offset:1024
    global_load_dwordx4 a[12:15], v16, s[38:39] offset:1536
    global_load_dwordx4 a[16:19], v16, s[38:39] offset:2048
    global_load_dwordx4 a[20:23], v16, s[38:39] offset:2560
    global_load_dwordx4 a[24:27], v16, s[38:39] offset:3072
    ds_read_b128 v[228:231], v9 offset:1024
    s_waitcnt vmcnt(28) lgkmcnt(1)
    v_mfma_f32_16x16x32_bf16 v[64:67], v[96:99], v[224:227], 0
    v_mfma_f32_16x16x32_bf16 v[68:71], v[100:103], v[224:227], 0
    v_mfma_f32_16x16x32_bf16 v[72:75], v[104:107], v[224:227], 0
    v_mfma_f32_16x16x32_bf16 v[76:79], v[108:111], v[224:227], 0
    v_mfma_f32_16x16x32_bf16 v[80:83], v[112:115], v[224:227], 0
    v_mfma_f32_16x16x32_bf16 v[84:87], v[116:119], v[224:227], 0
    v_mfma_f32_16x16x32_bf16 v[88:91], v[120:123], v[224:227], 0
    s_add_u32 s38, s52, 114688
    s_addc_u32 s39, s53, 0
    global_load_dwordx4 v[96:99], v9, s[38:39] offset:0
    global_load_dwordx4 v[100:103], v9, s[38:39] offset:1024
    global_load_dwordx4 v[104:107], v9, s[38:39] offset:2048
    global_load_dwordx4 v[108:111], v9, s[38:39] offset:3072
    global_load_dwordx4 v[112:115], v5, s[38:39] offset:0
    global_load_dwordx4 v[116:119], v5, s[38:39] offset:1024
    global_load_dwordx4 v[120:123], v5, s[38:39] offset:2048
    s_add_u32 s38, s50, 14336
    s_addc_u32 s39, s51, 0
    global_load_dwordx4 a[28:31], v16, s[38:39] offset:0
    global_load_dwordx4 a[32:35], v16, s[38:39] offset:512
    global_load_dwordx4 a[36:39], v16, s[38:39] offset:1024
    global_load_dwordx4 a[40:43], v16, s[38:39] offset:1536
    global_load_dwordx4 a[44:47], v16, s[38:39] offset:2048
    global_load_dwordx4 a[48:51], v16, s[38:39] offset:2560
    global_load_dwordx4 a[52:55], v16, s[38:39] offset:3072
    ds_read_b128 v[224:227], v9 offset:2048
    s_waitcnt vmcnt(35) lgkmcnt(1)
    v_mfma_f32_16x16x32_bf16 v[64:67], v[124:127], v[228:231], v[64:67]
    v_mfma_f32_16x16x32_bf16 v[68:71], v[128:131], v[228:231], v[68:71]
    v_mfma_f32_16x16x32_bf16 v[72:75], v[132:135], v[228:231], v[72:75]
    v_mfma_f32_16x16x32_bf16 v[76:79], v[136:139], v[228:231], v[76:79]
    v_mfma_f32_16x16x32_bf16 v[80:83], v[140:143], v[228:231], v[80:83]
    v_mfma_f32_16x16x32_bf16 v[84:87], v[144:147], v[228:231], v[84:87]
    v_mfma_f32_16x16x32_bf16 v[88:91], v[148:151], v[228:231], v[88:91]
    s_add_u32 s38, s52, 143360
    s_addc_u32 s39, s53, 0
    global_load_dwordx4 v[124:127], v9, s[38:39] offset:0
    global_load_dwordx4 v[128:131], v9, s[38:39] offset:1024
    global_load_dwordx4 v[132:135], v9, s[38:39] offset:2048
    global_load_dwordx4 v[136:139], v9, s[38:39] offset:3072
    global_load_dwordx4 v[140:143], v5, s[38:39] offset:0
    global_load_dwordx4 v[144:147], v5, s[38:39] offset:1024
    global_load_dwordx4 v[148:151], v5, s[38:39] offset:2048
    s_add_u32 s38, s50, 28672
    s_addc_u32 s39, s51, 0
    global_load_dwordx4 a[56:59], v16, s[38:39] offset:0
    global_load_dwordx4 a[60:63], v16, s[38:39] offset:512
    global_load_dwordx4 a[64:67], v16, s[38:39] offset:1024
    global_load_dwordx4 a[68:71], v16, s[38:39] offset:1536
    global_load_dwordx4 a[72:75], v16, s[38:39] offset:2048
    global_load_dwordx4 a[76:79], v16, s[38:39] offset:2560
    global_load_dwordx4 a[80:83], v16, s[38:39] offset:3072
    ds_read_b128 v[228:231], v9 offset:3072
    s_waitcnt vmcnt(42) lgkmcnt(1)
    v_mfma_f32_16x16x32_bf16 v[64:67], v[152:155], v[224:227], v[64:67]
    v_mfma_f32_16x16x32_bf16 v[68:71], v[156:159], v[224:227], v[68:71]
    v_mfma_f32_16x16x32_bf16 v[72:75], v[160:163], v[224:227], v[72:75]
    v_mfma_f32_16x16x32_bf16 v[76:79], v[164:167], v[224:227], v[76:79]
    v_mfma_f32_16x16x32_bf16 v[80:83], v[168:171], v[224:227], v[80:83]
    v_mfma_f32_16x16x32_bf16 v[84:87], v[172:175], v[224:227], v[84:87]
    v_mfma_f32_16x16x32_bf16 v[88:91], v[176:179], v[224:227], v[88:91]
    s_add_u32 s38, s52, 172032
    s_addc_u32 s39, s53, 0
    global_load_dwordx4 v[152:155], v9, s[38:39] offset:0
    global_load_dwordx4 v[156:159], v9, s[38:39] offset:1024
    global_load_dwordx4 v[160:163], v9, s[38:39] offset:2048
    global_load_dwordx4 v[164:167], v9, s[38:39] offset:3072
    global_load_dwordx4 v[168:171], v5, s[38:39] offset:0
    global_load_dwordx4 v[172:175], v5, s[38:39] offset:1024
    global_load_dwordx4 v[176:179], v5, s[38:39] offset:2048
    s_add_u32 s38, s50, 43008
    s_addc_u32 s39, s51, 0
    global_load_dwordx4 a[84:87], v16, s[38:39] offset:0
    global_load_dwordx4 a[88:91], v16, s[38:39] offset:512
    global_load_dwordx4 a[92:95], v16, s[38:39] offset:1024
    global_load_dwordx4 a[96:99], v16, s[38:39] offset:1536
    global_load_dwordx4 a[100:103], v16, s[38:39] offset:2048
    global_load_dwordx4 a[104:107], v16, s[38:39] offset:2560
    global_load_dwordx4 a[108:111], v16, s[38:39] offset:3072
    ds_read_b128 v[224:227], v9 offset:4096
    s_waitcnt vmcnt(49) lgkmcnt(1)
    v_mfma_f32_16x16x32_bf16 v[64:67], v[180:183], v[228:231], v[64:67]
    v_mfma_f32_16x16x32_bf16 v[68:71], v[184:187], v[228:231], v[68:71]
    v_mfma_f32_16x16x32_bf16 v[72:75], v[188:191], v[228:231], v[72:75]
    v_mfma_f32_16x16x32_bf16 v[76:79], v[192:195], v[228:231], v[76:79]
    v_mfma_f32_16x16x32_bf16 v[80:83], v[196:199], v[228:231], v[80:83]
    v_mfma_f32_16x16x32_bf16 v[84:87], v[200:203], v[228:231], v[84:87]
    v_mfma_f32_16x16x32_bf16 v[88:91], v[204:207], v[228:231], v[88:91]
    s_add_u32 s38, s52, 200704
    s_addc_u32 s39, s53, 0
    global_load_dwordx4 v[180:183], v9, s[38:39] offset:0
    global_load_dwordx4 v[184:187], v9, s[38:39] offset:1024
    global_load_dwordx4 v[188:191], v9, s[38:39] offset:2048
    global_load_dwordx4 v[192:195], v9, s[38:39] offset:3072
    global_load_dwordx4 v[196:199], v5, s[38:39] offset:0
    global_load_dwordx4 v[200:203], v5, s[38:39] offset:1024
    global_load_dwordx4 v[204:207], v5, s[38:39] offset:2048
    s_add_u32 s38, s50, 57344
    s_addc_u32 s39, s51, 0
    global_load_dwordx4 a[112:115], v16, s[38:39] offset:0
    global_load_dwordx4 a[116:119], v16, s[38:39] offset:512
    global_load_dwordx4 a[120:123], v16, s[38:39] offset:1024
    global_load_dwordx4 a[124:127], v16, s[38:39] offset:1536
    global_load_dwordx4 a[128:131], v16, s[38:39] offset:2048
    global_load_dwordx4 a[132:135], v16, s[38:39] offset:2560
    global_load_dwordx4 a[136:139], v16, s[38:39] offset:3072
    ds_read_b128 v[228:231], v9 offset:5120
    s_waitcnt vmcnt(49) lgkmcnt(1)
    v_mfma_f32_16x16x32_bf16 v[64:67], v[96:99], v[224:227], v[64:67]
    v_mfma_f32_16x16x32_bf16 v[68:71], v[100:103], v[224:227], v[68:71]
    v_mfma_f32_16x16x32_bf16 v[72:75], v[104:107], v[224:227], v[72:75]
    v_mfma_f32_16x16x32_bf16 v[76:79], v[108:111], v[224:227], v[76:79]
    v_mfma_f32_16x16x32_bf16 v[80:83], v[112:115], v[224:227], v[80:83]
    v_mfma_f32_16x16x32_bf16 v[84:87], v[116:119], v[224:227], v[84:87]
    v_mfma_f32_16x16x32_bf16 v[88:91], v[120:123], v[224:227], v[88:91]
    s_add_u32 s38, s52, 229376
    s_addc_u32 s39, s53, 0
    global_load_dwordx4 v[96:99], v9, s[38:39] offset:0
    global_load_dwordx4 v[100:103], v9, s[38:39] offset:1024
    global_load_dwordx4 v[104:107], v9, s[38:39] offset:2048
    global_load_dwordx4 v[108:111], v9, s[38:39] offset:3072
    global_load_dwordx4 v[112:115], v5, s[38:39] offset:0
    global_load_dwordx4 v[116:119], v5, s[38:39] offset:1024
    global_load_dwordx4 v[120:123], v5, s[38:39] offset:2048
    s_add_u32 s38, s50, 71680
    s_addc_u32 s39, s51, 0
    global_load_dwordx4 a[140:143], v16, s[38:39] offset:0
    global_load_dwordx4 a[144:147], v16, s[38:39] offset:512
    global_load_dwordx4 a[148:151], v16, s[38:39] offset:1024
    global_load_dwordx4 a[152:155], v16, s[38:39] offset:1536
    global_load_dwordx4 a[156:159], v16, s[38:39] offset:2048
    global_load_dwordx4 a[160:163], v16, s[38:39] offset:2560
    global_load_dwordx4 a[164:167], v16, s[38:39] offset:3072
    ds_read_b128 v[224:227], v9 offset:6144
    s_waitcnt vmcnt(49) lgkmcnt(1)
    v_mfma_f32_16x16x32_bf16 v[64:67], v[124:127], v[228:231], v[64:67]
    v_mfma_f32_16x16x32_bf16 v[68:71], v[128:131], v[228:231], v[68:71]
    v_mfma_f32_16x16x32_bf16 v[72:75], v[132:135], v[228:231], v[72:75]
    v_mfma_f32_16x16x32_bf16 v[76:79], v[136:139], v[228:231], v[76:79]
    v_mfma_f32_16x16x32_bf16 v[80:83], v[140:143], v[228:231], v[80:83]
    v_mfma_f32_16x16x32_bf16 v[84:87], v[144:147], v[228:231], v[84:87]
    v_mfma_f32_16x16x32_bf16 v[88:91], v[148:151], v[228:231], v[88:91]
    s_add_u32 s38, s52, 258048
    s_addc_u32 s39, s53, 0
    global_load_dwordx4 v[124:127], v9, s[38:39] offset:0
    global_load_dwordx4 v[128:131], v9, s[38:39] offset:1024
    global_load_dwordx4 v[132:135], v9, s[38:39] offset:2048
    global_load_dwordx4 v[136:139], v9, s[38:39] offset:3072
    global_load_dwordx4 v[140:143], v5, s[38:39] offset:0
    global_load_dwordx4 v[144:147], v5, s[38:39] offset:1024
    global_load_dwordx4 v[148:151], v5, s[38:39] offset:2048
    s_add_u32 s38, s50, 86016
    s_addc_u32 s39, s51, 0
    global_load_dwordx4 a[168:171], v16, s[38:39] offset:0
    global_load_dwordx4 a[172:175], v16, s[38:39] offset:512
    global_load_dwordx4 a[176:179], v16, s[38:39] offset:1024
    global_load_dwordx4 a[180:183], v16, s[38:39] offset:1536
    global_load_dwordx4 a[184:187], v16, s[38:39] offset:2048
    global_load_dwordx4 a[188:191], v16, s[38:39] offset:2560
    global_load_dwordx4 a[192:195], v16, s[38:39] offset:3072
    ds_read_b128 v[228:231], v9 offset:7168
    s_waitcnt vmcnt(49) lgkmcnt(1)
    v_mfma_f32_16x16x32_bf16 v[64:67], v[152:155], v[224:227], v[64:67]
    v_mfma_f32_16x16x32_bf16 v[68:71], v[156:159], v[224:227], v[68:71]
    v_mfma_f32_16x16x32_bf16 v[72:75], v[160:163], v[224:227], v[72:75]
    v_mfma_f32_16x16x32_bf16 v[76:79], v[164:167], v[224:227], v[76:79]
    v_mfma_f32_16x16x32_bf16 v[80:83], v[168:171], v[224:227], v[80:83]
    v_mfma_f32_16x16x32_bf16 v[84:87], v[172:175], v[224:227], v[84:87]
    v_mfma_f32_16x16x32_bf16 v[88:91], v[176:179], v[224:227], v[88:91]
    s_add_u32 s38, s52, 286720
    s_addc_u32 s39, s53, 0
    global_load_dwordx4 v[152:155], v9, s[38:39] offset:0
    global_load_dwordx4 v[156:159], v9, s[38:39] offset:1024
    global_load_dwordx4 v[160:163], v9, s[38:39] offset:2048
    global_load_dwordx4 v[164:167], v9, s[38:39] offset:3072
    global_load_dwordx4 v[168:171], v5, s[38:39] offset:0
    global_load_dwordx4 v[172:175], v5, s[38:39] offset:1024
    global_load_dwordx4 v[176:179], v5, s[38:39] offset:2048
    s_add_u32 s38, s50, 100352
    s_addc_u32 s39, s51, 0
    global_load_dwordx4 a[196:199], v16, s[38:39] offset:0
    global_load_dwordx4 a[200:203], v16, s[38:39] offset:512
    global_load_dwordx4 a[204:207], v16, s[38:39] offset:1024
    global_load_dwordx4 a[208:211], v16, s[38:39] offset:1536
    global_load_dwordx4 a[212:215], v16, s[38:39] offset:2048
    global_load_dwordx4 a[216:219], v16, s[38:39] offset:2560
    global_load_dwordx4 a[220:223], v16, s[38:39] offset:3072
    ds_read_b128 v[224:227], v9 offset:8192
    s_waitcnt vmcnt(49) lgkmcnt(1)
    v_mfma_f32_16x16x32_bf16 v[64:67], v[180:183], v[228:231], v[64:67]
    v_mfma_f32_16x16x32_bf16 v[68:71], v[184:187], v[228:231], v[68:71]
    v_mfma_f32_16x16x32_bf16 v[72:75], v[188:191], v[228:231], v[72:75]
    v_mfma_f32_16x16x32_bf16 v[76:79], v[192:195], v[228:231], v[76:79]
    v_mfma_f32_16x16x32_bf16 v[80:83], v[196:199], v[228:231], v[80:83]
    v_mfma_f32_16x16x32_bf16 v[84:87], v[200:203], v[228:231], v[84:87]
    v_mfma_f32_16x16x32_bf16 v[88:91], v[204:207], v[228:231], v[88:91]
    s_add_u32 s38, s52, 315392
    s_addc_u32 s39, s53, 0
    global_load_dwordx4 v[180:183], v9, s[38:39] offset:0
    global_load_dwordx4 v[184:187], v9, s[38:39] offset:1024
    global_load_dwordx4 v[188:191], v9, s[38:39] offset:2048
    global_load_dwordx4 v[192:195], v9, s[38:39] offset:3072
    global_load_dwordx4 v[196:199], v5, s[38:39] offset:0
    global_load_dwordx4 v[200:203], v5, s[38:39] offset:1024
    global_load_dwordx4 v[204:207], v5, s[38:39] offset:2048
    ds_read_b128 v[228:231], v9 offset:9216
    s_waitcnt vmcnt(42) lgkmcnt(1)
    v_mfma_f32_16x16x32_bf16 v[64:67], v[96:99], v[224:227], v[64:67]
    v_mfma_f32_16x16x32_bf16 v[68:71], v[100:103], v[224:227], v[68:71]
    v_mfma_f32_16x16x32_bf16 v[72:75], v[104:107], v[224:227], v[72:75]
    v_mfma_f32_16x16x32_bf16 v[76:79], v[108:111], v[224:227], v[76:79]
    v_mfma_f32_16x16x32_bf16 v[80:83], v[112:115], v[224:227], v[80:83]
    v_mfma_f32_16x16x32_bf16 v[84:87], v[116:119], v[224:227], v[84:87]
    v_mfma_f32_16x16x32_bf16 v[88:91], v[120:123], v[224:227], v[88:91]
    s_add_u32 s38, s52, 344064
    s_addc_u32 s39, s53, 0
    global_load_dwordx4 v[96:99], v9, s[38:39] offset:0
    global_load_dwordx4 v[100:103], v9, s[38:39] offset:1024
    global_load_dwordx4 v[104:107], v9, s[38:39] offset:2048
    global_load_dwordx4 v[108:111], v9, s[38:39] offset:3072
    global_load_dwordx4 v[112:115], v5, s[38:39] offset:0
    global_load_dwordx4 v[116:119], v5, s[38:39] offset:1024
    global_load_dwordx4 v[120:123], v5, s[38:39] offset:2048
    ds_read_b128 v[224:227], v9 offset:10240
    s_waitcnt vmcnt(35) lgkmcnt(1)
    v_mfma_f32_16x16x32_bf16 v[64:67], v[124:127], v[228:231], v[64:67]
    v_mfma_f32_16x16x32_bf16 v[68:71], v[128:131], v[228:231], v[68:71]
    v_mfma_f32_16x16x32_bf16 v[72:75], v[132:135], v[228:231], v[72:75]
    v_mfma_f32_16x16x32_bf16 v[76:79], v[136:139], v[228:231], v[76:79]
    v_mfma_f32_16x16x32_bf16 v[80:83], v[140:143], v[228:231], v[80:83]
    v_mfma_f32_16x16x32_bf16 v[84:87], v[144:147], v[228:231], v[84:87]
    v_mfma_f32_16x16x32_bf16 v[88:91], v[148:151], v[228:231], v[88:91]
    s_add_u32 s38, s52, 372736
    s_addc_u32 s39, s53, 0
    global_load_dwordx4 v[124:127], v9, s[38:39] offset:0
    global_load_dwordx4 v[128:131], v9, s[38:39] offset:1024
    global_load_dwordx4 v[132:135], v9, s[38:39] offset:2048
    global_load_dwordx4 v[136:139], v9, s[38:39] offset:3072
    global_load_dwordx4 v[140:143], v5, s[38:39] offset:0
    global_load_dwordx4 v[144:147], v5, s[38:39] offset:1024
    global_load_dwordx4 v[148:151], v5, s[38:39] offset:2048
    ds_read_b128 v[228:231], v9 offset:11264
    s_waitcnt vmcnt(28) lgkmcnt(1)
    v_mfma_f32_16x16x32_bf16 v[64:67], v[152:155], v[224:227], v[64:67]
    v_mfma_f32_16x16x32_bf16 v[68:71], v[156:159], v[224:227], v[68:71]
    v_mfma_f32_16x16x32_bf16 v[72:75], v[160:163], v[224:227], v[72:75]
    v_mfma_f32_16x16x32_bf16 v[76:79], v[164:167], v[224:227], v[76:79]
    v_mfma_f32_16x16x32_bf16 v[80:83], v[168:171], v[224:227], v[80:83]
    v_mfma_f32_16x16x32_bf16 v[84:87], v[172:175], v[224:227], v[84:87]
    v_mfma_f32_16x16x32_bf16 v[88:91], v[176:179], v[224:227], v[88:91]
    s_add_u32 s38, s52, 401408
    s_addc_u32 s39, s53, 0
    global_load_dwordx4 v[152:155], v9, s[38:39] offset:0
    global_load_dwordx4 v[156:159], v9, s[38:39] offset:1024
    global_load_dwordx4 v[160:163], v9, s[38:39] offset:2048
    global_load_dwordx4 v[164:167], v9, s[38:39] offset:3072
    global_load_dwordx4 v[168:171], v5, s[38:39] offset:0
    global_load_dwordx4 v[172:175], v5, s[38:39] offset:1024
    global_load_dwordx4 v[176:179], v5, s[38:39] offset:2048
    ds_read_b128 v[224:227], v9 offset:12288
    s_waitcnt vmcnt(21) lgkmcnt(1)
    v_mfma_f32_16x16x32_bf16 v[64:67], v[180:183], v[228:231], v[64:67]
    v_mfma_f32_16x16x32_bf16 v[68:71], v[184:187], v[228:231], v[68:71]
    v_mfma_f32_16x16x32_bf16 v[72:75], v[188:191], v[228:231], v[72:75]
    v_mfma_f32_16x16x32_bf16 v[76:79], v[192:195], v[228:231], v[76:79]
    v_mfma_f32_16x16x32_bf16 v[80:83], v[196:199], v[228:231], v[80:83]
    v_mfma_f32_16x16x32_bf16 v[84:87], v[200:203], v[228:231], v[84:87]
    v_mfma_f32_16x16x32_bf16 v[88:91], v[204:207], v[228:231], v[88:91]
    s_add_u32 s38, s52, 430080
    s_addc_u32 s39, s53, 0
    global_load_dwordx4 v[180:183], v9, s[38:39] offset:0
    global_load_dwordx4 v[184:187], v9, s[38:39] offset:1024
    global_load_dwordx4 v[188:191], v9, s[38:39] offset:2048
    global_load_dwordx4 v[192:195], v9, s[38:39] offset:3072
    global_load_dwordx4 v[196:199], v5, s[38:39] offset:0
    global_load_dwordx4 v[200:203], v5, s[38:39] offset:1024
    global_load_dwordx4 v[204:207], v5, s[38:39] offset:2048
    ds_read_b128 v[228:231], v9 offset:13312
    s_waitcnt vmcnt(21) lgkmcnt(1)
    v_mfma_f32_16x16x32_bf16 v[64:67], v[96:99], v[224:227], v[64:67]
    v_mfma_f32_16x16x32_bf16 v[68:71], v[100:103], v[224:227], v[68:71]
    v_mfma_f32_16x16x32_bf16 v[72:75], v[104:107], v[224:227], v[72:75]
    v_mfma_f32_16x16x32_bf16 v[76:79], v[108:111], v[224:227], v[76:79]
    v_mfma_f32_16x16x32_bf16 v[80:83], v[112:115], v[224:227], v[80:83]
    v_mfma_f32_16x16x32_bf16 v[84:87], v[116:119], v[224:227], v[84:87]
    v_mfma_f32_16x16x32_bf16 v[88:91], v[120:123], v[224:227], v[88:91]
    ds_read_b128 v[224:227], v9 offset:14336
    s_waitcnt vmcnt(14) lgkmcnt(1)
    v_mfma_f32_16x16x32_bf16 v[64:67], v[124:127], v[228:231], v[64:67]
    v_mfma_f32_16x16x32_bf16 v[68:71], v[128:131], v[228:231], v[68:71]
    v_mfma_f32_16x16x32_bf16 v[72:75], v[132:135], v[228:231], v[72:75]
    v_mfma_f32_16x16x32_bf16 v[76:79], v[136:139], v[228:231], v[76:79]
    v_mfma_f32_16x16x32_bf16 v[80:83], v[140:143], v[228:231], v[80:83]
    v_mfma_f32_16x16x32_bf16 v[84:87], v[144:147], v[228:231], v[84:87]
    v_mfma_f32_16x16x32_bf16 v[88:91], v[148:151], v[228:231], v[88:91]
    ds_read_b128 v[228:231], v9 offset:15360
    s_waitcnt vmcnt(7) lgkmcnt(1)
    v_mfma_f32_16x16x32_bf16 v[64:67], v[152:155], v[224:227], v[64:67]
    v_mfma_f32_16x16x32_bf16 v[68:71], v[156:159], v[224:227], v[68:71]
    v_mfma_f32_16x16x32_bf16 v[72:75], v[160:163], v[224:227], v[72:75]
    v_mfma_f32_16x16x32_bf16 v[76:79], v[164:167], v[224:227], v[76:79]
    v_mfma_f32_16x16x32_bf16 v[80:83], v[168:171], v[224:227], v[80:83]
    v_mfma_f32_16x16x32_bf16 v[84:87], v[172:175], v[224:227], v[84:87]
    v_mfma_f32_16x16x32_bf16 v[88:91], v[176:179], v[224:227], v[88:91]
    ds_read_b128 v[224:227], v9 offset:16384
    s_waitcnt vmcnt(0) lgkmcnt(1)
    v_mfma_f32_16x16x32_bf16 v[64:67], v[180:183], v[228:231], v[64:67]
    v_mfma_f32_16x16x32_bf16 v[68:71], v[184:187], v[228:231], v[68:71]
    v_mfma_f32_16x16x32_bf16 v[72:75], v[188:191], v[228:231], v[72:75]
    v_mfma_f32_16x16x32_bf16 v[76:79], v[192:195], v[228:231], v[76:79]
    v_mfma_f32_16x16x32_bf16 v[80:83], v[196:199], v[228:231], v[80:83]
    v_mfma_f32_16x16x32_bf16 v[84:87], v[200:203], v[228:231], v[84:87]
    v_mfma_f32_16x16x32_bf16 v[88:91], v[204:207], v[228:231], v[88:91]
    ds_read_b128 v[228:231], v9 offset:17408
    s_waitcnt vmcnt(0) lgkmcnt(1)
    v_mfma_f32_16x16x32_bf16 v[64:67], a[0:3], v[224:227], v[64:67]
    v_mfma_f32_16x16x32_bf16 v[68:71], a[4:7], v[224:227], v[68:71]
    v_mfma_f32_16x16x32_bf16 v[72:75], a[8:11], v[224:227], v[72:75]
    v_mfma_f32_16x16x32_bf16 v[76:79], a[12:15], v[224:227], v[76:79]
    v_mfma_f32_16x16x32_bf16 v[80:83], a[16:19], v[224:227], v[80:83]
    v_mfma_f32_16x16x32_bf16 v[84:87], a[20:23], v[224:227], v[84:87]
    v_mfma_f32_16x16x32_bf16 v[88:91], a[24:27], v[224:227], v[88:91]
    ds_read_b128 v[224:227], v9 offset:18432
    s_waitcnt vmcnt(0) lgkmcnt(1)
    v_mfma_f32_16x16x32_bf16 v[64:67], a[28:31], v[228:231], v[64:67]
    v_mfma_f32_16x16x32_bf16 v[68:71], a[32:35], v[228:231], v[68:71]
    v_mfma_f32_16x16x32_bf16 v[72:75], a[36:39], v[228:231], v[72:75]
    v_mfma_f32_16x16x32_bf16 v[76:79], a[40:43], v[228:231], v[76:79]
    v_mfma_f32_16x16x32_bf16 v[80:83], a[44:47], v[228:231], v[80:83]
    v_mfma_f32_16x16x32_bf16 v[84:87], a[48:51], v[228:231], v[84:87]
    v_mfma_f32_16x16x32_bf16 v[88:91], a[52:55], v[228:231], v[88:91]
    ds_read_b128 v[228:231], v9 offset:19456
    s_waitcnt vmcnt(0) lgkmcnt(1)
    v_mfma_f32_16x16x32_bf16 v[64:67], a[56:59], v[224:227], v[64:67]
    v_mfma_f32_16x16x32_bf16 v[68:71], a[60:63], v[224:227], v[68:71]
    v_mfma_f32_16x16x32_bf16 v[72:75], a[64:67], v[224:227], v[72:75]
    v_mfma_f32_16x16x32_bf16 v[76:79], a[68:71], v[224:227], v[76:79]
    v_mfma_f32_16x16x32_bf16 v[80:83], a[72:75], v[224:227], v[80:83]
    v_mfma_f32_16x16x32_bf16 v[84:87], a[76:79], v[224:227], v[84:87]
    v_mfma_f32_16x16x32_bf16 v[88:91], a[80:83], v[224:227], v[88:91]
    ds_read_b128 v[224:227], v9 offset:20480
    s_waitcnt vmcnt(0) lgkmcnt(1)
    v_mfma_f32_16x16x32_bf16 v[64:67], a[84:87], v[228:231], v[64:67]
    v_mfma_f32_16x16x32_bf16 v[68:71], a[88:91], v[228:231], v[68:71]
    v_mfma_f32_16x16x32_bf16 v[72:75], a[92:95], v[228:231], v[72:75]
    v_mfma_f32_16x16x32_bf16 v[76:79], a[96:99], v[228:231], v[76:79]
    v_mfma_f32_16x16x32_bf16 v[80:83], a[100:103], v[228:231], v[80:83]
    v_mfma_f32_16x16x32_bf16 v[84:87], a[104:107], v[228:231], v[84:87]
    v_mfma_f32_16x16x32_bf16 v[88:91], a[108:111], v[228:231], v[88:91]
    ds_read_b128 v[228:231], v9 offset:21504
    s_waitcnt vmcnt(0) lgkmcnt(1)
    v_mfma_f32_16x16x32_bf16 v[64:67], a[112:115], v[224:227], v[64:67]
    v_mfma_f32_16x16x32_bf16 v[68:71], a[116:119], v[224:227], v[68:71]
    v_mfma_f32_16x16x32_bf16 v[72:75], a[120:123], v[224:227], v[72:75]
    v_mfma_f32_16x16x32_bf16 v[76:79], a[124:127], v[224:227], v[76:79]
    v_mfma_f32_16x16x32_bf16 v[80:83], a[128:131], v[224:227], v[80:83]
    v_mfma_f32_16x16x32_bf16 v[84:87], a[132:135], v[224:227], v[84:87]
    v_mfma_f32_16x16x32_bf16 v[88:91], a[136:139], v[224:227], v[88:91]
    ds_read_b128 v[224:227], v9 offset:22528
    s_waitcnt vmcnt(0) lgkmcnt(1)
    v_mfma_f32_16x16x32_bf16 v[64:67], a[140:143], v[228:231], v[64:67]
    v_mfma_f32_16x16x32_bf16 v[68:71], a[144:147], v[228:231], v[68:71]
    v_mfma_f32_16x16x32_bf16 v[72:75], a[148:151], v[228:231], v[72:75]
    v_mfma_f32_16x16x32_bf16 v[76:79], a[152:155], v[228:231], v[76:79]
    v_mfma_f32_16x16x32_bf16 v[80:83], a[156:159], v[228:231], v[80:83]
    v_mfma_f32_16x16x32_bf16 v[84:87], a[160:163], v[228:231], v[84:87]
    v_mfma_f32_16x16x32_bf16 v[88:91], a[164:167], v[228:231], v[88:91]
    ds_read_b128 v[228:231], v9 offset:23552
    s_waitcnt vmcnt(0) lgkmcnt(1)
    v_mfma_f32_16x16x32_bf16 v[64:67], a[168:171], v[224:227], v[64:67]
    v_mfma_f32_16x16x32_bf16 v[68:71], a[172:175], v[224:227], v[68:71]
    v_mfma_f32_16x16x32_bf16 v[72:75], a[176:179], v[224:227], v[72:75]
    v_mfma_f32_16x16x32_bf16 v[76:79], a[180:183], v[224:227], v[76:79]
    v_mfma_f32_16x16x32_bf16 v[80:83], a[184:187], v[224:227], v[80:83]
    v_mfma_f32_16x16x32_bf16 v[84:87], a[188:191], v[224:227], v[84:87]
    v_mfma_f32_16x16x32_bf16 v[88:91], a[192:195], v[224:227], v[88:91]
    s_waitcnt vmcnt(0) lgkmcnt(0)
    v_mfma_f32_16x16x32_bf16 v[64:67], a[196:199], v[228:231], v[64:67]
    v_mfma_f32_16x16x32_bf16 v[68:71], a[200:203], v[228:231], v[68:71]
    v_mfma_f32_16x16x32_bf16 v[72:75], a[204:207], v[228:231], v[72:75]
    v_mfma_f32_16x16x32_bf16 v[76:79], a[208:211], v[228:231], v[76:79]
    v_mfma_f32_16x16x32_bf16 v[80:83], a[212:215], v[228:231], v[80:83]
    v_mfma_f32_16x16x32_bf16 v[84:87], a[216:219], v[228:231], v[84:87]
    v_mfma_f32_16x16x32_bf16 v[88:91], a[220:223], v[228:231], v[88:91]
    s_nop 9
    s_lshl_b32 s20, s2, 5
    s_add_u32 s20, s20, 0
    v_add_u32 v10, s20, v2
    v_mul_u32_u24 v10, 896, v10
    s_mul_i32 s21, s10, 224
    v_lshl_add_u32 v10, v3, 3, v10
    v_add_u32 v10, s21, v10
    s_mul_i32 s21, s10, 448
    v_lshlrev_b32 v12, 4, v3
    v_add_u32 v12, s21, v12
    s_add_u32 s22, s4, 0xe00
    s_addc_u32 s23, s5, 0
    s_add_u32 s24, s4, 0x6c55000
    s_addc_u32 s25, s5, 0
    global_load_dwordx4 v[160:163], v12, s[22:23] offset:0
    global_load_dwordx2 v[120:121], v10, s[6:7] offset:0
    global_load_dwordx4 v[164:167], v12, s[22:23] offset:64
    global_load_dwordx2 v[122:123], v10, s[6:7] offset:32
    global_load_dwordx4 v[168:171], v12, s[22:23] offset:128
    global_load_dwordx2 v[124:125], v10, s[6:7] offset:64
    global_load_dwordx4 v[172:175], v12, s[22:23] offset:192
    global_load_dwordx2 v[126:127], v10, s[6:7] offset:96
    global_load_dwordx4 v[176:179], v12, s[22:23] offset:256
    global_load_dwordx2 v[128:129], v10, s[6:7] offset:128
    global_load_dwordx4 v[180:183], v12, s[22:23] offset:320
    global_load_dwordx2 v[130:131], v10, s[6:7] offset:160
    global_load_dwordx4 v[184:187], v12, s[22:23] offset:384
    global_load_dwordx2 v[132:133], v10, s[6:7] offset:192
    s_waitcnt vmcnt(0)
    v_cvt_pk_bf16_f32 v32, v64, v65
    v_lshlrev_b32 v64, 16, v32
    v_and_b32 v65, 0xffff0000, v32
    v_cvt_pk_bf16_f32 v32, v66, v67
    v_lshlrev_b32 v66, 16, v32
    v_and_b32 v67, 0xffff0000, v32
    v_mul_f32 v64, v64, v160
    v_mul_f32 v65, v65, v161
    v_mul_f32 v66, v66, v162
    v_mul_f32 v67, v67, v163
    v_cvt_pk_bf16_f32 v32, v64, v65
    v_lshlrev_b32 v64, 16, v32
    v_and_b32 v65, 0xffff0000, v32
    v_cvt_pk_bf16_f32 v32, v66, v67
    v_lshlrev_b32 v66, 16, v32
    v_and_b32 v67, 0xffff0000, v32
    v_lshlrev_b32 v32, 16, v120
    v_and_b32 v33, 0xffff0000, v120
    v_add_f32 v64, v64, v32
    v_add_f32 v65, v65, v33
    v_lshlrev_b32 v32, 16, v121
    v_and_b32 v33, 0xffff0000, v121
    v_add_f32 v66, v66, v32
    v_add_f32 v67, v67, v33
    v_cvt_pk_bf16_f32 v120, v64, v65
    v_cvt_pk_bf16_f32 v121, v66, v67
    global_store_dwordx2 v10, v[120:121], s[24:25] offset:0 sc1
    v_lshlrev_b32 v64, 16, v120
    v_and_b32 v65, 0xffff0000, v120
    v_lshlrev_b32 v66, 16, v121
    v_and_b32 v67, 0xffff0000, v121
    v_cvt_pk_bf16_f32 v32, v68, v69
    v_lshlrev_b32 v68, 16, v32
    v_and_b32 v69, 0xffff0000, v32
    v_cvt_pk_bf16_f32 v32, v70, v71
    v_lshlrev_b32 v70, 16, v32
    v_and_b32 v71, 0xffff0000, v32
    v_mul_f32 v68, v68, v164
    v_mul_f32 v69, v69, v165
    v_mul_f32 v70, v70, v166
    v_mul_f32 v71, v71, v167
    v_cvt_pk_bf16_f32 v32, v68, v69
    v_lshlrev_b32 v68, 16, v32
    v_and_b32 v69, 0xffff0000, v32
    v_cvt_pk_bf16_f32 v32, v70, v71
    v_lshlrev_b32 v70, 16, v32
    v_and_b32 v71, 0xffff0000, v32
    v_lshlrev_b32 v32, 16, v122
    v_and_b32 v33, 0xffff0000, v122
    v_add_f32 v68, v68, v32
    v_add_f32 v69, v69, v33
    v_lshlrev_b32 v32, 16, v123
    v_and_b32 v33, 0xffff0000, v123
    v_add_f32 v70, v70, v32
    v_add_f32 v71, v71, v33
    v_cvt_pk_bf16_f32 v122, v68, v69
    v_cvt_pk_bf16_f32 v123, v70, v71
    global_store_dwordx2 v10, v[122:123], s[24:25] offset:32 sc1
    v_lshlrev_b32 v68, 16, v122
    v_and_b32 v69, 0xffff0000, v122
    v_lshlrev_b32 v70, 16, v123
    v_and_b32 v71, 0xffff0000, v123
    v_cvt_pk_bf16_f32 v32, v72, v73
    v_lshlrev_b32 v72, 16, v32
    v_and_b32 v73, 0xffff0000, v32
    v_cvt_pk_bf16_f32 v32, v74, v75
    v_lshlrev_b32 v74, 16, v32
    v_and_b32 v75, 0xffff0000, v32
    v_mul_f32 v72, v72, v168
    v_mul_f32 v73, v73, v169
    v_mul_f32 v74, v74, v170
    v_mul_f32 v75, v75, v171
    v_cvt_pk_bf16_f32 v32, v72, v73
    v_lshlrev_b32 v72, 16, v32
    v_and_b32 v73, 0xffff0000, v32
    v_cvt_pk_bf16_f32 v32, v74, v75
    v_lshlrev_b32 v74, 16, v32
    v_and_b32 v75, 0xffff0000, v32
    v_lshlrev_b32 v32, 16, v124
    v_and_b32 v33, 0xffff0000, v124
    v_add_f32 v72, v72, v32
    v_add_f32 v73, v73, v33
    v_lshlrev_b32 v32, 16, v125
    v_and_b32 v33, 0xffff0000, v125
    v_add_f32 v74, v74, v32
    v_add_f32 v75, v75, v33
    v_cvt_pk_bf16_f32 v124, v72, v73
    v_cvt_pk_bf16_f32 v125, v74, v75
    global_store_dwordx2 v10, v[124:125], s[24:25] offset:64 sc1
    v_lshlrev_b32 v72, 16, v124
    v_and_b32 v73, 0xffff0000, v124
    v_lshlrev_b32 v74, 16, v125
    v_and_b32 v75, 0xffff0000, v125
    v_cvt_pk_bf16_f32 v32, v76, v77
    v_lshlrev_b32 v76, 16, v32
    v_and_b32 v77, 0xffff0000, v32
    v_cvt_pk_bf16_f32 v32, v78, v79
    v_lshlrev_b32 v78, 16, v32
    v_and_b32 v79, 0xffff0000, v32
    v_mul_f32 v76, v76, v172
    v_mul_f32 v77, v77, v173
    v_mul_f32 v78, v78, v174
    v_mul_f32 v79, v79, v175
    v_cvt_pk_bf16_f32 v32, v76, v77
    v_lshlrev_b32 v76, 16, v32
    v_and_b32 v77, 0xffff0000, v32
    v_cvt_pk_bf16_f32 v32, v78, v79
    v_lshlrev_b32 v78, 16, v32
    v_and_b32 v79, 0xffff0000, v32
    v_lshlrev_b32 v32, 16, v126
    v_and_b32 v33, 0xffff0000, v126
    v_add_f32 v76, v76, v32
    v_add_f32 v77, v77, v33
    v_lshlrev_b32 v32, 16, v127
    v_and_b32 v33, 0xffff0000, v127
    v_add_f32 v78, v78, v32
    v_add_f32 v79, v79, v33
    v_cvt_pk_bf16_f32 v126, v76, v77
    v_cvt_pk_bf16_f32 v127, v78, v79
    global_store_dwordx2 v10, v[126:127], s[24:25] offset:96 sc1
    v_lshlrev_b32 v76, 16, v126
    v_and_b32 v77, 0xffff0000, v126
    v_lshlrev_b32 v78, 16, v127
    v_and_b32 v79, 0xffff0000, v127
    v_cvt_pk_bf16_f32 v32, v80, v81
    v_lshlrev_b32 v80, 16, v32
    v_and_b32 v81, 0xffff0000, v32
    v_cvt_pk_bf16_f32 v32, v82, v83
    v_lshlrev_b32 v82, 16, v32
    v_and_b32 v83, 0xffff0000, v32
    v_mul_f32 v80, v80, v176
    v_mul_f32 v81, v81, v177
    v_mul_f32 v82, v82, v178
    v_mul_f32 v83, v83, v179
    v_cvt_pk_bf16_f32 v32, v80, v81
    v_lshlrev_b32 v80, 16, v32
    v_and_b32 v81, 0xffff0000, v32
    v_cvt_pk_bf16_f32 v32, v82, v83
    v_lshlrev_b32 v82, 16, v32
    v_and_b32 v83, 0xffff0000, v32
    v_lshlrev_b32 v32, 16, v128
    v_and_b32 v33, 0xffff0000, v128
    v_add_f32 v80, v80, v32
    v_add_f32 v81, v81, v33
    v_lshlrev_b32 v32, 16, v129
    v_and_b32 v33, 0xffff0000, v129
    v_add_f32 v82, v82, v32
    v_add_f32 v83, v83, v33
    v_cvt_pk_bf16_f32 v128, v80, v81
    v_cvt_pk_bf16_f32 v129, v82, v83
    global_store_dwordx2 v10, v[128:129], s[24:25] offset:128 sc1
    v_lshlrev_b32 v80, 16, v128
    v_and_b32 v81, 0xffff0000, v128
    v_lshlrev_b32 v82, 16, v129
    v_and_b32 v83, 0xffff0000, v129
    v_cvt_pk_bf16_f32 v32, v84, v85
    v_lshlrev_b32 v84, 16, v32
    v_and_b32 v85, 0xffff0000, v32
    v_cvt_pk_bf16_f32 v32, v86, v87
    v_lshlrev_b32 v86, 16, v32
    v_and_b32 v87, 0xffff0000, v32
    v_mul_f32 v84, v84, v180
    v_mul_f32 v85, v85, v181
    v_mul_f32 v86, v86, v182
    v_mul_f32 v87, v87, v183
    v_cvt_pk_bf16_f32 v32, v84, v85
    v_lshlrev_b32 v84, 16, v32
    v_and_b32 v85, 0xffff0000, v32
    v_cvt_pk_bf16_f32 v32, v86, v87
    v_lshlrev_b32 v86, 16, v32
    v_and_b32 v87, 0xffff0000, v32
    v_lshlrev_b32 v32, 16, v130
    v_and_b32 v33, 0xffff0000, v130
    v_add_f32 v84, v84, v32
    v_add_f32 v85, v85, v33
    v_lshlrev_b32 v32, 16, v131
    v_and_b32 v33, 0xffff0000, v131
    v_add_f32 v86, v86, v32
    v_add_f32 v87, v87, v33
    v_cvt_pk_bf16_f32 v130, v84, v85
    v_cvt_pk_bf16_f32 v131, v86, v87
    global_store_dwordx2 v10, v[130:131], s[24:25] offset:160 sc1
    v_lshlrev_b32 v84, 16, v130
    v_and_b32 v85, 0xffff0000, v130
    v_lshlrev_b32 v86, 16, v131
    v_and_b32 v87, 0xffff0000, v131
    v_cvt_pk_bf16_f32 v32, v88, v89
    v_lshlrev_b32 v88, 16, v32
    v_and_b32 v89, 0xffff0000, v32
    v_cvt_pk_bf16_f32 v32, v90, v91
    v_lshlrev_b32 v90, 16, v32
    v_and_b32 v91, 0xffff0000, v32
    v_mul_f32 v88, v88, v184
    v_mul_f32 v89, v89, v185
    v_mul_f32 v90, v90, v186
    v_mul_f32 v91, v91, v187
    v_cvt_pk_bf16_f32 v32, v88, v89
    v_lshlrev_b32 v88, 16, v32
    v_and_b32 v89, 0xffff0000, v32
    v_cvt_pk_bf16_f32 v32, v90, v91
    v_lshlrev_b32 v90, 16, v32
    v_and_b32 v91, 0xffff0000, v32
    v_lshlrev_b32 v32, 16, v132
    v_and_b32 v33, 0xffff0000, v132
    v_add_f32 v88, v88, v32
    v_add_f32 v89, v89, v33
    v_lshlrev_b32 v32, 16, v133
    v_and_b32 v33, 0xffff0000, v133
    v_add_f32 v90, v90, v32
    v_add_f32 v91, v91, v33
    v_cvt_pk_bf16_f32 v132, v88, v89
    v_cvt_pk_bf16_f32 v133, v90, v91
    global_store_dwordx2 v10, v[132:133], s[24:25] offset:192 sc1
    v_lshlrev_b32 v88, 16, v132
    v_and_b32 v89, 0xffff0000, v132
    v_lshlrev_b32 v90, 16, v133
    v_and_b32 v91, 0xffff0000, v133
    s_add_u32 s22, s4, 0x1500
    s_addc_u32 s23, s5, 0
    s_add_u32 s26, s4, 0x1c00
    s_addc_u32 s27, s5, 0
    s_add_u32 s24, s4, 0x6e15000
    s_addc_u32 s25, s5, 0
    global_load_dwordx4 v[160:163], v12, s[22:23] offset:0
    global_load_dwordx4 v[192:195], v12, s[26:27] offset:0
    global_load_dwordx4 v[164:167], v12, s[22:23] offset:64
    global_load_dwordx4 v[196:199], v12, s[26:27] offset:64
    global_load_dwordx4 v[168:171], v12, s[22:23] offset:128
    global_load_dwordx4 v[200:203], v12, s[26:27] offset:128
    global_load_dwordx4 v[172:175], v12, s[22:23] offset:192
    global_load_dwordx4 v[204:207], v12, s[26:27] offset:192
    global_load_dwordx4 v[176:179], v12, s[22:23] offset:256
    global_load_dwordx4 v[208:211], v12, s[26:27] offset:256
    global_load_dwordx4 v[180:183], v12, s[22:23] offset:320
    global_load_dwordx4 v[212:215], v12, s[26:27] offset:320
    global_load_dwordx4 v[184:187], v12, s[22:23] offset:384
    global_load_dwordx4 v[216:219], v12, s[26:27] offset:384
    v_lshlrev_b32 v34, 2, v2
    v_add_u32 v34, 24576, v34
    s_lshl_b32 s21, s10, 6
    v_add_u32 v33, s21, v34
    v_add_f32 v40, v64, v65
    v_add_f32 v40, v40, v66
    v_add_f32 v40, v40, v67
    v_add_f32 v40, v40, v68
    v_add_f32 v40, v40, v69
    v_add_f32 v40, v40, v70
    v_add_f32 v40, v40, v71
    v_add_f32 v40, v40, v72
    v_add_f32 v40, v40, v73
    v_add_f32 v40, v40, v74
    v_add_f32 v40, v40, v75
    v_add_f32 v40, v40, v76
    v_add_f32 v40, v40, v77
    v_add_f32 v40, v40, v78
    v_add_f32 v40, v40, v79
    v_add_f32 v40, v40, v80
    v_add_f32 v40, v40, v81
    v_add_f32 v40, v40, v82
    v_add_f32 v40, v40, v83
    v_add_f32 v40, v40, v84
    v_add_f32 v40, v40, v85
    v_add_f32 v40, v40, v86
    v_add_f32 v40, v40, v87
    v_add_f32 v40, v40, v88
    v_add_f32 v40, v40, v89
    v_add_f32 v40, v40, v90
    v_add_f32 v40, v40, v91
    v_mov_b32 v36, v40
    s_nop 1
    v_permlane16_swap_b32 v36, v40
    s_nop 1
    v_add_f32 v40, v36, v40
    v_mov_b32 v36, v40
    s_nop 1
    v_permlane32_swap_b32 v36, v40
    s_nop 1
    v_add_f32 v40, v36, v40
    ds_write_b32 v33, v40 offset:0
    s_waitcnt lgkmcnt(0)
    s_barrier
    ds_read_b32 v36, v34 offset:0
    ds_read_b32 v37, v34 offset:64
    ds_read_b32 v38, v34 offset:128
    ds_read_b32 v39, v34 offset:192
    s_waitcnt lgkmcnt(0)
    v_add_f32 v36, v36, v37
    v_add_f32 v38, v38, v39
    v_add_f32 v40, v36, v38
    v_mul_f32 v40, 0x3b124925, v40
    v_mov_b32 v41, 0
    v_sub_f32 v42, v64, v40
    v_fmac_f32 v41, v42, v42
    v_sub_f32 v42, v65, v40
    v_fmac_f32 v41, v42, v42
    v_sub_f32 v42, v66, v40
    v_fmac_f32 v41, v42, v42
    v_sub_f32 v42, v67, v40
    v_fmac_f32 v41, v42, v42
    v_sub_f32 v42, v68, v40
    v_fmac_f32 v41, v42, v42
    v_sub_f32 v42, v69, v40
    v_fmac_f32 v41, v42, v42
    v_sub_f32 v42, v70, v40
    v_fmac_f32 v41, v42, v42
    v_sub_f32 v42, v71, v40
    v_fmac_f32 v41, v42, v42
    v_sub_f32 v42, v72, v40
    v_fmac_f32 v41, v42, v42
    v_sub_f32 v42, v73, v40
    v_fmac_f32 v41, v42, v42
    v_sub_f32 v42, v74, v40
    v_fmac_f32 v41, v42, v42
    v_sub_f32 v42, v75, v40
    v_fmac_f32 v41, v42, v42
    v_sub_f32 v42, v76, v40
    v_fmac_f32 v41, v42, v42
    v_sub_f32 v42, v77, v40
    v_fmac_f32 v41, v42, v42
    v_sub_f32 v42, v78, v40
    v_fmac_f32 v41, v42, v42
    v_sub_f32 v42, v79, v40
    v_fmac_f32 v41, v42, v42
    v_sub_f32 v42, v80, v40
    v_fmac_f32 v41, v42, v42
    v_sub_f32 v42, v81, v40
    v_fmac_f32 v41, v42, v42
    v_sub_f32 v42, v82, v40
    v_fmac_f32 v41, v42, v42
    v_sub_f32 v42, v83, v40
    v_fmac_f32 v41, v42, v42
    v_sub_f32 v42, v84, v40
    v_fmac_f32 v41, v42, v42
    v_sub_f32 v42, v85, v40
    v_fmac_f32 v41, v42, v42
    v_sub_f32 v42, v86, v40
    v_fmac_f32 v41, v42, v42
    v_sub_f32 v42, v87, v40
    v_fmac_f32 v41, v42, v42
    v_sub_f32 v42, v88, v40
    v_fmac_f32 v41, v42, v42
    v_sub_f32 v42, v89, v40
    v_fmac_f32 v41, v42, v42
    v_sub_f32 v42, v90, v40
    v_fmac_f32 v41, v42, v42
    v_sub_f32 v42, v91, v40
    v_fmac_f32 v41, v42, v42
    v_mov_b32 v36, v41
    s_nop 1
    v_permlane16_swap_b32 v36, v41
    s_nop 1
    v_add_f32 v41, v36, v41
    v_mov_b32 v36, v41
    s_nop 1
    v_permlane32_swap_b32 v36, v41
    s_nop 1
    v_add_f32 v41, v36, v41
    ds_write_b32 v33, v41 offset:256
    s_waitcnt lgkmcnt(0)
    s_barrier
    ds_read_b32 v36, v34 offset:256
    ds_read_b32 v37, v34 offset:320
    ds_read_b32 v38, v34 offset:384
    ds_read_b32 v39, v34 offset:448
    s_waitcnt lgkmcnt(0)
    v_add_f32 v36, v36, v37
    v_add_f32 v38, v38, v39
    v_add_f32 v41, v36, v38
    v_mul_f32 v41, 0x3b124925, v41
    v_cvt_pk_bf16_f32 v42, v40, v41
    v_lshlrev_b32 v40, 16, v42
    v_and_b32 v41, 0xffff0000, v42
    v_add_f32 v41, 0x3727c5ac, v41
    v_cvt_pk_bf16_f32 v43, v41, v41
    v_lshlrev_b32 v41, 16, v43
    v_and_b32 v42, 0xffff0000, v43
    v_sqrt_f32 v41, v41
    s_nop 0
    v_cvt_pk_bf16_f32 v43, v41, v41
    v_lshlrev_b32 v41, 16, v43
    v_and_b32 v42, 0xffff0000, v43
    v_rcp_f32 v42, v41
    s_nop 0
    s_waitcnt vmcnt(0)
    v_sub_f32 v64, v64, v40
    v_sub_f32 v65, v65, v40
    v_cvt_pk_bf16_f32 v43, v64, v65
    v_lshlrev_b32 v64, 16, v43
    v_and_b32 v65, 0xffff0000, v43
    v_mul_f32 v44, v64, v42
    v_fma_f32 v45, -v44, v41, v64
    v_fma_f32 v64, v45, v42, v44
    v_mul_f32 v44, v65, v42
    v_fma_f32 v45, -v44, v41, v65
    v_fma_f32 v65, v45, v42, v44
    v_cvt_pk_bf16_f32 v43, v64, v65
    v_lshlrev_b32 v64, 16, v43
    v_and_b32 v65, 0xffff0000, v43
    v_mul_f32 v64, v64, v192
    v_mul_f32 v65, v65, v193
    v_cvt_pk_bf16_f32 v43, v64, v65
    v_lshlrev_b32 v64, 16, v43
    v_and_b32 v65, 0xffff0000, v43
    v_add_f32 v64, v64, v160
    v_add_f32 v65, v65, v161
    v_cvt_pk_bf16_f32 v120, v64, v65
    v_sub_f32 v66, v66, v40
    v_sub_f32 v67, v67, v40
    v_cvt_pk_bf16_f32 v43, v66, v67
    v_lshlrev_b32 v66, 16, v43
    v_and_b32 v67, 0xffff0000, v43
    v_mul_f32 v44, v66, v42
    v_fma_f32 v45, -v44, v41, v66
    v_fma_f32 v66, v45, v42, v44
    v_mul_f32 v44, v67, v42
    v_fma_f32 v45, -v44, v41, v67
    v_fma_f32 v67, v45, v42, v44
    v_cvt_pk_bf16_f32 v43, v66, v67
    v_lshlrev_b32 v66, 16, v43
    v_and_b32 v67, 0xffff0000, v43
    v_mul_f32 v66, v66, v194
    v_mul_f32 v67, v67, v195
    v_cvt_pk_bf16_f32 v43, v66, v67
    v_lshlrev_b32 v66, 16, v43
    v_and_b32 v67, 0xffff0000, v43
    v_add_f32 v66, v66, v162
    v_add_f32 v67, v67, v163
    v_cvt_pk_bf16_f32 v121, v66, v67
    global_store_dwordx2 v10, v[120:121], s[24:25] offset:0 sc1
    v_sub_f32 v68, v68, v40
    v_sub_f32 v69, v69, v40
    v_cvt_pk_bf16_f32 v43, v68, v69
    v_lshlrev_b32 v68, 16, v43
    v_and_b32 v69, 0xffff0000, v43
    v_mul_f32 v44, v68, v42
    v_fma_f32 v45, -v44, v41, v68
    v_fma_f32 v68, v45, v42, v44
    v_mul_f32 v44, v69, v42
    v_fma_f32 v45, -v44, v41, v69
    v_fma_f32 v69, v45, v42, v44
    v_cvt_pk_bf16_f32 v43, v68, v69
    v_lshlrev_b32 v68, 16, v43
    v_and_b32 v69, 0xffff0000, v43
    v_mul_f32 v68, v68, v196
    v_mul_f32 v69, v69, v197
    v_cvt_pk_bf16_f32 v43, v68, v69
    v_lshlrev_b32 v68, 16, v43
    v_and_b32 v69, 0xffff0000, v43
    v_add_f32 v68, v68, v164
    v_add_f32 v69, v69, v165
    v_cvt_pk_bf16_f32 v122, v68, v69
    v_sub_f32 v70, v70, v40
    v_sub_f32 v71, v71, v40
    v_cvt_pk_bf16_f32 v43, v70, v71
    v_lshlrev_b32 v70, 16, v43
    v_and_b32 v71, 0xffff0000, v43
    v_mul_f32 v44, v70, v42
    v_fma_f32 v45, -v44, v41, v70
    v_fma_f32 v70, v45, v42, v44
    v_mul_f32 v44, v71, v42
    v_fma_f32 v45, -v44, v41, v71
    v_fma_f32 v71, v45, v42, v44
    v_cvt_pk_bf16_f32 v43, v70, v71
    v_lshlrev_b32 v70, 16, v43
    v_and_b32 v71, 0xffff0000, v43
    v_mul_f32 v70, v70, v198
    v_mul_f32 v71, v71, v199
    v_cvt_pk_bf16_f32 v43, v70, v71
    v_lshlrev_b32 v70, 16, v43
    v_and_b32 v71, 0xffff0000, v43
    v_add_f32 v70, v70, v166
    v_add_f32 v71, v71, v167
    v_cvt_pk_bf16_f32 v123, v70, v71
    global_store_dwordx2 v10, v[122:123], s[24:25] offset:32 sc1
    v_sub_f32 v72, v72, v40
    v_sub_f32 v73, v73, v40
    v_cvt_pk_bf16_f32 v43, v72, v73
    v_lshlrev_b32 v72, 16, v43
    v_and_b32 v73, 0xffff0000, v43
    v_mul_f32 v44, v72, v42
    v_fma_f32 v45, -v44, v41, v72
    v_fma_f32 v72, v45, v42, v44
    v_mul_f32 v44, v73, v42
    v_fma_f32 v45, -v44, v41, v73
    v_fma_f32 v73, v45, v42, v44
    v_cvt_pk_bf16_f32 v43, v72, v73
    v_lshlrev_b32 v72, 16, v43
    v_and_b32 v73, 0xffff0000, v43
    v_mul_f32 v72, v72, v200
    v_mul_f32 v73, v73, v201
    v_cvt_pk_bf16_f32 v43, v72, v73
    v_lshlrev_b32 v72, 16, v43
    v_and_b32 v73, 0xffff0000, v43
    v_add_f32 v72, v72, v168
    v_add_f32 v73, v73, v169
    v_cvt_pk_bf16_f32 v124, v72, v73
    v_sub_f32 v74, v74, v40
    v_sub_f32 v75, v75, v40
    v_cvt_pk_bf16_f32 v43, v74, v75
    v_lshlrev_b32 v74, 16, v43
    v_and_b32 v75, 0xffff0000, v43
    v_mul_f32 v44, v74, v42
    v_fma_f32 v45, -v44, v41, v74
    v_fma_f32 v74, v45, v42, v44
    v_mul_f32 v44, v75, v42
    v_fma_f32 v45, -v44, v41, v75
    v_fma_f32 v75, v45, v42, v44
    v_cvt_pk_bf16_f32 v43, v74, v75
    v_lshlrev_b32 v74, 16, v43
    v_and_b32 v75, 0xffff0000, v43
    v_mul_f32 v74, v74, v202
    v_mul_f32 v75, v75, v203
    v_cvt_pk_bf16_f32 v43, v74, v75
    v_lshlrev_b32 v74, 16, v43
    v_and_b32 v75, 0xffff0000, v43
    v_add_f32 v74, v74, v170
    v_add_f32 v75, v75, v171
    v_cvt_pk_bf16_f32 v125, v74, v75
    global_store_dwordx2 v10, v[124:125], s[24:25] offset:64 sc1
    v_sub_f32 v76, v76, v40
    v_sub_f32 v77, v77, v40
    v_cvt_pk_bf16_f32 v43, v76, v77
    v_lshlrev_b32 v76, 16, v43
    v_and_b32 v77, 0xffff0000, v43
    v_mul_f32 v44, v76, v42
    v_fma_f32 v45, -v44, v41, v76
    v_fma_f32 v76, v45, v42, v44
    v_mul_f32 v44, v77, v42
    v_fma_f32 v45, -v44, v41, v77
    v_fma_f32 v77, v45, v42, v44
    v_cvt_pk_bf16_f32 v43, v76, v77
    v_lshlrev_b32 v76, 16, v43
    v_and_b32 v77, 0xffff0000, v43
    v_mul_f32 v76, v76, v204
    v_mul_f32 v77, v77, v205
    v_cvt_pk_bf16_f32 v43, v76, v77
    v_lshlrev_b32 v76, 16, v43
    v_and_b32 v77, 0xffff0000, v43
    v_add_f32 v76, v76, v172
    v_add_f32 v77, v77, v173
    v_cvt_pk_bf16_f32 v126, v76, v77
    v_sub_f32 v78, v78, v40
    v_sub_f32 v79, v79, v40
    v_cvt_pk_bf16_f32 v43, v78, v79
    v_lshlrev_b32 v78, 16, v43
    v_and_b32 v79, 0xffff0000, v43
    v_mul_f32 v44, v78, v42
    v_fma_f32 v45, -v44, v41, v78
    v_fma_f32 v78, v45, v42, v44
    v_mul_f32 v44, v79, v42
    v_fma_f32 v45, -v44, v41, v79
    v_fma_f32 v79, v45, v42, v44
    v_cvt_pk_bf16_f32 v43, v78, v79
    v_lshlrev_b32 v78, 16, v43
    v_and_b32 v79, 0xffff0000, v43
    v_mul_f32 v78, v78, v206
    v_mul_f32 v79, v79, v207
    v_cvt_pk_bf16_f32 v43, v78, v79
    v_lshlrev_b32 v78, 16, v43
    v_and_b32 v79, 0xffff0000, v43
    v_add_f32 v78, v78, v174
    v_add_f32 v79, v79, v175
    v_cvt_pk_bf16_f32 v127, v78, v79
    global_store_dwordx2 v10, v[126:127], s[24:25] offset:96 sc1
    v_sub_f32 v80, v80, v40
    v_sub_f32 v81, v81, v40
    v_cvt_pk_bf16_f32 v43, v80, v81
    v_lshlrev_b32 v80, 16, v43
    v_and_b32 v81, 0xffff0000, v43
    v_mul_f32 v44, v80, v42
    v_fma_f32 v45, -v44, v41, v80
    v_fma_f32 v80, v45, v42, v44
    v_mul_f32 v44, v81, v42
    v_fma_f32 v45, -v44, v41, v81
    v_fma_f32 v81, v45, v42, v44
    v_cvt_pk_bf16_f32 v43, v80, v81
    v_lshlrev_b32 v80, 16, v43
    v_and_b32 v81, 0xffff0000, v43
    v_mul_f32 v80, v80, v208
    v_mul_f32 v81, v81, v209
    v_cvt_pk_bf16_f32 v43, v80, v81
    v_lshlrev_b32 v80, 16, v43
    v_and_b32 v81, 0xffff0000, v43
    v_add_f32 v80, v80, v176
    v_add_f32 v81, v81, v177
    v_cvt_pk_bf16_f32 v128, v80, v81
    v_sub_f32 v82, v82, v40
    v_sub_f32 v83, v83, v40
    v_cvt_pk_bf16_f32 v43, v82, v83
    v_lshlrev_b32 v82, 16, v43
    v_and_b32 v83, 0xffff0000, v43
    v_mul_f32 v44, v82, v42
    v_fma_f32 v45, -v44, v41, v82
    v_fma_f32 v82, v45, v42, v44
    v_mul_f32 v44, v83, v42
    v_fma_f32 v45, -v44, v41, v83
    v_fma_f32 v83, v45, v42, v44
    v_cvt_pk_bf16_f32 v43, v82, v83
    v_lshlrev_b32 v82, 16, v43
    v_and_b32 v83, 0xffff0000, v43
    v_mul_f32 v82, v82, v210
    v_mul_f32 v83, v83, v211
    v_cvt_pk_bf16_f32 v43, v82, v83
    v_lshlrev_b32 v82, 16, v43
    v_and_b32 v83, 0xffff0000, v43
    v_add_f32 v82, v82, v178
    v_add_f32 v83, v83, v179
    v_cvt_pk_bf16_f32 v129, v82, v83
    global_store_dwordx2 v10, v[128:129], s[24:25] offset:128 sc1
    v_sub_f32 v84, v84, v40
    v_sub_f32 v85, v85, v40
    v_cvt_pk_bf16_f32 v43, v84, v85
    v_lshlrev_b32 v84, 16, v43
    v_and_b32 v85, 0xffff0000, v43
    v_mul_f32 v44, v84, v42
    v_fma_f32 v45, -v44, v41, v84
    v_fma_f32 v84, v45, v42, v44
    v_mul_f32 v44, v85, v42
    v_fma_f32 v45, -v44, v41, v85
    v_fma_f32 v85, v45, v42, v44
    v_cvt_pk_bf16_f32 v43, v84, v85
    v_lshlrev_b32 v84, 16, v43
    v_and_b32 v85, 0xffff0000, v43
    v_mul_f32 v84, v84, v212
    v_mul_f32 v85, v85, v213
    v_cvt_pk_bf16_f32 v43, v84, v85
    v_lshlrev_b32 v84, 16, v43
    v_and_b32 v85, 0xffff0000, v43
    v_add_f32 v84, v84, v180
    v_add_f32 v85, v85, v181
    v_cvt_pk_bf16_f32 v130, v84, v85
    v_sub_f32 v86, v86, v40
    v_sub_f32 v87, v87, v40
    v_cvt_pk_bf16_f32 v43, v86, v87
    v_lshlrev_b32 v86, 16, v43
    v_and_b32 v87, 0xffff0000, v43
    v_mul_f32 v44, v86, v42
    v_fma_f32 v45, -v44, v41, v86
    v_fma_f32 v86, v45, v42, v44
    v_mul_f32 v44, v87, v42
    v_fma_f32 v45, -v44, v41, v87
    v_fma_f32 v87, v45, v42, v44
    v_cvt_pk_bf16_f32 v43, v86, v87
    v_lshlrev_b32 v86, 16, v43
    v_and_b32 v87, 0xffff0000, v43
    v_mul_f32 v86, v86, v214
    v_mul_f32 v87, v87, v215
    v_cvt_pk_bf16_f32 v43, v86, v87
    v_lshlrev_b32 v86, 16, v43
    v_and_b32 v87, 0xffff0000, v43
    v_add_f32 v86, v86, v182
    v_add_f32 v87, v87, v183
    v_cvt_pk_bf16_f32 v131, v86, v87
    global_store_dwordx2 v10, v[130:131], s[24:25] offset:160 sc1
    v_sub_f32 v88, v88, v40
    v_sub_f32 v89, v89, v40
    v_cvt_pk_bf16_f32 v43, v88, v89
    v_lshlrev_b32 v88, 16, v43
    v_and_b32 v89, 0xffff0000, v43
    v_mul_f32 v44, v88, v42
    v_fma_f32 v45, -v44, v41, v88
    v_fma_f32 v88, v45, v42, v44
    v_mul_f32 v44, v89, v42
    v_fma_f32 v45, -v44, v41, v89
    v_fma_f32 v89, v45, v42, v44
    v_cvt_pk_bf16_f32 v43, v88, v89
    v_lshlrev_b32 v88, 16, v43
    v_and_b32 v89, 0xffff0000, v43
    v_mul_f32 v88, v88, v216
    v_mul_f32 v89, v89, v217
    v_cvt_pk_bf16_f32 v43, v88, v89
    v_lshlrev_b32 v88, 16, v43
    v_and_b32 v89, 0xffff0000, v43
    v_add_f32 v88, v88, v184
    v_add_f32 v89, v89, v185
    v_cvt_pk_bf16_f32 v132, v88, v89
    v_sub_f32 v90, v90, v40
    v_sub_f32 v91, v91, v40
    v_cvt_pk_bf16_f32 v43, v90, v91
    v_lshlrev_b32 v90, 16, v43
    v_and_b32 v91, 0xffff0000, v43
    v_mul_f32 v44, v90, v42
    v_fma_f32 v45, -v44, v41, v90
    v_fma_f32 v90, v45, v42, v44
    v_mul_f32 v44, v91, v42
    v_fma_f32 v45, -v44, v41, v91
    v_fma_f32 v91, v45, v42, v44
    v_cvt_pk_bf16_f32 v43, v90, v91
    v_lshlrev_b32 v90, 16, v43
    v_and_b32 v91, 0xffff0000, v43
    v_mul_f32 v90, v90, v218
    v_mul_f32 v91, v91, v219
    v_cvt_pk_bf16_f32 v43, v90, v91
    v_lshlrev_b32 v90, 16, v43
    v_and_b32 v91, 0xffff0000, v43
    v_add_f32 v90, v90, v186
    v_add_f32 v91, v91, v187
    v_cvt_pk_bf16_f32 v133, v90, v91
    global_store_dwordx2 v10, v[132:133], s[24:25] offset:192 sc1
    s_branch sig_attn_9
it1_attn_8:
    global_load_dwordx4 v[120:123], v9, s[32:33] offset:0
    global_load_dwordx4 v[124:127], v9, s[32:33] offset:1024
    global_load_dwordx4 v[128:131], v9, s[32:33] offset:2048
    global_load_dwordx4 v[132:135], v9, s[32:33] offset:3072
    global_load_dwordx4 v[136:139], v5, s[32:33] offset:0
    global_load_dwordx4 v[140:143], v5, s[32:33] offset:1024
    global_load_dwordx4 v[144:147], v5, s[32:33] offset:2048
    global_load_dwordx4 v[148:151], v5, s[32:33] offset:3072
    global_load_dwordx4 v[152:155], v6, s[32:33] offset:0
    global_load_dwordx4 v[156:159], v6, s[32:33] offset:1024
    global_load_dwordx4 v[160:163], v6, s[32:33] offset:2048
    global_load_dwordx4 v[164:167], v6, s[32:33] offset:3072
    global_load_dwordx4 v[168:171], v7, s[32:33] offset:0
    global_load_dwordx4 v[172:175], v7, s[32:33] offset:1024
    global_load_dwordx4 v[176:179], v9, s[34:35] offset:0
    global_load_dwordx4 v[180:183], v9, s[34:35] offset:1024
    global_load_dwordx4 v[184:187], v9, s[34:35] offset:2048
    global_load_dwordx4 v[188:191], v9, s[34:35] offset:3072
    global_load_dwordx4 v[192:195], v5, s[34:35] offset:0
    global_load_dwordx4 v[196:199], v5, s[34:35] offset:1024
    global_load_dwordx4 v[200:203], v5, s[34:35] offset:2048
    global_load_dwordx4 v[204:207], v5, s[34:35] offset:3072
    global_load_dwordx4 v[208:211], v6, s[34:35] offset:0
    global_load_dwordx4 v[212:215], v6, s[34:35] offset:1024
    global_load_dwordx4 v[216:219], v6, s[34:35] offset:2048
    global_load_dwordx4 v[220:223], v6, s[34:35] offset:3072
    global_load_dwordx4 v[224:227], v7, s[34:35] offset:0
    global_load_dwordx4 v[228:231], v7, s[34:35] offset:1024
    s_add_u32 s38, s36, 0
    s_addc_u32 s39, s37, 0
    global_load_dwordx4 a[0:3], v9, s[38:39] offset:0
    global_load_dwordx4 a[4:7], v9, s[38:39] offset:1024
    global_load_dwordx4 a[8:11], v9, s[38:39] offset:2048
    global_load_dwordx4 a[12:15], v9, s[38:39] offset:3072
    global_load_dwordx4 a[16:19], v5, s[38:39] offset:0
    global_load_dwordx4 a[20:23], v5, s[38:39] offset:1024
    global_load_dwordx4 a[24:27], v5, s[38:39] offset:2048
    global_load_dwordx4 a[28:31], v5, s[38:39] offset:3072
    global_load_dwordx4 a[32:35], v6, s[38:39] offset:0
    global_load_dwordx4 a[36:39], v6, s[38:39] offset:1024
    global_load_dwordx4 a[40:43], v6, s[38:39] offset:2048
    global_load_dwordx4 a[44:47], v6, s[38:39] offset:3072
    global_load_dwordx4 a[48:51], v7, s[38:39] offset:0
    global_load_dwordx4 a[52:55], v7, s[38:39] offset:1024
    s_add_u32 s38, s36, 14336
    s_addc_u32 s39, s37, 0
    global_load_dwordx4 a[56:59], v9, s[38:39] offset:0
    global_load_dwordx4 a[60:63], v9, s[38:39] offset:1024
    global_load_dwordx4 a[64:67], v9, s[38:39] offset:2048
    global_load_dwordx4 a[68:71], v9, s[38:39] offset:3072
    global_load_dwordx4 a[72:75], v5, s[38:39] offset:0
    global_load_dwordx4 a[76:79], v5, s[38:39] offset:1024
    global_load_dwordx4 a[80:83], v5, s[38:39] offset:2048
    global_load_dwordx4 a[84:87], v5, s[38:39] offset:3072
    global_load_dwordx4 a[88:91], v6, s[38:39] offset:0
    global_load_dwordx4 a[92:95], v6, s[38:39] offset:1024
    global_load_dwordx4 a[96:99], v6, s[38:39] offset:2048
    global_load_dwordx4 a[100:103], v6, s[38:39] offset:3072
    global_load_dwordx4 a[104:107], v7, s[38:39] offset:0
    global_load_dwordx4 a[108:111], v7, s[38:39] offset:1024
    s_add_u32 s38, s36, 28672
    s_addc_u32 s39, s37, 0
    global_load_dwordx4 a[112:115], v9, s[38:39] offset:0
    global_load_dwordx4 a[116:119], v9, s[38:39] offset:1024
    global_load_dwordx4 a[120:123], v9, s[38:39] offset:2048
    global_load_dwordx4 a[124:127], v9, s[38:39] offset:3072
    global_load_dwordx4 a[128:131], v5, s[38:39] offset:0
    global_load_dwordx4 a[132:135], v5, s[38:39] offset:1024
    global_load_dwordx4 a[136:139], v5, s[38:39] offset:2048
    global_load_dwordx4 a[140:143], v5, s[38:39] offset:3072
    global_load_dwordx4 a[144:147], v6, s[38:39] offset:0
    global_load_dwordx4 a[148:151], v6, s[38:39] offset:1024
    global_load_dwordx4 a[152:155], v6, s[38:39] offset:2048
    global_load_dwordx4 a[156:159], v6, s[38:39] offset:3072
    global_load_dwordx4 a[160:163], v7, s[38:39] offset:0
    global_load_dwordx4 a[164:167], v7, s[38:39] offset:1024
    s_add_u32 s38, s36, 43008
    s_addc_u32 s39, s37, 0
    global_load_dwordx4 a[168:171], v9, s[38:39] offset:0
    global_load_dwordx4 a[172:175], v9, s[38:39] offset:1024
    global_load_dwordx4 a[176:179], v9, s[38:39] offset:2048
    global_load_dwordx4 a[180:183], v9, s[38:39] offset:3072
    global_load_dwordx4 a[184:187], v5, s[38:39] offset:0
    global_load_dwordx4 a[188:191], v5, s[38:39] offset:1024
    global_load_dwordx4 a[192:195], v5, s[38:39] offset:2048
    global_load_dwordx4 a[196:199], v5, s[38:39] offset:3072
    global_load_dwordx4 a[200:203], v6, s[38:39] offset:0
    global_load_dwordx4 a[204:207], v6, s[38:39] offset:1024
    global_load_dwordx4 a[208:211], v6, s[38:39] offset:2048
    global_load_dwordx4 a[212:215], v6, s[38:39] offset:3072
    global_load_dwordx4 a[216:219], v7, s[38:39] offset:0
    global_load_dwordx4 a[220:223], v7, s[38:39] offset:1024
    s_cmp_lt_u32 s2, 3
    s_cbranch_scc1 np_attn_17
    s_sub_u32 s64, s63, 12
    s_cmp_lg_u32 s10, 0
    s_cbranch_scc1 wo_attn_20
    s_add_u32 s94, s4, 0x6bd4800
    s_addc_u32 s95, s5, 0
    v_mov_b32 v10, s64
wc_attn_18:
    global_load_dword v11, v10, s[94:95] sc1
    s_add_u32 s92, s92, 1
    s_cmp_gt_u32 s92, 524288
    s_cbranch_scc1 wd_attn_19
    s_waitcnt vmcnt(0)
    v_cmp_gt_u32 vcc, 14, v11
    s_nop 1
    s_cbranch_vccz wd_attn_19
    s_sleep 2
    s_branch wc_attn_18
wd_attn_19:
wo_attn_20:
    s_barrier
np_attn_17:
    s_mul_i32 s64, s2, 458752
    s_add_u32 s66, s4, 0x3093000
    s_addc_u32 s67, s5, 0
    v_and_b32 v10, 63, v0
    v_lshlrev_b32 v10, 7, v10
    s_mul_i32 s93, s10, 114688
    s_add_u32 s93, s93, s64
    v_add_u32 v10, s93, v10
    global_load_dword v255, v10, s[66:67]
    v_add_u32 v10, 8192, v10
    global_load_dword v255, v10, s[66:67]
    v_add_u32 v10, 8192, v10
    global_load_dword v255, v10, s[66:67]
    v_add_u32 v10, 8192, v10
    global_load_dword v255, v10, s[66:67]
    v_add_u32 v10, 8192, v10
    global_load_dword v255, v10, s[66:67]
    v_add_u32 v10, 8192, v10
    global_load_dword v255, v10, s[66:67]
    v_add_u32 v10, 8192, v10
    global_load_dword v255, v10, s[66:67]
    v_add_u32 v10, 8192, v10
    global_load_dword v255, v10, s[66:67]
    v_add_u32 v10, 8192, v10
    global_load_dword v255, v10, s[66:67]
    v_add_u32 v10, 8192, v10
    global_load_dword v255, v10, s[66:67]
    v_add_u32 v10, 8192, v10
    global_load_dword v255, v10, s[66:67]
    v_add_u32 v10, 8192, v10
    global_load_dword v255, v10, s[66:67]
    v_add_u32 v10, 8192, v10
    global_load_dword v255, v10, s[66:67]
    v_add_u32 v10, 8192, v10
    global_load_dword v255, v10, s[66:67]
    s_cmp_lg_u32 s10, 0
    s_cbranch_scc1 wo_attn_23
    s_add_u32 s94, s4, 0x6bd4800
    s_addc_u32 s95, s5, 0
    v_mov_b32 v10, s63
wc_attn_21:
    global_load_dword v11, v10, s[94:95] sc1
    s_add_u32 s92, s92, 1
    s_cmp_gt_u32 s92, 524288
    s_cbranch_scc1 wd_attn_22
    s_waitcnt vmcnt(0)
    v_cmp_gt_u32 vcc, 14, v11
    s_nop 1
    s_cbranch_vccz wd_attn_22
    s_sleep 2
    s_branch wc_attn_21
wd_attn_22:
    buffer_inv sc1
    s_waitcnt vmcnt(0)
wo_attn_23:
    s_barrier
    global_load_dwordx4 v[64:67], v14, s[30:31] offset:0
    global_load_dwordx4 v[68:71], v14, s[30:31] offset:512
    global_load_dwordx4 v[72:75], v14, s[30:31] offset:1024
    global_load_dwordx4 v[76:79], v14, s[30:31] offset:1536
    global_load_dwordx4 v[80:83], v14, s[30:31] offset:2048
    global_load_dwordx4 v[84:87], v14, s[30:31] offset:2560
    global_load_dwordx4 v[88:91], v14, s[30:31] offset:3072
    global_load_dwordx4 v[92:95], v14, s[30:31] offset:3584
    global_load_dwordx4 v[96:99], v15, s[30:31] offset:0
    global_load_dwordx4 v[100:103], v15, s[30:31] offset:512
    global_load_dwordx4 v[104:107], v15, s[30:31] offset:1024
    global_load_dwordx4 v[108:111], v15, s[30:31] offset:1536
    global_load_dwordx4 v[112:115], v15, s[30:31] offset:2048
    global_load_dwordx4 v[116:119], v15, s[30:31] offset:2560
    s_waitcnt vmcnt(0)
    v_mfma_f32_16x16x32_bf16 v[32:35], v[64:67], a[0:3], 0
    v_mfma_f32_16x16x32_bf16 v[36:39], v[120:123], a[0:3], 0
    v_mfma_f32_16x16x32_bf16 v[40:43], v[176:179], a[0:3], 0
    v_mfma_f32_16x16x32_bf16 v[32:35], v[68:71], a[4:7], v[32:35]
    v_mfma_f32_16x16x32_bf16 v[36:39], v[124:127], a[4:7], v[36:39]
    v_mfma_f32_16x16x32_bf16 v[40:43], v[180:183], a[4:7], v[40:43]
    v_mfma_f32_16x16x32_bf16 v[32:35], v[72:75], a[8:11], v[32:35]
    v_mfma_f32_16x16x32_bf16 v[36:39], v[128:131], a[8:11], v[36:39]
    v_mfma_f32_16x16x32_bf16 v[40:43], v[184:187], a[8:11], v[40:43]
    v_mfma_f32_16x16x32_bf16 v[32:35], v[76:79], a[12:15], v[32:35]
    v_mfma_f32_16x16x32_bf16 v[36:39], v[132:135], a[12:15], v[36:39]
    v_mfma_f32_16x16x32_bf16 v[40:43], v[188:191], a[12:15], v[40:43]
    v_mfma_f32_16x16x32_bf16 v[32:35], v[80:83], a[16:19], v[32:35]
    v_mfma_f32_16x16x32_bf16 v[36:39], v[136:139], a[16:19], v[36:39]
    v_mfma_f32_16x16x32_bf16 v[40:43], v[192:195], a[16:19], v[40:43]
    v_mfma_f32_16x16x32_bf16 v[32:35], v[84:87], a[20:23], v[32:35]
    v_mfma_f32_16x16x32_bf16 v[36:39], v[140:143], a[20:23], v[36:39]
    v_mfma_f32_16x16x32_bf16 v[40:43], v[196:199], a[20:23], v[40:43]
    v_mfma_f32_16x16x32_bf16 v[32:35], v[88:91], a[24:27], v[32:35]
    v_mfma_f32_16x16x32_bf16 v[36:39], v[144:147], a[24:27], v[36:39]
    v_mfma_f32_16x16x32_bf16 v[40:43], v[200:203], a[24:27], v[40:43]
    v_mfma_f32_16x16x32_bf16 v[32:35], v[92:95], a[28:31], v[32:35]
    v_mfma_f32_16x16x32_bf16 v[36:39], v[148:151], a[28:31], v[36:39]
    v_mfma_f32_16x16x32_bf16 v[40:43], v[204:207], a[28:31], v[40:43]
    v_mfma_f32_16x16x32_bf16 v[32:35], v[96:99], a[32:35], v[32:35]
    v_mfma_f32_16x16x32_bf16 v[36:39], v[152:155], a[32:35], v[36:39]
    v_mfma_f32_16x16x32_bf16 v[40:43], v[208:211], a[32:35], v[40:43]
    v_mfma_f32_16x16x32_bf16 v[32:35], v[100:103], a[36:39], v[32:35]
    v_mfma_f32_16x16x32_bf16 v[36:39], v[156:159], a[36:39], v[36:39]
    v_mfma_f32_16x16x32_bf16 v[40:43], v[212:215], a[36:39], v[40:43]
    v_mfma_f32_16x16x32_bf16 v[32:35], v[104:107], a[40:43], v[32:35]
    v_mfma_f32_16x16x32_bf16 v[36:39], v[160:163], a[40:43], v[36:39]
    v_mfma_f32_16x16x32_bf16 v[40:43], v[216:219], a[40:43], v[40:43]
    v_mfma_f32_16x16x32_bf16 v[32:35], v[108:111], a[44:47], v[32:35]
    v_mfma_f32_16x16x32_bf16 v[36:39], v[164:167], a[44:47], v[36:39]
    v_mfma_f32_16x16x32_bf16 v[40:43], v[220:223], a[44:47], v[40:43]
    v_mfma_f32_16x16x32_bf16 v[32:35], v[112:115], a[48:51], v[32:35]
    v_mfma_f32_16x16x32_bf16 v[36:39], v[168:171], a[48:51], v[36:39]
    v_mfma_f32_16x16x32_bf16 v[40:43], v[224:227], a[48:51], v[40:43]
    v_mfma_f32_16x16x32_bf16 v[32:35], v[116:119], a[52:55], v[32:35]
    v_mfma_f32_16x16x32_bf16 v[36:39], v[172:175], a[52:55], v[36:39]
    v_mfma_f32_16x16x32_bf16 v[40:43], v[228:231], a[52:55], v[40:43]
    s_nop 9
    v_cndmask_b32 v32, v60, v32, s[40:41]
    v_cndmask_b32 v33, v60, v33, s[40:41]
    v_cndmask_b32 v34, v60, v34, s[40:41]
    v_cndmask_b32 v35, v60, v35, s[40:41]
    v_cndmask_b32 v40, v60, v40, s[42:43]
    v_cndmask_b32 v41, v60, v41, s[44:45]
    v_cndmask_b32 v42, v60, v42, s[46:47]
    v_cndmask_b32 v43, v60, v43, s[48:49]
    v_max3_f32 v44, v32, v33, v34
    v_max3_f32 v44, v44, v35, v36
    v_max3_f32 v44, v44, v37, v38
    v_max3_f32 v44, v44, v39, v40
    v_max3_f32 v44, v44, v41, v42
    v_max_f32 v44, v44, v43
    v_mov_b32 v45, v44
    s_nop 1
    v_permlane16_swap_b32 v45, v44
    s_nop 1
    v_max_f32 v44, v45, v44
    v_mov_b32 v45, v44
    s_nop 1
    v_permlane32_swap_b32 v45, v44
    s_nop 1
    v_max_f32 v44, v45, v44
    v_mul_f32 v44, v61, v44
    v_fma_f32 v32, v32, v61, -v44
    v_fma_f32 v33, v33, v61, -v44
    v_fma_f32 v34, v34, v61, -v44
    v_fma_f32 v35, v35, v61, -v44
    v_fma_f32 v36, v36, v61, -v44
    v_fma_f32 v37, v37, v61, -v44
    v_fma_f32 v38, v38, v61, -v44
    v_fma_f32 v39, v39, v61, -v44
    v_fma_f32 v40, v40, v61, -v44
    v_fma_f32 v41, v41, v61, -v44
    v_fma_f32 v42, v42, v61, -v44
    v_fma_f32 v43, v43, v61, -v44
    v_exp_f32 v32, v32
    v_exp_f32 v33, v33
    v_exp_f32 v34, v34
    v_exp_f32 v35, v35
    v_exp_f32 v36, v36
    v_exp_f32 v37, v37
    v_exp_f32 v38, v38
    v_exp_f32 v39, v39
    v_exp_f32 v40, v40
    v_exp_f32 v41, v41
    v_exp_f32 v42, v42
    v_exp_f32 v43, v43
    s_nop 0
    v_add_f32 v44, v32, v33
    v_add_f32 v44, v44, v34
    v_add_f32 v44, v44, v35
    v_add_f32 v44, v44, v36
    v_add_f32 v44, v44, v37
    v_add_f32 v44, v44, v38
    v_add_f32 v44, v44, v39
    v_add_f32 v44, v44, v40
    v_add_f32 v44, v44, v41
    v_add_f32 v44, v44, v42
    v_add_f32 v44, v44, v43
    v_mov_b32 v45, v44
    s_nop 1
    v_permlane16_swap_b32 v45, v44
    s_nop 1
    v_add_f32 v44, v45, v44
    v_mov_b32 v45, v44
    s_nop 1
    v_permlane32_swap_b32 v45, v44
    s_nop 1
    v_add_f32 v44, v45, v44
    v_rcp_f32 v44, v44
    s_nop 0
    v_mul_f32 v32, v32, v44
    v_mul_f32 v33, v33, v44
    v_mul_f32 v34, v34, v44
    v_mul_f32 v35, v35, v44
    v_mul_f32 v36, v36, v44
    v_mul_f32 v37, v37, v44
    v_mul_f32 v38, v38, v44
    v_mul_f32 v39, v39, v44
    v_mul_f32 v40, v40, v44
    v_mul_f32 v41, v41, v44
    v_mul_f32 v42, v42, v44
    v_mul_f32 v43, v43, v44
    v_cvt_pk_bf16_f32 v48, v36, v37
    v_cvt_pk_bf16_f32 v49, v38, v39
    v_cvt_pk_bf16_f32 v50, v40, v41
    v_cvt_pk_bf16_f32 v51, v42, v43
    v_cvt_pk_bf16_f32 v52, v32, v33
    v_cvt_pk_bf16_f32 v53, v34, v35
    ds_write_b128 v12, v[48:51] offset:0
    ds_write_b64 v13, v[52:53] offset:0
    s_waitcnt lgkmcnt(0)
    v_mfma_f32_16x16x32_bf16 v[32:35], v[64:67], a[56:59], 0
    v_mfma_f32_16x16x32_bf16 v[36:39], v[120:123], a[56:59], 0
    v_mfma_f32_16x16x32_bf16 v[40:43], v[176:179], a[56:59], 0
    v_mfma_f32_16x16x32_bf16 v[32:35], v[68:71], a[60:63], v[32:35]
    v_mfma_f32_16x16x32_bf16 v[36:39], v[124:127], a[60:63], v[36:39]
    v_mfma_f32_16x16x32_bf16 v[40:43], v[180:183], a[60:63], v[40:43]
    v_mfma_f32_16x16x32_bf16 v[32:35], v[72:75], a[64:67], v[32:35]
    v_mfma_f32_16x16x32_bf16 v[36:39], v[128:131], a[64:67], v[36:39]
    v_mfma_f32_16x16x32_bf16 v[40:43], v[184:187], a[64:67], v[40:43]
    v_mfma_f32_16x16x32_bf16 v[32:35], v[76:79], a[68:71], v[32:35]
    v_mfma_f32_16x16x32_bf16 v[36:39], v[132:135], a[68:71], v[36:39]
    v_mfma_f32_16x16x32_bf16 v[40:43], v[188:191], a[68:71], v[40:43]
    v_mfma_f32_16x16x32_bf16 v[32:35], v[80:83], a[72:75], v[32:35]
    v_mfma_f32_16x16x32_bf16 v[36:39], v[136:139], a[72:75], v[36:39]
    v_mfma_f32_16x16x32_bf16 v[40:43], v[192:195], a[72:75], v[40:43]
    v_mfma_f32_16x16x32_bf16 v[32:35], v[84:87], a[76:79], v[32:35]
    v_mfma_f32_16x16x32_bf16 v[36:39], v[140:143], a[76:79], v[36:39]
    v_mfma_f32_16x16x32_bf16 v[40:43], v[196:199], a[76:79], v[40:43]
    v_mfma_f32_16x16x32_bf16 v[32:35], v[88:91], a[80:83], v[32:35]
    v_mfma_f32_16x16x32_bf16 v[36:39], v[144:147], a[80:83], v[36:39]
    v_mfma_f32_16x16x32_bf16 v[40:43], v[200:203], a[80:83], v[40:43]
    v_mfma_f32_16x16x32_bf16 v[32:35], v[92:95], a[84:87], v[32:35]
    v_mfma_f32_16x16x32_bf16 v[36:39], v[148:151], a[84:87], v[36:39]
    v_mfma_f32_16x16x32_bf16 v[40:43], v[204:207], a[84:87], v[40:43]
    v_mfma_f32_16x16x32_bf16 v[32:35], v[96:99], a[88:91], v[32:35]
    v_mfma_f32_16x16x32_bf16 v[36:39], v[152:155], a[88:91], v[36:39]
    v_mfma_f32_16x16x32_bf16 v[40:43], v[208:211], a[88:91], v[40:43]
    v_mfma_f32_16x16x32_bf16 v[32:35], v[100:103], a[92:95], v[32:35]
    v_mfma_f32_16x16x32_bf16 v[36:39], v[156:159], a[92:95], v[36:39]
    v_mfma_f32_16x16x32_bf16 v[40:43], v[212:215], a[92:95], v[40:43]
    v_mfma_f32_16x16x32_bf16 v[32:35], v[104:107], a[96:99], v[32:35]
    v_mfma_f32_16x16x32_bf16 v[36:39], v[160:163], a[96:99], v[36:39]
    v_mfma_f32_16x16x32_bf16 v[40:43], v[216:219], a[96:99], v[40:43]
    v_mfma_f32_16x16x32_bf16 v[32:35], v[108:111], a[100:103], v[32:35]
    v_mfma_f32_16x16x32_bf16 v[36:39], v[164:167], a[100:103], v[36:39]
    v_mfma_f32_16x16x32_bf16 v[40:43], v[220:223], a[100:103], v[40:43]
    v_mfma_f32_16x16x32_bf16 v[32:35], v[112:115], a[104:107], v[32:35]
    v_mfma_f32_16x16x32_bf16 v[36:39], v[168:171], a[104:107], v[36:39]
    v_mfma_f32_16x16x32_bf16 v[40:43], v[224:227], a[104:107], v[40:43]
    v_mfma_f32_16x16x32_bf16 v[32:35], v[116:119], a[108:111], v[32:35]
    v_mfma_f32_16x16x32_bf16 v[36:39], v[172:175], a[108:111], v[36:39]
    v_mfma_f32_16x16x32_bf16 v[40:43], v[228:231], a[108:111], v[40:43]
    s_nop 9
    v_cndmask_b32 v32, v60, v32, s[40:41]
    v_cndmask_b32 v33, v60, v33, s[40:41]
    v_cndmask_b32 v34, v60, v34, s[40:41]
    v_cndmask_b32 v35, v60, v35, s[40:41]
    v_cndmask_b32 v40, v60, v40, s[42:43]
    v_cndmask_b32 v41, v60, v41, s[44:45]
    v_cndmask_b32 v42, v60, v42, s[46:47]
    v_cndmask_b32 v43, v60, v43, s[48:49]
    v_max3_f32 v44, v32, v33, v34
    v_max3_f32 v44, v44, v35, v36
    v_max3_f32 v44, v44, v37, v38
    v_max3_f32 v44, v44, v39, v40
    v_max3_f32 v44, v44, v41, v42
    v_max_f32 v44, v44, v43
    v_mov_b32 v45, v44
    s_nop 1
    v_permlane16_swap_b32 v45, v44
    s_nop 1
    v_max_f32 v44, v45, v44
    v_mov_b32 v45, v44
    s_nop 1
    v_permlane32_swap_b32 v45, v44
    s_nop 1
    v_max_f32 v44, v45, v44
    v_mul_f32 v44, v61, v44
    v_fma_f32 v32, v32, v61, -v44
    v_fma_f32 v33, v33, v61, -v44
    v_fma_f32 v34, v34, v61, -v44
    v_fma_f32 v35, v35, v61, -v44
    v_fma_f32 v36, v36, v61, -v44
    v_fma_f32 v37, v37, v61, -v44
    v_fma_f32 v38, v38, v61, -v44
    v_fma_f32 v39, v39, v61, -v44
    v_fma_f32 v40, v40, v61, -v44
    v_fma_f32 v41, v41, v61, -v44
    v_fma_f32 v42, v42, v61, -v44
    v_fma_f32 v43, v43, v61, -v44
    v_exp_f32 v32, v32
    v_exp_f32 v33, v33
    v_exp_f32 v34, v34
    v_exp_f32 v35, v35
    v_exp_f32 v36, v36
    v_exp_f32 v37, v37
    v_exp_f32 v38, v38
    v_exp_f32 v39, v39
    v_exp_f32 v40, v40
    v_exp_f32 v41, v41
    v_exp_f32 v42, v42
    v_exp_f32 v43, v43
    s_nop 0
    v_add_f32 v44, v32, v33
    v_add_f32 v44, v44, v34
    v_add_f32 v44, v44, v35
    v_add_f32 v44, v44, v36
    v_add_f32 v44, v44, v37
    v_add_f32 v44, v44, v38
    v_add_f32 v44, v44, v39
    v_add_f32 v44, v44, v40
    v_add_f32 v44, v44, v41
    v_add_f32 v44, v44, v42
    v_add_f32 v44, v44, v43
    v_mov_b32 v45, v44
    s_nop 1
    v_permlane16_swap_b32 v45, v44
    s_nop 1
    v_add_f32 v44, v45, v44
    v_mov_b32 v45, v44
    s_nop 1
    v_permlane32_swap_b32 v45, v44
    s_nop 1
    v_add_f32 v44, v45, v44
    v_rcp_f32 v44, v44
    s_nop 0
    v_mul_f32 v32, v32, v44
    v_mul_f32 v33, v33, v44
    v_mul_f32 v34, v34, v44
    v_mul_f32 v35, v35, v44
    v_mul_f32 v36, v36, v44
    v_mul_f32 v37, v37, v44
    v_mul_f32 v38, v38, v44
    v_mul_f32 v39, v39, v44
    v_mul_f32 v40, v40, v44
    v_mul_f32 v41, v41, v44
    v_mul_f32 v42, v42, v44
    v_mul_f32 v43, v43, v44
    v_cvt_pk_bf16_f32 v48, v36, v37
    v_cvt_pk_bf16_f32 v49, v38, v39
    v_cvt_pk_bf16_f32 v50, v40, v41
    v_cvt_pk_bf16_f32 v51, v42, v43
    v_cvt_pk_bf16_f32 v52, v32, v33
    v_cvt_pk_bf16_f32 v53, v34, v35
    ds_write_b128 v12, v[48:51] offset:1024
    ds_write_b64 v13, v[52:53] offset:8
    s_waitcnt lgkmcnt(0)
    v_mfma_f32_16x16x32_bf16 v[32:35], v[64:67], a[112:115], 0
    v_mfma_f32_16x16x32_bf16 v[36:39], v[120:123], a[112:115], 0
    v_mfma_f32_16x16x32_bf16 v[40:43], v[176:179], a[112:115], 0
    v_mfma_f32_16x16x32_bf16 v[32:35], v[68:71], a[116:119], v[32:35]
    v_mfma_f32_16x16x32_bf16 v[36:39], v[124:127], a[116:119], v[36:39]
    v_mfma_f32_16x16x32_bf16 v[40:43], v[180:183], a[116:119], v[40:43]
    v_mfma_f32_16x16x32_bf16 v[32:35], v[72:75], a[120:123], v[32:35]
    v_mfma_f32_16x16x32_bf16 v[36:39], v[128:131], a[120:123], v[36:39]
    v_mfma_f32_16x16x32_bf16 v[40:43], v[184:187], a[120:123], v[40:43]
    v_mfma_f32_16x16x32_bf16 v[32:35], v[76:79], a[124:127], v[32:35]
    v_mfma_f32_16x16x32_bf16 v[36:39], v[132:135], a[124:127], v[36:39]
    v_mfma_f32_16x16x32_bf16 v[40:43], v[188:191], a[124:127], v[40:43]
    v_mfma_f32_16x16x32_bf16 v[32:35], v[80:83], a[128:131], v[32:35]
    v_mfma_f32_16x16x32_bf16 v[36:39], v[136:139], a[128:131], v[36:39]
    v_mfma_f32_16x16x32_bf16 v[40:43], v[192:195], a[128:131], v[40:43]
    v_mfma_f32_16x16x32_bf16 v[32:35], v[84:87], a[132:135], v[32:35]
    v_mfma_f32_16x16x32_bf16 v[36:39], v[140:143], a[132:135], v[36:39]
    v_mfma_f32_16x16x32_bf16 v[40:43], v[196:199], a[132:135], v[40:43]
    v_mfma_f32_16x16x32_bf16 v[32:35], v[88:91], a[136:139], v[32:35]
    v_mfma_f32_16x16x32_bf16 v[36:39], v[144:147], a[136:139], v[36:39]
    v_mfma_f32_16x16x32_bf16 v[40:43], v[200:203], a[136:139], v[40:43]
    v_mfma_f32_16x16x32_bf16 v[32:35], v[92:95], a[140:143], v[32:35]
    v_mfma_f32_16x16x32_bf16 v[36:39], v[148:151], a[140:143], v[36:39]
    v_mfma_f32_16x16x32_bf16 v[40:43], v[204:207], a[140:143], v[40:43]
    v_mfma_f32_16x16x32_bf16 v[32:35], v[96:99], a[144:147], v[32:35]
    v_mfma_f32_16x16x32_bf16 v[36:39], v[152:155], a[144:147], v[36:39]
    v_mfma_f32_16x16x32_bf16 v[40:43], v[208:211], a[144:147], v[40:43]
    v_mfma_f32_16x16x32_bf16 v[32:35], v[100:103], a[148:151], v[32:35]
    v_mfma_f32_16x16x32_bf16 v[36:39], v[156:159], a[148:151], v[36:39]
    v_mfma_f32_16x16x32_bf16 v[40:43], v[212:215], a[148:151], v[40:43]
    v_mfma_f32_16x16x32_bf16 v[32:35], v[104:107], a[152:155], v[32:35]
    v_mfma_f32_16x16x32_bf16 v[36:39], v[160:163], a[152:155], v[36:39]
    v_mfma_f32_16x16x32_bf16 v[40:43], v[216:219], a[152:155], v[40:43]
    v_mfma_f32_16x16x32_bf16 v[32:35], v[108:111], a[156:159], v[32:35]
    v_mfma_f32_16x16x32_bf16 v[36:39], v[164:167], a[156:159], v[36:39]
    v_mfma_f32_16x16x32_bf16 v[40:43], v[220:223], a[156:159], v[40:43]
    v_mfma_f32_16x16x32_bf16 v[32:35], v[112:115], a[160:163], v[32:35]
    v_mfma_f32_16x16x32_bf16 v[36:39], v[168:171], a[160:163], v[36:39]
    v_mfma_f32_16x16x32_bf16 v[40:43], v[224:227], a[160:163], v[40:43]
    v_mfma_f32_16x16x32_bf16 v[32:35], v[116:119], a[164:167], v[32:35]
    v_mfma_f32_16x16x32_bf16 v[36:39], v[172:175], a[164:167], v[36:39]
    v_mfma_f32_16x16x32_bf16 v[40:43], v[228:231], a[164:167], v[40:43]
    s_nop 9
    v_cndmask_b32 v32, v60, v32, s[40:41]
    v_cndmask_b32 v33, v60, v33, s[40:41]
    v_cndmask_b32 v34, v60, v34, s[40:41]
    v_cndmask_b32 v35, v60, v35, s[40:41]
    v_cndmask_b32 v40, v60, v40, s[42:43]
    v_cndmask_b32 v41, v60, v41, s[44:45]
    v_cndmask_b32 v42, v60, v42, s[46:47]
    v_cndmask_b32 v43, v60, v43, s[48:49]
    v_max3_f32 v44, v32, v33, v34
    v_max3_f32 v44, v44, v35, v36
    v_max3_f32 v44, v44, v37, v38
    v_max3_f32 v44, v44, v39, v40
    v_max3_f32 v44, v44, v41, v42
    v_max_f32 v44, v44, v43
    v_mov_b32 v45, v44
    s_nop 1
    v_permlane16_swap_b32 v45, v44
    s_nop 1
    v_max_f32 v44, v45, v44
    v_mov_b32 v45, v44
    s_nop 1
    v_permlane32_swap_b32 v45, v44
    s_nop 1
    v_max_f32 v44, v45, v44
    v_mul_f32 v44, v61, v44
    v_fma_f32 v32, v32, v61, -v44
    v_fma_f32 v33, v33, v61, -v44
    v_fma_f32 v34, v34, v61, -v44
    v_fma_f32 v35, v35, v61, -v44
    v_fma_f32 v36, v36, v61, -v44
    v_fma_f32 v37, v37, v61, -v44
    v_fma_f32 v38, v38, v61, -v44
    v_fma_f32 v39, v39, v61, -v44
    v_fma_f32 v40, v40, v61, -v44
    v_fma_f32 v41, v41, v61, -v44
    v_fma_f32 v42, v42, v61, -v44
    v_fma_f32 v43, v43, v61, -v44
    v_exp_f32 v32, v32
    v_exp_f32 v33, v33
    v_exp_f32 v34, v34
    v_exp_f32 v35, v35
    v_exp_f32 v36, v36
    v_exp_f32 v37, v37
    v_exp_f32 v38, v38
    v_exp_f32 v39, v39
    v_exp_f32 v40, v40
    v_exp_f32 v41, v41
    v_exp_f32 v42, v42
    v_exp_f32 v43, v43
    s_nop 0
    v_add_f32 v44, v32, v33
    v_add_f32 v44, v44, v34
    v_add_f32 v44, v44, v35
    v_add_f32 v44, v44, v36
    v_add_f32 v44, v44, v37
    v_add_f32 v44, v44, v38
    v_add_f32 v44, v44, v39
    v_add_f32 v44, v44, v40
    v_add_f32 v44, v44, v41
    v_add_f32 v44, v44, v42
    v_add_f32 v44, v44, v43
    v_mov_b32 v45, v44
    s_nop 1
    v_permlane16_swap_b32 v45, v44
    s_nop 1
    v_add_f32 v44, v45, v44
    v_mov_b32 v45, v44
    s_nop 1
    v_permlane32_swap_b32 v45, v44
    s_nop 1
    v_add_f32 v44, v45, v44
    v_rcp_f32 v44, v44
    s_nop 0
    v_mul_f32 v32, v32, v44
    v_mul_f32 v33, v33, v44
    v_mul_f32 v34, v34, v44
    v_mul_f32 v35, v35, v44
    v_mul_f32 v36, v36, v44
    v_mul_f32 v37, v37, v44
    v_mul_f32 v38, v38, v44
    v_mul_f32 v39, v39, v44
    v_mul_f32 v40, v40, v44
    v_mul_f32 v41, v41, v44
    v_mul_f32 v42, v42, v44
    v_mul_f32 v43, v43, v44
    v_cvt_pk_bf16_f32 v48, v36, v37
    v_cvt_pk_bf16_f32 v49, v38, v39
    v_cvt_pk_bf16_f32 v50, v40, v41
    v_cvt_pk_bf16_f32 v51, v42, v43
    v_cvt_pk_bf16_f32 v52, v32, v33
    v_cvt_pk_bf16_f32 v53, v34, v35
    ds_write_b128 v12, v[48:51] offset:2048
    ds_write_b64 v13, v[52:53] offset:1024
    s_waitcnt lgkmcnt(0)
    v_mfma_f32_16x16x32_bf16 v[32:35], v[64:67], a[168:171], 0
    v_mfma_f32_16x16x32_bf16 v[36:39], v[120:123], a[168:171], 0
    v_mfma_f32_16x16x32_bf16 v[40:43], v[176:179], a[168:171], 0
    v_mfma_f32_16x16x32_bf16 v[32:35], v[68:71], a[172:175], v[32:35]
    v_mfma_f32_16x16x32_bf16 v[36:39], v[124:127], a[172:175], v[36:39]
    v_mfma_f32_16x16x32_bf16 v[40:43], v[180:183], a[172:175], v[40:43]
    v_mfma_f32_16x16x32_bf16 v[32:35], v[72:75], a[176:179], v[32:35]
    v_mfma_f32_16x16x32_bf16 v[36:39], v[128:131], a[176:179], v[36:39]
    v_mfma_f32_16x16x32_bf16 v[40:43], v[184:187], a[176:179], v[40:43]
    v_mfma_f32_16x16x32_bf16 v[32:35], v[76:79], a[180:183], v[32:35]
    v_mfma_f32_16x16x32_bf16 v[36:39], v[132:135], a[180:183], v[36:39]
    v_mfma_f32_16x16x32_bf16 v[40:43], v[188:191], a[180:183], v[40:43]
    v_mfma_f32_16x16x32_bf16 v[32:35], v[80:83], a[184:187], v[32:35]
    v_mfma_f32_16x16x32_bf16 v[36:39], v[136:139], a[184:187], v[36:39]
    v_mfma_f32_16x16x32_bf16 v[40:43], v[192:195], a[184:187], v[40:43]
    v_mfma_f32_16x16x32_bf16 v[32:35], v[84:87], a[188:191], v[32:35]
    v_mfma_f32_16x16x32_bf16 v[36:39], v[140:143], a[188:191], v[36:39]
    v_mfma_f32_16x16x32_bf16 v[40:43], v[196:199], a[188:191], v[40:43]
    v_mfma_f32_16x16x32_bf16 v[32:35], v[88:91], a[192:195], v[32:35]
    v_mfma_f32_16x16x32_bf16 v[36:39], v[144:147], a[192:195], v[36:39]
    v_mfma_f32_16x16x32_bf16 v[40:43], v[200:203], a[192:195], v[40:43]
    v_mfma_f32_16x16x32_bf16 v[32:35], v[92:95], a[196:199], v[32:35]
    v_mfma_f32_16x16x32_bf16 v[36:39], v[148:151], a[196:199], v[36:39]
    v_mfma_f32_16x16x32_bf16 v[40:43], v[204:207], a[196:199], v[40:43]
    v_mfma_f32_16x16x32_bf16 v[32:35], v[96:99], a[200:203], v[32:35]
    v_mfma_f32_16x16x32_bf16 v[36:39], v[152:155], a[200:203], v[36:39]
    v_mfma_f32_16x16x32_bf16 v[40:43], v[208:211], a[200:203], v[40:43]
    v_mfma_f32_16x16x32_bf16 v[32:35], v[100:103], a[204:207], v[32:35]
    v_mfma_f32_16x16x32_bf16 v[36:39], v[156:159], a[204:207], v[36:39]
    v_mfma_f32_16x16x32_bf16 v[40:43], v[212:215], a[204:207], v[40:43]
    v_mfma_f32_16x16x32_bf16 v[32:35], v[104:107], a[208:211], v[32:35]
    v_mfma_f32_16x16x32_bf16 v[36:39], v[160:163], a[208:211], v[36:39]
    v_mfma_f32_16x16x32_bf16 v[40:43], v[216:219], a[208:211], v[40:43]
    v_mfma_f32_16x16x32_bf16 v[32:35], v[108:111], a[212:215], v[32:35]
    v_mfma_f32_16x16x32_bf16 v[36:39], v[164:167], a[212:215], v[36:39]
    v_mfma_f32_16x16x32_bf16 v[40:43], v[220:223], a[212:215], v[40:43]
    v_mfma_f32_16x16x32_bf16 v[32:35], v[112:115], a[216:219], v[32:35]
    v_mfma_f32_16x16x32_bf16 v[36:39], v[168:171], a[216:219], v[36:39]
    v_mfma_f32_16x16x32_bf16 v[40:43], v[224:227], a[216:219], v[40:43]
    v_mfma_f32_16x16x32_bf16 v[32:35], v[116:119], a[220:223], v[32:35]
    v_mfma_f32_16x16x32_bf16 v[36:39], v[172:175], a[220:223], v[36:39]
    v_mfma_f32_16x16x32_bf16 v[40:43], v[228:231], a[220:223], v[40:43]
    s_nop 9
    v_cndmask_b32 v32, v60, v32, s[40:41]
    v_cndmask_b32 v33, v60, v33, s[40:41]
    v_cndmask_b32 v34, v60, v34, s[40:41]
    v_cndmask_b32 v35, v60, v35, s[40:41]
    v_cndmask_b32 v40, v60, v40, s[42:43]
    v_cndmask_b32 v41, v60, v41, s[44:45]
    v_cndmask_b32 v42, v60, v42, s[46:47]
    v_cndmask_b32 v43, v60, v43, s[48:49]
    v_max3_f32 v44, v32, v33, v34
    v_max3_f32 v44, v44, v35, v36
    v_max3_f32 v44, v44, v37, v38
    v_max3_f32 v44, v44, v39, v40
    v_max3_f32 v44, v44, v41, v42
    v_max_f32 v44, v44, v43
    v_mov_b32 v45, v44
    s_nop 1
    v_permlane16_swap_b32 v45, v44
    s_nop 1
    v_max_f32 v44, v45, v44
    v_mov_b32 v45, v44
    s_nop 1
    v_permlane32_swap_b32 v45, v44
    s_nop 1
    v_max_f32 v44, v45, v44
    v_mul_f32 v44, v61, v44
    v_fma_f32 v32, v32, v61, -v44
    v_fma_f32 v33, v33, v61, -v44
    v_fma_f32 v34, v34, v61, -v44
    v_fma_f32 v35, v35, v61, -v44
    v_fma_f32 v36, v36, v61, -v44
    v_fma_f32 v37, v37, v61, -v44
    v_fma_f32 v38, v38, v61, -v44
    v_fma_f32 v39, v39, v61, -v44
    v_fma_f32 v40, v40, v61, -v44
    v_fma_f32 v41, v41, v61, -v44
    v_fma_f32 v42, v42, v61, -v44
    v_fma_f32 v43, v43, v61, -v44
    v_exp_f32 v32, v32
    v_exp_f32 v33, v33
    v_exp_f32 v34, v34
    v_exp_f32 v35, v35
    v_exp_f32 v36, v36
    v_exp_f32 v37, v37
    v_exp_f32 v38, v38
    v_exp_f32 v39, v39
    v_exp_f32 v40, v40
    v_exp_f32 v41, v41
    v_exp_f32 v42, v42
    v_exp_f32 v43, v43
    s_nop 0
    v_add_f32 v44, v32, v33
    v_add_f32 v44, v44, v34
    v_add_f32 v44, v44, v35
    v_add_f32 v44, v44, v36
    v_add_f32 v44, v44, v37
    v_add_f32 v44, v44, v38
    v_add_f32 v44, v44, v39
    v_add_f32 v44, v44, v40
    v_add_f32 v44, v44, v41
    v_add_f32 v44, v44, v42
    v_add_f32 v44, v44, v43
    v_mov_b32 v45, v44
    s_nop 1
    v_permlane16_swap_b32 v45, v44
    s_nop 1
    v_add_f32 v44, v45, v44
    v_mov_b32 v45, v44
    s_nop 1
    v_permlane32_swap_b32 v45, v44
    s_nop 1
    v_add_f32 v44, v45, v44
    v_rcp_f32 v44, v44
    s_nop 0
    v_mul_f32 v32, v32, v44
    v_mul_f32 v33, v33, v44
    v_mul_f32 v34, v34, v44
    v_mul_f32 v35, v35, v44
    v_mul_f32 v36, v36, v44
    v_mul_f32 v37, v37, v44
    v_mul_f32 v38, v38, v44
    v_mul_f32 v39, v39, v44
    v_mul_f32 v40, v40, v44
    v_mul_f32 v41, v41, v44
    v_mul_f32 v42, v42, v44
    v_mul_f32 v43, v43, v44
    v_cvt_pk_bf16_f32 v48, v36, v37
    v_cvt_pk_bf16_f32 v49, v38, v39
    v_cvt_pk_bf16_f32 v50, v40, v41
    v_cvt_pk_bf16_f32 v51, v42, v43
    v_cvt_pk_bf16_f32 v52, v32, v33
    v_cvt_pk_bf16_f32 v53, v34, v35
    ds_write_b128 v12, v[48:51] offset:3072
    ds_write_b64 v13, v[52:53] offset:1032
    s_waitcnt lgkmcnt(0)
    s_add_u32 s38, s52, 0
    s_addc_u32 s39, s53, 0
    global_load_dwordx4 v[96:99], v9, s[38:39] offset:0
    global_load_dwordx4 v[100:103], v9, s[38:39] offset:1024
    global_load_dwordx4 v[104:107], v9, s[38:39] offset:2048
    global_load_dwordx4 v[108:111], v9, s[38:39] offset:3072
    global_load_dwordx4 v[112:115], v5, s[38:39] offset:0
    global_load_dwordx4 v[116:119], v5, s[38:39] offset:1024
    global_load_dwordx4 v[120:123], v5, s[38:39] offset:2048
    s_add_u32 s38, s52, 28672
    s_addc_u32 s39, s53, 0
    global_load_dwordx4 v[124:127], v9, s[38:39] offset:0
    global_load_dwordx4 v[128:131], v9, s[38:39] offset:1024
    global_load_dwordx4 v[132:135], v9, s[38:39] offset:2048
    global_load_dwordx4 v[136:139], v9, s[38:39] offset:3072
    global_load_dwordx4 v[140:143], v5, s[38:39] offset:0
    global_load_dwordx4 v[144:147], v5, s[38:39] offset:1024
    global_load_dwordx4 v[148:151], v5, s[38:39] offset:2048
    s_add_u32 s38, s52, 57344
    s_addc_u32 s39, s53, 0
    global_load_dwordx4 v[152:155], v9, s[38:39] offset:0
    global_load_dwordx4 v[156:159], v9, s[38:39] offset:1024
    global_load_dwordx4 v[160:163], v9, s[38:39] offset:2048
    global_load_dwordx4 v[164:167], v9, s[38:39] offset:3072
    global_load_dwordx4 v[168:171], v5, s[38:39] offset:0
    global_load_dwordx4 v[172:175], v5, s[38:39] offset:1024
    global_load_dwordx4 v[176:179], v5, s[38:39] offset:2048
    s_barrier
    ds_read_b128 v[224:227], v9 offset:0
    s_add_u32 s38, s52, 86016
    s_addc_u32 s39, s53, 0
    global_load_dwordx4 v[180:183], v9, s[38:39] offset:0
    global_load_dwordx4 v[184:187], v9, s[38:39] offset:1024
    global_load_dwordx4 v[188:191], v9, s[38:39] offset:2048
    global_load_dwordx4 v[192:195], v9, s[38:39] offset:3072
    global_load_dwordx4 v[196:199], v5, s[38:39] offset:0
    global_load_dwordx4 v[200:203], v5, s[38:39] offset:1024
    global_load_dwordx4 v[204:207], v5, s[38:39] offset:2048
    s_add_u32 s38, s50, 0
    s_addc_u32 s39, s51, 0
    global_load_dwordx4 a[0:3], v16, s[38:39] offset:0
    global_load_dwordx4 a[4:7], v16, s[38:39] offset:512
    global_load_dwordx4 a[8:11], v16, s[38:39] offset:1024
    global_load_dwordx4 a[12:15], v16, s[38:39] offset:1536
    global_load_dwordx4 a[16:19], v16, s[38:39] offset:2048
    global_load_dwordx4 a[20:23], v16, s[38:39] offset:2560
    global_load_dwordx4 a[24:27], v16, s[38:39] offset:3072
    ds_read_b128 v[228:231], v9 offset:1024
    s_waitcnt vmcnt(28) lgkmcnt(1)
    v_mfma_f32_16x16x32_bf16 v[64:67], v[96:99], v[224:227], 0
    v_mfma_f32_16x16x32_bf16 v[68:71], v[100:103], v[224:227], 0
    v_mfma_f32_16x16x32_bf16 v[72:75], v[104:107], v[224:227], 0
    v_mfma_f32_16x16x32_bf16 v[76:79], v[108:111], v[224:227], 0
    v_mfma_f32_16x16x32_bf16 v[80:83], v[112:115], v[224:227], 0
    v_mfma_f32_16x16x32_bf16 v[84:87], v[116:119], v[224:227], 0
    v_mfma_f32_16x16x32_bf16 v[88:91], v[120:123], v[224:227], 0
    s_add_u32 s38, s52, 114688
    s_addc_u32 s39, s53, 0
    global_load_dwordx4 v[96:99], v9, s[38:39] offset:0
    global_load_dwordx4 v[100:103], v9, s[38:39] offset:1024
    global_load_dwordx4 v[104:107], v9, s[38:39] offset:2048
    global_load_dwordx4 v[108:111], v9, s[38:39] offset:3072
    global_load_dwordx4 v[112:115], v5, s[38:39] offset:0
    global_load_dwordx4 v[116:119], v5, s[38:39] offset:1024
    global_load_dwordx4 v[120:123], v5, s[38:39] offset:2048
    s_add_u32 s38, s50, 14336
    s_addc_u32 s39, s51, 0
    global_load_dwordx4 a[28:31], v16, s[38:39] offset:0
    global_load_dwordx4 a[32:35], v16, s[38:39] offset:512
    global_load_dwordx4 a[36:39], v16, s[38:39] offset:1024
    global_load_dwordx4 a[40:43], v16, s[38:39] offset:1536
    global_load_dwordx4 a[44:47], v16, s[38:39] offset:2048
    global_load_dwordx4 a[48:51], v16, s[38:39] offset:2560
    global_load_dwordx4 a[52:55], v16, s[38:39] offset:3072
    ds_read_b128 v[224:227], v9 offset:2048
    s_waitcnt vmcnt(35) lgkmcnt(1)
    v_mfma_f32_16x16x32_bf16 v[64:67], v[124:127], v[228:231], v[64:67]
    v_mfma_f32_16x16x32_bf16 v[68:71], v[128:131], v[228:231], v[68:71]
    v_mfma_f32_16x16x32_bf16 v[72:75], v[132:135], v[228:231], v[72:75]
    v_mfma_f32_16x16x32_bf16 v[76:79], v[136:139], v[228:231], v[76:79]
    v_mfma_f32_16x16x32_bf16 v[80:83], v[140:143], v[228:231], v[80:83]
    v_mfma_f32_16x16x32_bf16 v[84:87], v[144:147], v[228:231], v[84:87]
    v_mfma_f32_16x16x32_bf16 v[88:91], v[148:151], v[228:231], v[88:91]
    s_add_u32 s38, s52, 143360
    s_addc_u32 s39, s53, 0
    global_load_dwordx4 v[124:127], v9, s[38:39] offset:0
    global_load_dwordx4 v[128:131], v9, s[38:39] offset:1024
    global_load_dwordx4 v[132:135], v9, s[38:39] offset:2048
    global_load_dwordx4 v[136:139], v9, s[38:39] offset:3072
    global_load_dwordx4 v[140:143], v5, s[38:39] offset:0
    global_load_dwordx4 v[144:147], v5, s[38:39] offset:1024
    global_load_dwordx4 v[148:151], v5, s[38:39] offset:2048
    s_add_u32 s38, s50, 28672
    s_addc_u32 s39, s51, 0
    global_load_dwordx4 a[56:59], v16, s[38:39] offset:0
    global_load_dwordx4 a[60:63], v16, s[38:39] offset:512
    global_load_dwordx4 a[64:67], v16, s[38:39] offset:1024
    global_load_dwordx4 a[68:71], v16, s[38:39] offset:1536
    global_load_dwordx4 a[72:75], v16, s[38:39] offset:2048
    global_load_dwordx4 a[76:79], v16, s[38:39] offset:2560
    global_load_dwordx4 a[80:83], v16, s[38:39] offset:3072
    ds_read_b128 v[228:231], v9 offset:3072
    s_waitcnt vmcnt(42) lgkmcnt(1)
    v_mfma_f32_16x16x32_bf16 v[64:67], v[152:155], v[224:227], v[64:67]
    v_mfma_f32_16x16x32_bf16 v[68:71], v[156:159], v[224:227], v[68:71]
    v_mfma_f32_16x16x32_bf16 v[72:75], v[160:163], v[224:227], v[72:75]
    v_mfma_f32_16x16x32_bf16 v[76:79], v[164:167], v[224:227], v[76:79]
    v_mfma_f32_16x16x32_bf16 v[80:83], v[168:171], v[224:227], v[80:83]
    v_mfma_f32_16x16x32_bf16 v[84:87], v[172:175], v[224:227], v[84:87]
    v_mfma_f32_16x16x32_bf16 v[88:91], v[176:179], v[224:227], v[88:91]
    s_add_u32 s38, s52, 172032
    s_addc_u32 s39, s53, 0
    global_load_dwordx4 v[152:155], v9, s[38:39] offset:0
    global_load_dwordx4 v[156:159], v9, s[38:39] offset:1024
    global_load_dwordx4 v[160:163], v9, s[38:39] offset:2048
    global_load_dwordx4 v[164:167], v9, s[38:39] offset:3072
    global_load_dwordx4 v[168:171], v5, s[38:39] offset:0
    global_load_dwordx4 v[172:175], v5, s[38:39] offset:1024
    global_load_dwordx4 v[176:179], v5, s[38:39] offset:2048
    s_add_u32 s38, s50, 43008
    s_addc_u32 s39, s51, 0
    global_load_dwordx4 a[84:87], v16, s[38:39] offset:0
    global_load_dwordx4 a[88:91], v16, s[38:39] offset:512
    global_load_dwordx4 a[92:95], v16, s[38:39] offset:1024
    global_load_dwordx4 a[96:99], v16, s[38:39] offset:1536
    global_load_dwordx4 a[100:103], v16, s[38:39] offset:2048
    global_load_dwordx4 a[104:107], v16, s[38:39] offset:2560
    global_load_dwordx4 a[108:111], v16, s[38:39] offset:3072
    ds_read_b128 v[224:227], v9 offset:4096
    s_waitcnt vmcnt(49) lgkmcnt(1)
    v_mfma_f32_16x16x32_bf16 v[64:67], v[180:183], v[228:231], v[64:67]
    v_mfma_f32_16x16x32_bf16 v[68:71], v[184:187], v[228:231], v[68:71]
    v_mfma_f32_16x16x32_bf16 v[72:75], v[188:191], v[228:231], v[72:75]
    v_mfma_f32_16x16x32_bf16 v[76:79], v[192:195], v[228:231], v[76:79]
    v_mfma_f32_16x16x32_bf16 v[80:83], v[196:199], v[228:231], v[80:83]
    v_mfma_f32_16x16x32_bf16 v[84:87], v[200:203], v[228:231], v[84:87]
    v_mfma_f32_16x16x32_bf16 v[88:91], v[204:207], v[228:231], v[88:91]
    s_add_u32 s38, s52, 200704
    s_addc_u32 s39, s53, 0
    global_load_dwordx4 v[180:183], v9, s[38:39] offset:0
    global_load_dwordx4 v[184:187], v9, s[38:39] offset:1024
    global_load_dwordx4 v[188:191], v9, s[38:39] offset:2048
    global_load_dwordx4 v[192:195], v9, s[38:39] offset:3072
    global_load_dwordx4 v[196:199], v5, s[38:39] offset:0
    global_load_dwordx4 v[200:203], v5, s[38:39] offset:1024
    global_load_dwordx4 v[204:207], v5, s[38:39] offset:2048
    s_add_u32 s38, s50, 57344
    s_addc_u32 s39, s51, 0
    global_load_dwordx4 a[112:115], v16, s[38:39] offset:0
    global_load_dwordx4 a[116:119], v16, s[38:39] offset:512
    global_load_dwordx4 a[120:123], v16, s[38:39] offset:1024
    global_load_dwordx4 a[124:127], v16, s[38:39] offset:1536
    global_load_dwordx4 a[128:131], v16, s[38:39] offset:2048
    global_load_dwordx4 a[132:135], v16, s[38:39] offset:2560
    global_load_dwordx4 a[136:139], v16, s[38:39] offset:3072
    ds_read_b128 v[228:231], v9 offset:5120
    s_waitcnt vmcnt(49) lgkmcnt(1)
    v_mfma_f32_16x16x32_bf16 v[64:67], v[96:99], v[224:227], v[64:67]
    v_mfma_f32_16x16x32_bf16 v[68:71], v[100:103], v[224:227], v[68:71]
    v_mfma_f32_16x16x32_bf16 v[72:75], v[104:107], v[224:227], v[72:75]
    v_mfma_f32_16x16x32_bf16 v[76:79], v[108:111], v[224:227], v[76:79]
    v_mfma_f32_16x16x32_bf16 v[80:83], v[112:115], v[224:227], v[80:83]
    v_mfma_f32_16x16x32_bf16 v[84:87], v[116:119], v[224:227], v[84:87]
    v_mfma_f32_16x16x32_bf16 v[88:91], v[120:123], v[224:227], v[88:91]
    s_add_u32 s38, s52, 229376
    s_addc_u32 s39, s53, 0
    global_load_dwordx4 v[96:99], v9, s[38:39] offset:0
    global_load_dwordx4 v[100:103], v9, s[38:39] offset:1024
    global_load_dwordx4 v[104:107], v9, s[38:39] offset:2048
    global_load_dwordx4 v[108:111], v9, s[38:39] offset:3072
    global_load_dwordx4 v[112:115], v5, s[38:39] offset:0
    global_load_dwordx4 v[116:119], v5, s[38:39] offset:1024
    global_load_dwordx4 v[120:123], v5, s[38:39] offset:2048
    s_add_u32 s38, s50, 71680
    s_addc_u32 s39, s51, 0
    global_load_dwordx4 a[140:143], v16, s[38:39] offset:0
    global_load_dwordx4 a[144:147], v16, s[38:39] offset:512
    global_load_dwordx4 a[148:151], v16, s[38:39] offset:1024
    global_load_dwordx4 a[152:155], v16, s[38:39] offset:1536
    global_load_dwordx4 a[156:159], v16, s[38:39] offset:2048
    global_load_dwordx4 a[160:163], v16, s[38:39] offset:2560
    global_load_dwordx4 a[164:167], v16, s[38:39] offset:3072
    ds_read_b128 v[224:227], v9 offset:6144
    s_waitcnt vmcnt(49) lgkmcnt(1)
    v_mfma_f32_16x16x32_bf16 v[64:67], v[124:127], v[228:231], v[64:67]
    v_mfma_f32_16x16x32_bf16 v[68:71], v[128:131], v[228:231], v[68:71]
    v_mfma_f32_16x16x32_bf16 v[72:75], v[132:135], v[228:231], v[72:75]
    v_mfma_f32_16x16x32_bf16 v[76:79], v[136:139], v[228:231], v[76:79]
    v_mfma_f32_16x16x32_bf16 v[80:83], v[140:143], v[228:231], v[80:83]
    v_mfma_f32_16x16x32_bf16 v[84:87], v[144:147], v[228:231], v[84:87]
    v_mfma_f32_16x16x32_bf16 v[88:91], v[148:151], v[228:231], v[88:91]
    s_add_u32 s38, s52, 258048
    s_addc_u32 s39, s53, 0
    global_load_dwordx4 v[124:127], v9, s[38:39] offset:0
    global_load_dwordx4 v[128:131], v9, s[38:39] offset:1024
    global_load_dwordx4 v[132:135], v9, s[38:39] offset:2048
    global_load_dwordx4 v[136:139], v9, s[38:39] offset:3072
    global_load_dwordx4 v[140:143], v5, s[38:39] offset:0
    global_load_dwordx4 v[144:147], v5, s[38:39] offset:1024
    global_load_dwordx4 v[148:151], v5, s[38:39] offset:2048
    s_add_u32 s38, s50, 86016
    s_addc_u32 s39, s51, 0
    global_load_dwordx4 a[168:171], v16, s[38:39] offset:0
    global_load_dwordx4 a[172:175], v16, s[38:39] offset:512
    global_load_dwordx4 a[176:179], v16, s[38:39] offset:1024
    global_load_dwordx4 a[180:183], v16, s[38:39] offset:1536
    global_load_dwordx4 a[184:187], v16, s[38:39] offset:2048
    global_load_dwordx4 a[188:191], v16, s[38:39] offset:2560
    global_load_dwordx4 a[192:195], v16, s[38:39] offset:3072
    ds_read_b128 v[228:231], v9 offset:7168
    s_waitcnt vmcnt(49) lgkmcnt(1)
    v_mfma_f32_16x16x32_bf16 v[64:67], v[152:155], v[224:227], v[64:67]
    v_mfma_f32_16x16x32_bf16 v[68:71], v[156:159], v[224:227], v[68:71]
    v_mfma_f32_16x16x32_bf16 v[72:75], v[160:163], v[224:227], v[72:75]
    v_mfma_f32_16x16x32_bf16 v[76:79], v[164:167], v[224:227], v[76:79]
    v_mfma_f32_16x16x32_bf16 v[80:83], v[168:171], v[224:227], v[80:83]
    v_mfma_f32_16x16x32_bf16 v[84:87], v[172:175], v[224:227], v[84:87]
    v_mfma_f32_16x16x32_bf16 v[88:91], v[176:179], v[224:227], v[88:91]
    s_add_u32 s38, s52, 286720
    s_addc_u32 s39, s53, 0
    global_load_dwordx4 v[152:155], v9, s[38:39] offset:0
    global_load_dwordx4 v[156:159], v9, s[38:39] offset:1024
    global_load_dwordx4 v[160:163], v9, s[38:39] offset:2048
    global_load_dwordx4 v[164:167], v9, s[38:39] offset:3072
    global_load_dwordx4 v[168:171], v5, s[38:39] offset:0
    global_load_dwordx4 v[172:175], v5, s[38:39] offset:1024
    global_load_dwordx4 v[176:179], v5, s[38:39] offset:2048
    s_add_u32 s38, s50, 100352
    s_addc_u32 s39, s51, 0
    global_load_dwordx4 a[196:199], v16, s[38:39] offset:0
    global_load_dwordx4 a[200:203], v16, s[38:39] offset:512
    global_load_dwordx4 a[204:207], v16, s[38:39] offset:1024
    global_load_dwordx4 a[208:211], v16, s[38:39] offset:1536
    global_load_dwordx4 a[212:215], v16, s[38:39] offset:2048
    global_load_dwordx4 a[216:219], v16, s[38:39] offset:2560
    global_load_dwordx4 a[220:223], v16, s[38:39] offset:3072
    ds_read_b128 v[224:227], v9 offset:8192
    s_waitcnt vmcnt(49) lgkmcnt(1)
    v_mfma_f32_16x16x32_bf16 v[64:67], v[180:183], v[228:231], v[64:67]
    v_mfma_f32_16x16x32_bf16 v[68:71], v[184:187], v[228:231], v[68:71]
    v_mfma_f32_16x16x32_bf16 v[72:75], v[188:191], v[228:231], v[72:75]
    v_mfma_f32_16x16x32_bf16 v[76:79], v[192:195], v[228:231], v[76:79]
    v_mfma_f32_16x16x32_bf16 v[80:83], v[196:199], v[228:231], v[80:83]
    v_mfma_f32_16x16x32_bf16 v[84:87], v[200:203], v[228:231], v[84:87]
    v_mfma_f32_16x16x32_bf16 v[88:91], v[204:207], v[228:231], v[88:91]
    s_add_u32 s38, s52, 315392
    s_addc_u32 s39, s53, 0
    global_load_dwordx4 v[180:183], v9, s[38:39] offset:0
    global_load_dwordx4 v[184:187], v9, s[38:39] offset:1024
    global_load_dwordx4 v[188:191], v9, s[38:39] offset:2048
    global_load_dwordx4 v[192:195], v9, s[38:39] offset:3072
    global_load_dwordx4 v[196:199], v5, s[38:39] offset:0
    global_load_dwordx4 v[200:203], v5, s[38:39] offset:1024
    global_load_dwordx4 v[204:207], v5, s[38:39] offset:2048
    ds_read_b128 v[228:231], v9 offset:9216
    s_waitcnt vmcnt(42) lgkmcnt(1)
    v_mfma_f32_16x16x32_bf16 v[64:67], v[96:99], v[224:227], v[64:67]
    v_mfma_f32_16x16x32_bf16 v[68:71], v[100:103], v[224:227], v[68:71]
    v_mfma_f32_16x16x32_bf16 v[72:75], v[104:107], v[224:227], v[72:75]
    v_mfma_f32_16x16x32_bf16 v[76:79], v[108:111], v[224:227], v[76:79]
    v_mfma_f32_16x16x32_bf16 v[80:83], v[112:115], v[224:227], v[80:83]
    v_mfma_f32_16x16x32_bf16 v[84:87], v[116:119], v[224:227], v[84:87]
    v_mfma_f32_16x16x32_bf16 v[88:91], v[120:123], v[224:227], v[88:91]
    s_add_u32 s38, s52, 344064
    s_addc_u32 s39, s53, 0
    global_load_dwordx4 v[96:99], v9, s[38:39] offset:0
    global_load_dwordx4 v[100:103], v9, s[38:39] offset:1024
    global_load_dwordx4 v[104:107], v9, s[38:39] offset:2048
    global_load_dwordx4 v[108:111], v9, s[38:39] offset:3072
    global_load_dwordx4 v[112:115], v5, s[38:39] offset:0
    global_load_dwordx4 v[116:119], v5, s[38:39] offset:1024
    global_load_dwordx4 v[120:123], v5, s[38:39] offset:2048
    ds_read_b128 v[224:227], v9 offset:10240
    s_waitcnt vmcnt(35) lgkmcnt(1)
    v_mfma_f32_16x16x32_bf16 v[64:67], v[124:127], v[228:231], v[64:67]
    v_mfma_f32_16x16x32_bf16 v[68:71], v[128:131], v[228:231], v[68:71]
    v_mfma_f32_16x16x32_bf16 v[72:75], v[132:135], v[228:231], v[72:75]
    v_mfma_f32_16x16x32_bf16 v[76:79], v[136:139], v[228:231], v[76:79]
    v_mfma_f32_16x16x32_bf16 v[80:83], v[140:143], v[228:231], v[80:83]
    v_mfma_f32_16x16x32_bf16 v[84:87], v[144:147], v[228:231], v[84:87]
    v_mfma_f32_16x16x32_bf16 v[88:91], v[148:151], v[228:231], v[88:91]
    s_add_u32 s38, s52, 372736
    s_addc_u32 s39, s53, 0
    global_load_dwordx4 v[124:127], v9, s[38:39] offset:0
    global_load_dwordx4 v[128:131], v9, s[38:39] offset:1024
    global_load_dwordx4 v[132:135], v9, s[38:39] offset:2048
    global_load_dwordx4 v[136:139], v9, s[38:39] offset:3072
    global_load_dwordx4 v[140:143], v5, s[38:39] offset:0
    global_load_dwordx4 v[144:147], v5, s[38:39] offset:1024
    global_load_dwordx4 v[148:151], v5, s[38:39] offset:2048
    ds_read_b128 v[228:231], v9 offset:11264
    s_waitcnt vmcnt(28) lgkmcnt(1)
    v_mfma_f32_16x16x32_bf16 v[64:67], v[152:155], v[224:227], v[64:67]
    v_mfma_f32_16x16x32_bf16 v[68:71], v[156:159], v[224:227], v[68:71]
    v_mfma_f32_16x16x32_bf16 v[72:75], v[160:163], v[224:227], v[72:75]
    v_mfma_f32_16x16x32_bf16 v[76:79], v[164:167], v[224:227], v[76:79]
    v_mfma_f32_16x16x32_bf16 v[80:83], v[168:171], v[224:227], v[80:83]
    v_mfma_f32_16x16x32_bf16 v[84:87], v[172:175], v[224:227], v[84:87]
    v_mfma_f32_16x16x32_bf16 v[88:91], v[176:179], v[224:227], v[88:91]
    s_add_u32 s38, s52, 401408
    s_addc_u32 s39, s53, 0
    global_load_dwordx4 v[152:155], v9, s[38:39] offset:0
    global_load_dwordx4 v[156:159], v9, s[38:39] offset:1024
    global_load_dwordx4 v[160:163], v9, s[38:39] offset:2048
    global_load_dwordx4 v[164:167], v9, s[38:39] offset:3072
    global_load_dwordx4 v[168:171], v5, s[38:39] offset:0
    global_load_dwordx4 v[172:175], v5, s[38:39] offset:1024
    global_load_dwordx4 v[176:179], v5, s[38:39] offset:2048
    ds_read_b128 v[224:227], v9 offset:12288
    s_waitcnt vmcnt(21) lgkmcnt(1)
    v_mfma_f32_16x16x32_bf16 v[64:67], v[180:183], v[228:231], v[64:67]
    v_mfma_f32_16x16x32_bf16 v[68:71], v[184:187], v[228:231], v[68:71]
    v_mfma_f32_16x16x32_bf16 v[72:75], v[188:191], v[228:231], v[72:75]
    v_mfma_f32_16x16x32_bf16 v[76:79], v[192:195], v[228:231], v[76:79]
    v_mfma_f32_16x16x32_bf16 v[80:83], v[196:199], v[228:231], v[80:83]
    v_mfma_f32_16x16x32_bf16 v[84:87], v[200:203], v[228:231], v[84:87]
    v_mfma_f32_16x16x32_bf16 v[88:91], v[204:207], v[228:231], v[88:91]
    s_add_u32 s38, s52, 430080
    s_addc_u32 s39, s53, 0
    global_load_dwordx4 v[180:183], v9, s[38:39] offset:0
    global_load_dwordx4 v[184:187], v9, s[38:39] offset:1024
    global_load_dwordx4 v[188:191], v9, s[38:39] offset:2048
    global_load_dwordx4 v[192:195], v9, s[38:39] offset:3072
    global_load_dwordx4 v[196:199], v5, s[38:39] offset:0
    global_load_dwordx4 v[200:203], v5, s[38:39] offset:1024
    global_load_dwordx4 v[204:207], v5, s[38:39] offset:2048
    ds_read_b128 v[228:231], v9 offset:13312
    s_waitcnt vmcnt(21) lgkmcnt(1)
    v_mfma_f32_16x16x32_bf16 v[64:67], v[96:99], v[224:227], v[64:67]
    v_mfma_f32_16x16x32_bf16 v[68:71], v[100:103], v[224:227], v[68:71]
    v_mfma_f32_16x16x32_bf16 v[72:75], v[104:107], v[224:227], v[72:75]
    v_mfma_f32_16x16x32_bf16 v[76:79], v[108:111], v[224:227], v[76:79]
    v_mfma_f32_16x16x32_bf16 v[80:83], v[112:115], v[224:227], v[80:83]
    v_mfma_f32_16x16x32_bf16 v[84:87], v[116:119], v[224:227], v[84:87]
    v_mfma_f32_16x16x32_bf16 v[88:91], v[120:123], v[224:227], v[88:91]
    ds_read_b128 v[224:227], v9 offset:14336
    s_waitcnt vmcnt(14) lgkmcnt(1)
    v_mfma_f32_16x16x32_bf16 v[64:67], v[124:127], v[228:231], v[64:67]
    v_mfma_f32_16x16x32_bf16 v[68:71], v[128:131], v[228:231], v[68:71]
    v_mfma_f32_16x16x32_bf16 v[72:75], v[132:135], v[228:231], v[72:75]
    v_mfma_f32_16x16x32_bf16 v[76:79], v[136:139], v[228:231], v[76:79]
    v_mfma_f32_16x16x32_bf16 v[80:83], v[140:143], v[228:231], v[80:83]
    v_mfma_f32_16x16x32_bf16 v[84:87], v[144:147], v[228:231], v[84:87]
    v_mfma_f32_16x16x32_bf16 v[88:91], v[148:151], v[228:231], v[88:91]
    ds_read_b128 v[228:231], v9 offset:15360
    s_waitcnt vmcnt(7) lgkmcnt(1)
    v_mfma_f32_16x16x32_bf16 v[64:67], v[152:155], v[224:227], v[64:67]
    v_mfma_f32_16x16x32_bf16 v[68:71], v[156:159], v[224:227], v[68:71]
    v_mfma_f32_16x16x32_bf16 v[72:75], v[160:163], v[224:227], v[72:75]
    v_mfma_f32_16x16x32_bf16 v[76:79], v[164:167], v[224:227], v[76:79]
    v_mfma_f32_16x16x32_bf16 v[80:83], v[168:171], v[224:227], v[80:83]
    v_mfma_f32_16x16x32_bf16 v[84:87], v[172:175], v[224:227], v[84:87]
    v_mfma_f32_16x16x32_bf16 v[88:91], v[176:179], v[224:227], v[88:91]
    ds_read_b128 v[224:227], v9 offset:16384
    s_waitcnt vmcnt(0) lgkmcnt(1)
    v_mfma_f32_16x16x32_bf16 v[64:67], v[180:183], v[228:231], v[64:67]
    v_mfma_f32_16x16x32_bf16 v[68:71], v[184:187], v[228:231], v[68:71]
    v_mfma_f32_16x16x32_bf16 v[72:75], v[188:191], v[228:231], v[72:75]
    v_mfma_f32_16x16x32_bf16 v[76:79], v[192:195], v[228:231], v[76:79]
    v_mfma_f32_16x16x32_bf16 v[80:83], v[196:199], v[228:231], v[80:83]
    v_mfma_f32_16x16x32_bf16 v[84:87], v[200:203], v[228:231], v[84:87]
    v_mfma_f32_16x16x32_bf16 v[88:91], v[204:207], v[228:231], v[88:91]
    ds_read_b128 v[228:231], v9 offset:17408
    s_waitcnt vmcnt(0) lgkmcnt(1)
    v_mfma_f32_16x16x32_bf16 v[64:67], a[0:3], v[224:227], v[64:67]
    v_mfma_f32_16x16x32_bf16 v[68:71], a[4:7], v[224:227], v[68:71]
    v_mfma_f32_16x16x32_bf16 v[72:75], a[8:11], v[224:227], v[72:75]
    v_mfma_f32_16x16x32_bf16 v[76:79], a[12:15], v[224:227], v[76:79]
    v_mfma_f32_16x16x32_bf16 v[80:83], a[16:19], v[224:227], v[80:83]
    v_mfma_f32_16x16x32_bf16 v[84:87], a[20:23], v[224:227], v[84:87]
    v_mfma_f32_16x16x32_bf16 v[88:91], a[24:27], v[224:227], v[88:91]
    ds_read_b128 v[224:227], v9 offset:18432
    s_waitcnt vmcnt(0) lgkmcnt(1)
    v_mfma_f32_16x16x32_bf16 v[64:67], a[28:31], v[228:231], v[64:67]
    v_mfma_f32_16x16x32_bf16 v[68:71], a[32:35], v[228:231], v[68:71]
    v_mfma_f32_16x16x32_bf16 v[72:75], a[36:39], v[228:231], v[72:75]
    v_mfma_f32_16x16x32_bf16 v[76:79], a[40:43], v[228:231], v[76:79]
    v_mfma_f32_16x16x32_bf16 v[80:83], a[44:47], v[228:231], v[80:83]
    v_mfma_f32_16x16x32_bf16 v[84:87], a[48:51], v[228:231], v[84:87]
    v_mfma_f32_16x16x32_bf16 v[88:91], a[52:55], v[228:231], v[88:91]
    ds_read_b128 v[228:231], v9 offset:19456
    s_waitcnt vmcnt(0) lgkmcnt(1)
    v_mfma_f32_16x16x32_bf16 v[64:67], a[56:59], v[224:227], v[64:67]
    v_mfma_f32_16x16x32_bf16 v[68:71], a[60:63], v[224:227], v[68:71]
    v_mfma_f32_16x16x32_bf16 v[72:75], a[64:67], v[224:227], v[72:75]
    v_mfma_f32_16x16x32_bf16 v[76:79], a[68:71], v[224:227], v[76:79]
    v_mfma_f32_16x16x32_bf16 v[80:83], a[72:75], v[224:227], v[80:83]
    v_mfma_f32_16x16x32_bf16 v[84:87], a[76:79], v[224:227], v[84:87]
    v_mfma_f32_16x16x32_bf16 v[88:91], a[80:83], v[224:227], v[88:91]
    ds_read_b128 v[224:227], v9 offset:20480
    s_waitcnt vmcnt(0) lgkmcnt(1)
    v_mfma_f32_16x16x32_bf16 v[64:67], a[84:87], v[228:231], v[64:67]
    v_mfma_f32_16x16x32_bf16 v[68:71], a[88:91], v[228:231], v[68:71]
    v_mfma_f32_16x16x32_bf16 v[72:75], a[92:95], v[228:231], v[72:75]
    v_mfma_f32_16x16x32_bf16 v[76:79], a[96:99], v[228:231], v[76:79]
    v_mfma_f32_16x16x32_bf16 v[80:83], a[100:103], v[228:231], v[80:83]
    v_mfma_f32_16x16x32_bf16 v[84:87], a[104:107], v[228:231], v[84:87]
    v_mfma_f32_16x16x32_bf16 v[88:91], a[108:111], v[228:231], v[88:91]
    ds_read_b128 v[228:231], v9 offset:21504
    s_waitcnt vmcnt(0) lgkmcnt(1)
    v_mfma_f32_16x16x32_bf16 v[64:67], a[112:115], v[224:227], v[64:67]
    v_mfma_f32_16x16x32_bf16 v[68:71], a[116:119], v[224:227], v[68:71]
    v_mfma_f32_16x16x32_bf16 v[72:75], a[120:123], v[224:227], v[72:75]
    v_mfma_f32_16x16x32_bf16 v[76:79], a[124:127], v[224:227], v[76:79]
    v_mfma_f32_16x16x32_bf16 v[80:83], a[128:131], v[224:227], v[80:83]
    v_mfma_f32_16x16x32_bf16 v[84:87], a[132:135], v[224:227], v[84:87]
    v_mfma_f32_16x16x32_bf16 v[88:91], a[136:139], v[224:227], v[88:91]
    ds_read_b128 v[224:227], v9 offset:22528
    s_waitcnt vmcnt(0) lgkmcnt(1)
    v_mfma_f32_16x16x32_bf16 v[64:67], a[140:143], v[228:231], v[64:67]
    v_mfma_f32_16x16x32_bf16 v[68:71], a[144:147], v[228:231], v[68:71]
    v_mfma_f32_16x16x32_bf16 v[72:75], a[148:151], v[228:231], v[72:75]
    v_mfma_f32_16x16x32_bf16 v[76:79], a[152:155], v[228:231], v[76:79]
    v_mfma_f32_16x16x32_bf16 v[80:83], a[156:159], v[228:231], v[80:83]
    v_mfma_f32_16x16x32_bf16 v[84:87], a[160:163], v[228:231], v[84:87]
    v_mfma_f32_16x16x32_bf16 v[88:91], a[164:167], v[228:231], v[88:91]
    ds_read_b128 v[228:231], v9 offset:23552
    s_waitcnt vmcnt(0) lgkmcnt(1)
    v_mfma_f32_16x16x32_bf16 v[64:67], a[168:171], v[224:227], v[64:67]
    v_mfma_f32_16x16x32_bf16 v[68:71], a[172:175], v[224:227], v[68:71]
    v_mfma_f32_16x16x32_bf16 v[72:75], a[176:179], v[224:227], v[72:75]
    v_mfma_f32_16x16x32_bf16 v[76:79], a[180:183], v[224:227], v[76:79]
    v_mfma_f32_16x16x32_bf16 v[80:83], a[184:187], v[224:227], v[80:83]
    v_mfma_f32_16x16x32_bf16 v[84:87], a[188:191], v[224:227], v[84:87]
    v_mfma_f32_16x16x32_bf16 v[88:91], a[192:195], v[224:227], v[88:91]
    s_waitcnt vmcnt(0) lgkmcnt(0)
    v_mfma_f32_16x16x32_bf16 v[64:67], a[196:199], v[228:231], v[64:67]
    v_mfma_f32_16x16x32_bf16 v[68:71], a[200:203], v[228:231], v[68:71]
    v_mfma_f32_16x16x32_bf16 v[72:75], a[204:207], v[228:231], v[72:75]
    v_mfma_f32_16x16x32_bf16 v[76:79], a[208:211], v[228:231], v[76:79]
    v_mfma_f32_16x16x32_bf16 v[80:83], a[212:215], v[228:231], v[80:83]
    v_mfma_f32_16x16x32_bf16 v[84:87], a[216:219], v[228:231], v[84:87]
    v_mfma_f32_16x16x32_bf16 v[88:91], a[220:223], v[228:231], v[88:91]
    s_nop 9
    s_lshl_b32 s20, s2, 5
    s_add_u32 s20, s20, 16
    v_add_u32 v10, s20, v2
    v_mul_u32_u24 v10, 896, v10
    s_mul_i32 s21, s10, 224
    v_lshl_add_u32 v10, v3, 3, v10
    v_add_u32 v10, s21, v10
    s_mul_i32 s21, s10, 448
    v_lshlrev_b32 v12, 4, v3
    v_add_u32 v12, s21, v12
    s_add_u32 s22, s4, 0xe00
    s_addc_u32 s23, s5, 0
    s_add_u32 s24, s4, 0x6c55000
    s_addc_u32 s25, s5, 0
    global_load_dwordx4 v[160:163], v12, s[22:23] offset:0
    global_load_dwordx2 v[120:121], v10, s[6:7] offset:0
    global_load_dwordx4 v[164:167], v12, s[22:23] offset:64
    global_load_dwordx2 v[122:123], v10, s[6:7] offset:32
    global_load_dwordx4 v[168:171], v12, s[22:23] offset:128
    global_load_dwordx2 v[124:125], v10, s[6:7] offset:64
    global_load_dwordx4 v[172:175], v12, s[22:23] offset:192
    global_load_dwordx2 v[126:127], v10, s[6:7] offset:96
    global_load_dwordx4 v[176:179], v12, s[22:23] offset:256
    global_load_dwordx2 v[128:129], v10, s[6:7] offset:128
    global_load_dwordx4 v[180:183], v12, s[22:23] offset:320
    global_load_dwordx2 v[130:131], v10, s[6:7] offset:160
    global_load_dwordx4 v[184:187], v12, s[22:23] offset:384
    global_load_dwordx2 v[132:133], v10, s[6:7] offset:192
    s_waitcnt vmcnt(0)
    v_cvt_pk_bf16_f32 v32, v64, v65
    v_lshlrev_b32 v64, 16, v32
    v_and_b32 v65, 0xffff0000, v32
    v_cvt_pk_bf16_f32 v32, v66, v67
    v_lshlrev_b32 v66, 16, v32
    v_and_b32 v67, 0xffff0000, v32
    v_mul_f32 v64, v64, v160
    v_mul_f32 v65, v65, v161
    v_mul_f32 v66, v66, v162
    v_mul_f32 v67, v67, v163
    v_cvt_pk_bf16_f32 v32, v64, v65
    v_lshlrev_b32 v64, 16, v32
    v_and_b32 v65, 0xffff0000, v32
    v_cvt_pk_bf16_f32 v32, v66, v67
    v_lshlrev_b32 v66, 16, v32
    v_and_b32 v67, 0xffff0000, v32
    v_lshlrev_b32 v32, 16, v120
    v_and_b32 v33, 0xffff0000, v120
    v_add_f32 v64, v64, v32
    v_add_f32 v65, v65, v33
    v_lshlrev_b32 v32, 16, v121
    v_and_b32 v33, 0xffff0000, v121
    v_add_f32 v66, v66, v32
    v_add_f32 v67, v67, v33
    v_cvt_pk_bf16_f32 v120, v64, v65
    v_cvt_pk_bf16_f32 v121, v66, v67
    global_store_dwordx2 v10, v[120:121], s[24:25] offset:0 sc1
    v_lshlrev_b32 v64, 16, v120
    v_and_b32 v65, 0xffff0000, v120
    v_lshlrev_b32 v66, 16, v121
    v_and_b32 v67, 0xffff0000, v121
    v_cvt_pk_bf16_f32 v32, v68, v69
    v_lshlrev_b32 v68, 16, v32
    v_and_b32 v69, 0xffff0000, v32
    v_cvt_pk_bf16_f32 v32, v70, v71
    v_lshlrev_b32 v70, 16, v32
    v_and_b32 v71, 0xffff0000, v32
    v_mul_f32 v68, v68, v164
    v_mul_f32 v69, v69, v165
    v_mul_f32 v70, v70, v166
    v_mul_f32 v71, v71, v167
    v_cvt_pk_bf16_f32 v32, v68, v69
    v_lshlrev_b32 v68, 16, v32
    v_and_b32 v69, 0xffff0000, v32
    v_cvt_pk_bf16_f32 v32, v70, v71
    v_lshlrev_b32 v70, 16, v32
    v_and_b32 v71, 0xffff0000, v32
    v_lshlrev_b32 v32, 16, v122
    v_and_b32 v33, 0xffff0000, v122
    v_add_f32 v68, v68, v32
    v_add_f32 v69, v69, v33
    v_lshlrev_b32 v32, 16, v123
    v_and_b32 v33, 0xffff0000, v123
    v_add_f32 v70, v70, v32
    v_add_f32 v71, v71, v33
    v_cvt_pk_bf16_f32 v122, v68, v69
    v_cvt_pk_bf16_f32 v123, v70, v71
    global_store_dwordx2 v10, v[122:123], s[24:25] offset:32 sc1
    v_lshlrev_b32 v68, 16, v122
    v_and_b32 v69, 0xffff0000, v122
    v_lshlrev_b32 v70, 16, v123
    v_and_b32 v71, 0xffff0000, v123
    v_cvt_pk_bf16_f32 v32, v72, v73
    v_lshlrev_b32 v72, 16, v32
    v_and_b32 v73, 0xffff0000, v32
    v_cvt_pk_bf16_f32 v32, v74, v75
    v_lshlrev_b32 v74, 16, v32
    v_and_b32 v75, 0xffff0000, v32
    v_mul_f32 v72, v72, v168
    v_mul_f32 v73, v73, v169
    v_mul_f32 v74, v74, v170
    v_mul_f32 v75, v75, v171
    v_cvt_pk_bf16_f32 v32, v72, v73
    v_lshlrev_b32 v72, 16, v32
    v_and_b32 v73, 0xffff0000, v32
    v_cvt_pk_bf16_f32 v32, v74, v75
    v_lshlrev_b32 v74, 16, v32
    v_and_b32 v75, 0xffff0000, v32
    v_lshlrev_b32 v32, 16, v124
    v_and_b32 v33, 0xffff0000, v124
    v_add_f32 v72, v72, v32
    v_add_f32 v73, v73, v33
    v_lshlrev_b32 v32, 16, v125
    v_and_b32 v33, 0xffff0000, v125
    v_add_f32 v74, v74, v32
    v_add_f32 v75, v75, v33
    v_cvt_pk_bf16_f32 v124, v72, v73
    v_cvt_pk_bf16_f32 v125, v74, v75
    global_store_dwordx2 v10, v[124:125], s[24:25] offset:64 sc1
    v_lshlrev_b32 v72, 16, v124
    v_and_b32 v73, 0xffff0000, v124
    v_lshlrev_b32 v74, 16, v125
    v_and_b32 v75, 0xffff0000, v125
    v_cvt_pk_bf16_f32 v32, v76, v77
    v_lshlrev_b32 v76, 16, v32
    v_and_b32 v77, 0xffff0000, v32
    v_cvt_pk_bf16_f32 v32, v78, v79
    v_lshlrev_b32 v78, 16, v32
    v_and_b32 v79, 0xffff0000, v32
    v_mul_f32 v76, v76, v172
    v_mul_f32 v77, v77, v173
    v_mul_f32 v78, v78, v174
    v_mul_f32 v79, v79, v175
    v_cvt_pk_bf16_f32 v32, v76, v77
    v_lshlrev_b32 v76, 16, v32
    v_and_b32 v77, 0xffff0000, v32
    v_cvt_pk_bf16_f32 v32, v78, v79
    v_lshlrev_b32 v78, 16, v32
    v_and_b32 v79, 0xffff0000, v32
    v_lshlrev_b32 v32, 16, v126
    v_and_b32 v33, 0xffff0000, v126
    v_add_f32 v76, v76, v32
    v_add_f32 v77, v77, v33
    v_lshlrev_b32 v32, 16, v127
    v_and_b32 v33, 0xffff0000, v127
    v_add_f32 v78, v78, v32
    v_add_f32 v79, v79, v33
    v_cvt_pk_bf16_f32 v126, v76, v77
    v_cvt_pk_bf16_f32 v127, v78, v79
    global_store_dwordx2 v10, v[126:127], s[24:25] offset:96 sc1
    v_lshlrev_b32 v76, 16, v126
    v_and_b32 v77, 0xffff0000, v126
    v_lshlrev_b32 v78, 16, v127
    v_and_b32 v79, 0xffff0000, v127
    v_cvt_pk_bf16_f32 v32, v80, v81
    v_lshlrev_b32 v80, 16, v32
    v_and_b32 v81, 0xffff0000, v32
    v_cvt_pk_bf16_f32 v32, v82, v83
    v_lshlrev_b32 v82, 16, v32
    v_and_b32 v83, 0xffff0000, v32
    v_mul_f32 v80, v80, v176
    v_mul_f32 v81, v81, v177
    v_mul_f32 v82, v82, v178
    v_mul_f32 v83, v83, v179
    v_cvt_pk_bf16_f32 v32, v80, v81
    v_lshlrev_b32 v80, 16, v32
    v_and_b32 v81, 0xffff0000, v32
    v_cvt_pk_bf16_f32 v32, v82, v83
    v_lshlrev_b32 v82, 16, v32
    v_and_b32 v83, 0xffff0000, v32
    v_lshlrev_b32 v32, 16, v128
    v_and_b32 v33, 0xffff0000, v128
    v_add_f32 v80, v80, v32
    v_add_f32 v81, v81, v33
    v_lshlrev_b32 v32, 16, v129
    v_and_b32 v33, 0xffff0000, v129
    v_add_f32 v82, v82, v32
    v_add_f32 v83, v83, v33
    v_cvt_pk_bf16_f32 v128, v80, v81
    v_cvt_pk_bf16_f32 v129, v82, v83
    global_store_dwordx2 v10, v[128:129], s[24:25] offset:128 sc1
    v_lshlrev_b32 v80, 16, v128
    v_and_b32 v81, 0xffff0000, v128
    v_lshlrev_b32 v82, 16, v129
    v_and_b32 v83, 0xffff0000, v129
    v_cvt_pk_bf16_f32 v32, v84, v85
    v_lshlrev_b32 v84, 16, v32
    v_and_b32 v85, 0xffff0000, v32
    v_cvt_pk_bf16_f32 v32, v86, v87
    v_lshlrev_b32 v86, 16, v32
    v_and_b32 v87, 0xffff0000, v32
    v_mul_f32 v84, v84, v180
    v_mul_f32 v85, v85, v181
    v_mul_f32 v86, v86, v182
    v_mul_f32 v87, v87, v183
    v_cvt_pk_bf16_f32 v32, v84, v85
    v_lshlrev_b32 v84, 16, v32
    v_and_b32 v85, 0xffff0000, v32
    v_cvt_pk_bf16_f32 v32, v86, v87
    v_lshlrev_b32 v86, 16, v32
    v_and_b32 v87, 0xffff0000, v32
    v_lshlrev_b32 v32, 16, v130
    v_and_b32 v33, 0xffff0000, v130
    v_add_f32 v84, v84, v32
    v_add_f32 v85, v85, v33
    v_lshlrev_b32 v32, 16, v131
    v_and_b32 v33, 0xffff0000, v131
    v_add_f32 v86, v86, v32
    v_add_f32 v87, v87, v33
    v_cvt_pk_bf16_f32 v130, v84, v85
    v_cvt_pk_bf16_f32 v131, v86, v87
    global_store_dwordx2 v10, v[130:131], s[24:25] offset:160 sc1
    v_lshlrev_b32 v84, 16, v130
    v_and_b32 v85, 0xffff0000, v130
    v_lshlrev_b32 v86, 16, v131
    v_and_b32 v87, 0xffff0000, v131
    v_cvt_pk_bf16_f32 v32, v88, v89
    v_lshlrev_b32 v88, 16, v32
    v_and_b32 v89, 0xffff0000, v32
    v_cvt_pk_bf16_f32 v32, v90, v91
    v_lshlrev_b32 v90, 16, v32
    v_and_b32 v91, 0xffff0000, v32
    v_mul_f32 v88, v88, v184
    v_mul_f32 v89, v89, v185
    v_mul_f32 v90, v90, v186
    v_mul_f32 v91, v91, v187
    v_cvt_pk_bf16_f32 v32, v88, v89
    v_lshlrev_b32 v88, 16, v32
    v_and_b32 v89, 0xffff0000, v32
    v_cvt_pk_bf16_f32 v32, v90, v91
    v_lshlrev_b32 v90, 16, v32
    v_and_b32 v91, 0xffff0000, v32
    v_lshlrev_b32 v32, 16, v132
    v_and_b32 v33, 0xffff0000, v132
    v_add_f32 v88, v88, v32
    v_add_f32 v89, v89, v33
    v_lshlrev_b32 v32, 16, v133
    v_and_b32 v33, 0xffff0000, v133
    v_add_f32 v90, v90, v32
    v_add_f32 v91, v91, v33
    v_cvt_pk_bf16_f32 v132, v88, v89
    v_cvt_pk_bf16_f32 v133, v90, v91
    global_store_dwordx2 v10, v[132:133], s[24:25] offset:192 sc1
    v_lshlrev_b32 v88, 16, v132
    v_and_b32 v89, 0xffff0000, v132
    v_lshlrev_b32 v90, 16, v133
    v_and_b32 v91, 0xffff0000, v133
    s_add_u32 s22, s4, 0x1500
    s_addc_u32 s23, s5, 0
    s_add_u32 s26, s4, 0x1c00
    s_addc_u32 s27, s5, 0
    s_add_u32 s24, s4, 0x6e15000
    s_addc_u32 s25, s5, 0
    global_load_dwordx4 v[160:163], v12, s[22:23] offset:0
    global_load_dwordx4 v[192:195], v12, s[26:27] offset:0
    global_load_dwordx4 v[164:167], v12, s[22:23] offset:64
    global_load_dwordx4 v[196:199], v12, s[26:27] offset:64
    global_load_dwordx4 v[168:171], v12, s[22:23] offset:128
    global_load_dwordx4 v[200:203], v12, s[26:27] offset:128
    global_load_dwordx4 v[172:175], v12, s[22:23] offset:192
    global_load_dwordx4 v[204:207], v12, s[26:27] offset:192
    global_load_dwordx4 v[176:179], v12, s[22:23] offset:256
    global_load_dwordx4 v[208:211], v12, s[26:27] offset:256
    global_load_dwordx4 v[180:183], v12, s[22:23] offset:320
    global_load_dwordx4 v[212:215], v12, s[26:27] offset:320
    global_load_dwordx4 v[184:187], v12, s[22:23] offset:384
    global_load_dwordx4 v[216:219], v12, s[26:27] offset:384
    v_lshlrev_b32 v34, 2, v2
    v_add_u32 v34, 24576, v34
    s_lshl_b32 s21, s10, 6
    v_add_u32 v33, s21, v34
    v_add_f32 v40, v64, v65
    v_add_f32 v40, v40, v66
    v_add_f32 v40, v40, v67
    v_add_f32 v40, v40, v68
    v_add_f32 v40, v40, v69
    v_add_f32 v40, v40, v70
    v_add_f32 v40, v40, v71
    v_add_f32 v40, v40, v72
    v_add_f32 v40, v40, v73
    v_add_f32 v40, v40, v74
    v_add_f32 v40, v40, v75
    v_add_f32 v40, v40, v76
    v_add_f32 v40, v40, v77
    v_add_f32 v40, v40, v78
    v_add_f32 v40, v40, v79
    v_add_f32 v40, v40, v80
    v_add_f32 v40, v40, v81
    v_add_f32 v40, v40, v82
    v_add_f32 v40, v40, v83
    v_add_f32 v40, v40, v84
    v_add_f32 v40, v40, v85
    v_add_f32 v40, v40, v86
    v_add_f32 v40, v40, v87
    v_add_f32 v40, v40, v88
    v_add_f32 v40, v40, v89
    v_add_f32 v40, v40, v90
    v_add_f32 v40, v40, v91
    v_mov_b32 v36, v40
    s_nop 1
    v_permlane16_swap_b32 v36, v40
    s_nop 1
    v_add_f32 v40, v36, v40
    v_mov_b32 v36, v40
    s_nop 1
    v_permlane32_swap_b32 v36, v40
    s_nop 1
    v_add_f32 v40, v36, v40
    ds_write_b32 v33, v40 offset:0
    s_waitcnt lgkmcnt(0)
    s_barrier
    ds_read_b32 v36, v34 offset:0
    ds_read_b32 v37, v34 offset:64
    ds_read_b32 v38, v34 offset:128
    ds_read_b32 v39, v34 offset:192
    s_waitcnt lgkmcnt(0)
    v_add_f32 v36, v36, v37
    v_add_f32 v38, v38, v39
    v_add_f32 v40, v36, v38
    v_mul_f32 v40, 0x3b124925, v40
    v_mov_b32 v41, 0
    v_sub_f32 v42, v64, v40
    v_fmac_f32 v41, v42, v42
    v_sub_f32 v42, v65, v40
    v_fmac_f32 v41, v42, v42
    v_sub_f32 v42, v66, v40
    v_fmac_f32 v41, v42, v42
    v_sub_f32 v42, v67, v40
    v_fmac_f32 v41, v42, v42
    v_sub_f32 v42, v68, v40
    v_fmac_f32 v41, v42, v42
    v_sub_f32 v42, v69, v40
    v_fmac_f32 v41, v42, v42
    v_sub_f32 v42, v70, v40
    v_fmac_f32 v41, v42, v42
    v_sub_f32 v42, v71, v40
    v_fmac_f32 v41, v42, v42
    v_sub_f32 v42, v72, v40
    v_fmac_f32 v41, v42, v42
    v_sub_f32 v42, v73, v40
    v_fmac_f32 v41, v42, v42
    v_sub_f32 v42, v74, v40
    v_fmac_f32 v41, v42, v42
    v_sub_f32 v42, v75, v40
    v_fmac_f32 v41, v42, v42
    v_sub_f32 v42, v76, v40
    v_fmac_f32 v41, v42, v42
    v_sub_f32 v42, v77, v40
    v_fmac_f32 v41, v42, v42
    v_sub_f32 v42, v78, v40
    v_fmac_f32 v41, v42, v42
    v_sub_f32 v42, v79, v40
    v_fmac_f32 v41, v42, v42
    v_sub_f32 v42, v80, v40
    v_fmac_f32 v41, v42, v42
    v_sub_f32 v42, v81, v40
    v_fmac_f32 v41, v42, v42
    v_sub_f32 v42, v82, v40
    v_fmac_f32 v41, v42, v42
    v_sub_f32 v42, v83, v40
    v_fmac_f32 v41, v42, v42
    v_sub_f32 v42, v84, v40
    v_fmac_f32 v41, v42, v42
    v_sub_f32 v42, v85, v40
    v_fmac_f32 v41, v42, v42
    v_sub_f32 v42, v86, v40
    v_fmac_f32 v41, v42, v42
    v_sub_f32 v42, v87, v40
    v_fmac_f32 v41, v42, v42
    v_sub_f32 v42, v88, v40
    v_fmac_f32 v41, v42, v42
    v_sub_f32 v42, v89, v40
    v_fmac_f32 v41, v42, v42
    v_sub_f32 v42, v90, v40
    v_fmac_f32 v41, v42, v42
    v_sub_f32 v42, v91, v40
    v_fmac_f32 v41, v42, v42
    v_mov_b32 v36, v41
    s_nop 1
    v_permlane16_swap_b32 v36, v41
    s_nop 1
    v_add_f32 v41, v36, v41
    v_mov_b32 v36, v41
    s_nop 1
    v_permlane32_swap_b32 v36, v41
    s_nop 1
    v_add_f32 v41, v36, v41
    ds_write_b32 v33, v41 offset:256
    s_waitcnt lgkmcnt(0)
    s_barrier
    ds_read_b32 v36, v34 offset:256
    ds_read_b32 v37, v34 offset:320
    ds_read_b32 v38, v34 offset:384
    ds_read_b32 v39, v34 offset:448
    s_waitcnt lgkmcnt(0)
    v_add_f32 v36, v36, v37
    v_add_f32 v38, v38, v39
    v_add_f32 v41, v36, v38
    v_mul_f32 v41, 0x3b124925, v41
    v_cvt_pk_bf16_f32 v42, v40, v41
    v_lshlrev_b32 v40, 16, v42
    v_and_b32 v41, 0xffff0000, v42
    v_add_f32 v41, 0x3727c5ac, v41
    v_cvt_pk_bf16_f32 v43, v41, v41
    v_lshlrev_b32 v41, 16, v43
    v_and_b32 v42, 0xffff0000, v43
    v_sqrt_f32 v41, v41
    s_nop 0
    v_cvt_pk_bf16_f32 v43, v41, v41
    v_lshlrev_b32 v41, 16, v43
    v_and_b32 v42, 0xffff0000, v43
    v_rcp_f32 v42, v41
    s_nop 0
    s_waitcnt vmcnt(0)
    v_sub_f32 v64, v64, v40
    v_sub_f32 v65, v65, v40
    v_cvt_pk_bf16_f32 v43, v64, v65
    v_lshlrev_b32 v64, 16, v43
    v_and_b32 v65, 0xffff0000, v43
    v_mul_f32 v44, v64, v42
    v_fma_f32 v45, -v44, v41, v64
    v_fma_f32 v64, v45, v42, v44
    v_mul_f32 v44, v65, v42
    v_fma_f32 v45, -v44, v41, v65
    v_fma_f32 v65, v45, v42, v44
    v_cvt_pk_bf16_f32 v43, v64, v65
    v_lshlrev_b32 v64, 16, v43
    v_and_b32 v65, 0xffff0000, v43
    v_mul_f32 v64, v64, v192
    v_mul_f32 v65, v65, v193
    v_cvt_pk_bf16_f32 v43, v64, v65
    v_lshlrev_b32 v64, 16, v43
    v_and_b32 v65, 0xffff0000, v43
    v_add_f32 v64, v64, v160
    v_add_f32 v65, v65, v161
    v_cvt_pk_bf16_f32 v120, v64, v65
    v_sub_f32 v66, v66, v40
    v_sub_f32 v67, v67, v40
    v_cvt_pk_bf16_f32 v43, v66, v67
    v_lshlrev_b32 v66, 16, v43
    v_and_b32 v67, 0xffff0000, v43
    v_mul_f32 v44, v66, v42
    v_fma_f32 v45, -v44, v41, v66
    v_fma_f32 v66, v45, v42, v44
    v_mul_f32 v44, v67, v42
    v_fma_f32 v45, -v44, v41, v67
    v_fma_f32 v67, v45, v42, v44
    v_cvt_pk_bf16_f32 v43, v66, v67
    v_lshlrev_b32 v66, 16, v43
    v_and_b32 v67, 0xffff0000, v43
    v_mul_f32 v66, v66, v194
    v_mul_f32 v67, v67, v195
    v_cvt_pk_bf16_f32 v43, v66, v67
    v_lshlrev_b32 v66, 16, v43
    v_and_b32 v67, 0xffff0000, v43
    v_add_f32 v66, v66, v162
    v_add_f32 v67, v67, v163
    v_cvt_pk_bf16_f32 v121, v66, v67
    global_store_dwordx2 v10, v[120:121], s[24:25] offset:0 sc1
    v_sub_f32 v68, v68, v40
    v_sub_f32 v69, v69, v40
    v_cvt_pk_bf16_f32 v43, v68, v69
    v_lshlrev_b32 v68, 16, v43
    v_and_b32 v69, 0xffff0000, v43
    v_mul_f32 v44, v68, v42
    v_fma_f32 v45, -v44, v41, v68
    v_fma_f32 v68, v45, v42, v44
    v_mul_f32 v44, v69, v42
    v_fma_f32 v45, -v44, v41, v69
    v_fma_f32 v69, v45, v42, v44
    v_cvt_pk_bf16_f32 v43, v68, v69
    v_lshlrev_b32 v68, 16, v43
    v_and_b32 v69, 0xffff0000, v43
    v_mul_f32 v68, v68, v196
    v_mul_f32 v69, v69, v197
    v_cvt_pk_bf16_f32 v43, v68, v69
    v_lshlrev_b32 v68, 16, v43
    v_and_b32 v69, 0xffff0000, v43
    v_add_f32 v68, v68, v164
    v_add_f32 v69, v69, v165
    v_cvt_pk_bf16_f32 v122, v68, v69
    v_sub_f32 v70, v70, v40
    v_sub_f32 v71, v71, v40
    v_cvt_pk_bf16_f32 v43, v70, v71
    v_lshlrev_b32 v70, 16, v43
    v_and_b32 v71, 0xffff0000, v43
    v_mul_f32 v44, v70, v42
    v_fma_f32 v45, -v44, v41, v70
    v_fma_f32 v70, v45, v42, v44
    v_mul_f32 v44, v71, v42
    v_fma_f32 v45, -v44, v41, v71
    v_fma_f32 v71, v45, v42, v44
    v_cvt_pk_bf16_f32 v43, v70, v71
    v_lshlrev_b32 v70, 16, v43
    v_and_b32 v71, 0xffff0000, v43
    v_mul_f32 v70, v70, v198
    v_mul_f32 v71, v71, v199
    v_cvt_pk_bf16_f32 v43, v70, v71
    v_lshlrev_b32 v70, 16, v43
    v_and_b32 v71, 0xffff0000, v43
    v_add_f32 v70, v70, v166
    v_add_f32 v71, v71, v167
    v_cvt_pk_bf16_f32 v123, v70, v71
    global_store_dwordx2 v10, v[122:123], s[24:25] offset:32 sc1
    v_sub_f32 v72, v72, v40
    v_sub_f32 v73, v73, v40
    v_cvt_pk_bf16_f32 v43, v72, v73
    v_lshlrev_b32 v72, 16, v43
    v_and_b32 v73, 0xffff0000, v43
    v_mul_f32 v44, v72, v42
    v_fma_f32 v45, -v44, v41, v72
    v_fma_f32 v72, v45, v42, v44
    v_mul_f32 v44, v73, v42
    v_fma_f32 v45, -v44, v41, v73
    v_fma_f32 v73, v45, v42, v44
    v_cvt_pk_bf16_f32 v43, v72, v73
    v_lshlrev_b32 v72, 16, v43
    v_and_b32 v73, 0xffff0000, v43
    v_mul_f32 v72, v72, v200
    v_mul_f32 v73, v73, v201
    v_cvt_pk_bf16_f32 v43, v72, v73
    v_lshlrev_b32 v72, 16, v43
    v_and_b32 v73, 0xffff0000, v43
    v_add_f32 v72, v72, v168
    v_add_f32 v73, v73, v169
    v_cvt_pk_bf16_f32 v124, v72, v73
    v_sub_f32 v74, v74, v40
    v_sub_f32 v75, v75, v40
    v_cvt_pk_bf16_f32 v43, v74, v75
    v_lshlrev_b32 v74, 16, v43
    v_and_b32 v75, 0xffff0000, v43
    v_mul_f32 v44, v74, v42
    v_fma_f32 v45, -v44, v41, v74
    v_fma_f32 v74, v45, v42, v44
    v_mul_f32 v44, v75, v42
    v_fma_f32 v45, -v44, v41, v75
    v_fma_f32 v75, v45, v42, v44
    v_cvt_pk_bf16_f32 v43, v74, v75
    v_lshlrev_b32 v74, 16, v43
    v_and_b32 v75, 0xffff0000, v43
    v_mul_f32 v74, v74, v202
    v_mul_f32 v75, v75, v203
    v_cvt_pk_bf16_f32 v43, v74, v75
    v_lshlrev_b32 v74, 16, v43
    v_and_b32 v75, 0xffff0000, v43
    v_add_f32 v74, v74, v170
    v_add_f32 v75, v75, v171
    v_cvt_pk_bf16_f32 v125, v74, v75
    global_store_dwordx2 v10, v[124:125], s[24:25] offset:64 sc1
    v_sub_f32 v76, v76, v40
    v_sub_f32 v77, v77, v40
    v_cvt_pk_bf16_f32 v43, v76, v77
    v_lshlrev_b32 v76, 16, v43
    v_and_b32 v77, 0xffff0000, v43
    v_mul_f32 v44, v76, v42
    v_fma_f32 v45, -v44, v41, v76
    v_fma_f32 v76, v45, v42, v44
    v_mul_f32 v44, v77, v42
    v_fma_f32 v45, -v44, v41, v77
    v_fma_f32 v77, v45, v42, v44
    v_cvt_pk_bf16_f32 v43, v76, v77
    v_lshlrev_b32 v76, 16, v43
    v_and_b32 v77, 0xffff0000, v43
    v_mul_f32 v76, v76, v204
    v_mul_f32 v77, v77, v205
    v_cvt_pk_bf16_f32 v43, v76, v77
    v_lshlrev_b32 v76, 16, v43
    v_and_b32 v77, 0xffff0000, v43
    v_add_f32 v76, v76, v172
    v_add_f32 v77, v77, v173
    v_cvt_pk_bf16_f32 v126, v76, v77
    v_sub_f32 v78, v78, v40
    v_sub_f32 v79, v79, v40
    v_cvt_pk_bf16_f32 v43, v78, v79
    v_lshlrev_b32 v78, 16, v43
    v_and_b32 v79, 0xffff0000, v43
    v_mul_f32 v44, v78, v42
    v_fma_f32 v45, -v44, v41, v78
    v_fma_f32 v78, v45, v42, v44
    v_mul_f32 v44, v79, v42
    v_fma_f32 v45, -v44, v41, v79
    v_fma_f32 v79, v45, v42, v44
    v_cvt_pk_bf16_f32 v43, v78, v79
    v_lshlrev_b32 v78, 16, v43
    v_and_b32 v79, 0xffff0000, v43
    v_mul_f32 v78, v78, v206
    v_mul_f32 v79, v79, v207
    v_cvt_pk_bf16_f32 v43, v78, v79
    v_lshlrev_b32 v78, 16, v43
    v_and_b32 v79, 0xffff0000, v43
    v_add_f32 v78, v78, v174
    v_add_f32 v79, v79, v175
    v_cvt_pk_bf16_f32 v127, v78, v79
    global_store_dwordx2 v10, v[126:127], s[24:25] offset:96 sc1
    v_sub_f32 v80, v80, v40
    v_sub_f32 v81, v81, v40
    v_cvt_pk_bf16_f32 v43, v80, v81
    v_lshlrev_b32 v80, 16, v43
    v_and_b32 v81, 0xffff0000, v43
    v_mul_f32 v44, v80, v42
    v_fma_f32 v45, -v44, v41, v80
    v_fma_f32 v80, v45, v42, v44
    v_mul_f32 v44, v81, v42
    v_fma_f32 v45, -v44, v41, v81
    v_fma_f32 v81, v45, v42, v44
    v_cvt_pk_bf16_f32 v43, v80, v81
    v_lshlrev_b32 v80, 16, v43
    v_and_b32 v81, 0xffff0000, v43
    v_mul_f32 v80, v80, v208
    v_mul_f32 v81, v81, v209
    v_cvt_pk_bf16_f32 v43, v80, v81
    v_lshlrev_b32 v80, 16, v43
    v_and_b32 v81, 0xffff0000, v43
    v_add_f32 v80, v80, v176
    v_add_f32 v81, v81, v177
    v_cvt_pk_bf16_f32 v128, v80, v81
    v_sub_f32 v82, v82, v40
    v_sub_f32 v83, v83, v40
    v_cvt_pk_bf16_f32 v43, v82, v83
    v_lshlrev_b32 v82, 16, v43
    v_and_b32 v83, 0xffff0000, v43
    v_mul_f32 v44, v82, v42
    v_fma_f32 v45, -v44, v41, v82
    v_fma_f32 v82, v45, v42, v44
    v_mul_f32 v44, v83, v42
    v_fma_f32 v45, -v44, v41, v83
    v_fma_f32 v83, v45, v42, v44
    v_cvt_pk_bf16_f32 v43, v82, v83
    v_lshlrev_b32 v82, 16, v43
    v_and_b32 v83, 0xffff0000, v43
    v_mul_f32 v82, v82, v210
    v_mul_f32 v83, v83, v211
    v_cvt_pk_bf16_f32 v43, v82, v83
    v_lshlrev_b32 v82, 16, v43
    v_and_b32 v83, 0xffff0000, v43
    v_add_f32 v82, v82, v178
    v_add_f32 v83, v83, v179
    v_cvt_pk_bf16_f32 v129, v82, v83
    global_store_dwordx2 v10, v[128:129], s[24:25] offset:128 sc1
    v_sub_f32 v84, v84, v40
    v_sub_f32 v85, v85, v40
    v_cvt_pk_bf16_f32 v43, v84, v85
    v_lshlrev_b32 v84, 16, v43
    v_and_b32 v85, 0xffff0000, v43
    v_mul_f32 v44, v84, v42
    v_fma_f32 v45, -v44, v41, v84
    v_fma_f32 v84, v45, v42, v44
    v_mul_f32 v44, v85, v42
    v_fma_f32 v45, -v44, v41, v85
    v_fma_f32 v85, v45, v42, v44
    v_cvt_pk_bf16_f32 v43, v84, v85
    v_lshlrev_b32 v84, 16, v43
    v_and_b32 v85, 0xffff0000, v43
    v_mul_f32 v84, v84, v212
    v_mul_f32 v85, v85, v213
    v_cvt_pk_bf16_f32 v43, v84, v85
    v_lshlrev_b32 v84, 16, v43
    v_and_b32 v85, 0xffff0000, v43
    v_add_f32 v84, v84, v180
    v_add_f32 v85, v85, v181
    v_cvt_pk_bf16_f32 v130, v84, v85
    v_sub_f32 v86, v86, v40
    v_sub_f32 v87, v87, v40
    v_cvt_pk_bf16_f32 v43, v86, v87
    v_lshlrev_b32 v86, 16, v43
    v_and_b32 v87, 0xffff0000, v43
    v_mul_f32 v44, v86, v42
    v_fma_f32 v45, -v44, v41, v86
    v_fma_f32 v86, v45, v42, v44
    v_mul_f32 v44, v87, v42
    v_fma_f32 v45, -v44, v41, v87
    v_fma_f32 v87, v45, v42, v44
    v_cvt_pk_bf16_f32 v43, v86, v87
    v_lshlrev_b32 v86, 16, v43
    v_and_b32 v87, 0xffff0000, v43
    v_mul_f32 v86, v86, v214
    v_mul_f32 v87, v87, v215
    v_cvt_pk_bf16_f32 v43, v86, v87
    v_lshlrev_b32 v86, 16, v43
    v_and_b32 v87, 0xffff0000, v43
    v_add_f32 v86, v86, v182
    v_add_f32 v87, v87, v183
    v_cvt_pk_bf16_f32 v131, v86, v87
    global_store_dwordx2 v10, v[130:131], s[24:25] offset:160 sc1
    v_sub_f32 v88, v88, v40
    v_sub_f32 v89, v89, v40
    v_cvt_pk_bf16_f32 v43, v88, v89
    v_lshlrev_b32 v88, 16, v43
    v_and_b32 v89, 0xffff0000, v43
    v_mul_f32 v44, v88, v42
    v_fma_f32 v45, -v44, v41, v88
    v_fma_f32 v88, v45, v42, v44
    v_mul_f32 v44, v89, v42
    v_fma_f32 v45, -v44, v41, v89
    v_fma_f32 v89, v45, v42, v44
    v_cvt_pk_bf16_f32 v43, v88, v89
    v_lshlrev_b32 v88, 16, v43
    v_and_b32 v89, 0xffff0000, v43
    v_mul_f32 v88, v88, v216
    v_mul_f32 v89, v89, v217
    v_cvt_pk_bf16_f32 v43, v88, v89
    v_lshlrev_b32 v88, 16, v43
    v_and_b32 v89, 0xffff0000, v43
    v_add_f32 v88, v88, v184
    v_add_f32 v89, v89, v185
    v_cvt_pk_bf16_f32 v132, v88, v89
    v_sub_f32 v90, v90, v40
    v_sub_f32 v91, v91, v40
    v_cvt_pk_bf16_f32 v43, v90, v91
    v_lshlrev_b32 v90, 16, v43
    v_and_b32 v91, 0xffff0000, v43
    v_mul_f32 v44, v90, v42
    v_fma_f32 v45, -v44, v41, v90
    v_fma_f32 v90, v45, v42, v44
    v_mul_f32 v44, v91, v42
    v_fma_f32 v45, -v44, v41, v91
    v_fma_f32 v91, v45, v42, v44
    v_cvt_pk_bf16_f32 v43, v90, v91
    v_lshlrev_b32 v90, 16, v43
    v_and_b32 v91, 0xffff0000, v43
    v_mul_f32 v90, v90, v218
    v_mul_f32 v91, v91, v219
    v_cvt_pk_bf16_f32 v43, v90, v91
    v_lshlrev_b32 v90, 16, v43
    v_and_b32 v91, 0xffff0000, v43
    v_add_f32 v90, v90, v186
    v_add_f32 v91, v91, v187
    v_cvt_pk_bf16_f32 v133, v90, v91
    global_store_dwordx2 v10, v[132:133], s[24:25] offset:192 sc1
sig_attn_9:
    s_waitcnt vmcnt(0)
    s_barrier
    s_add_u32 s94, s4, 0x6bd3800
    s_addc_u32 s95, s5, 0
    v_mov_b32 v2, s62
    v_mov_b32 v3, 1
    v_cmp_eq_u32 vcc, 0, v0
    s_and_saveexec_b64 s[88:89], vcc
    s_cbranch_execz sg_attn_24
    global_atomic_add v2, v3, s[94:95] sc1
sg_attn_24:
    s_mov_b64 exec, s[88:89]
end_attn_1:
    s_barrier
    s_add_u32 s90, s90, 128
    s_cmp_lt_u32 s90, 128
    s_cbranch_scc1 wl_chain_37
sk_chain_38:
    s_sub_u32 s90, s91, 128
    s_cmp_ge_u32 s90, 96
    s_cbranch_scc1 sk_chain_40
wl_chain_39:
    s_mov_b32 s2, s90
    s_cmp_ge_u32 s2, 896
    s_cbranch_scc1 end_f1_1
    s_load_dwordx2 s[4:5], s[0:1], 128
    s_load_dwordx2 s[12:13], s[0:1], 72
    s_mov_b32 s20, 0
    s_mov_b32 s21, s2
    s_mul_i32 s22, s21, 1171
    s_lshr_b32 s22, s22, 15
    s_mul_i32 s23, s22, 28
    s_sub_u32 s23, s21, s23
    v_and_b32 v1, 63, v0
    v_lshrrev_b32 v2, 6, v0
    s_nop 0
    v_readfirstlane_b32 s24, v2
    s_waitcnt lgkmcnt(0)
    s_add_u32 s6, s4, 0x6e15000
    s_addc_u32 s7, s5, 0
    s_add_u32 s8, s4, 0x543000
    s_addc_u32 s9, s5, 0
    s_add_u32 s10, s4, 0x6fd5000
    s_addc_u32 s11, s5, 0
    s_mul_i32 s42, s23, 57344
    v_and_b32 v2, 63, v0
    v_lshlrev_b32 v2, 7, v2
    s_mul_i32 s93, s24, 14336
    s_add_u32 s93, s93, s42
    v_add_u32 v2, s93, v2
    global_load_dword v255, v2, s[8:9]
    v_add_u32 v2, 8192, v2
    v_and_b32 v3, 63, v0
    v_cmp_gt_u32 vcc, 48, v3
    s_and_saveexec_b64 s[88:89], vcc
    global_load_dword v255, v2, s[8:9]
    s_mov_b64 exec, s[88:89]
    s_lshr_b32 s41, s22, 1
    s_lshl_b32 s41, s41, 6
    s_cmp_lg_u32 s24, 0
    s_cbranch_scc1 wo_f1_7
    s_add_u32 s94, s4, 0x6bd3800
    s_addc_u32 s95, s5, 0
    v_mov_b32 v2, s41
wc_f1_5:
    global_load_dword v3, v2, s[94:95] sc1
    s_add_u32 s92, s92, 1
    s_cmp_gt_u32 s92, 524288
    s_cbranch_scc1 wd_f1_6
    s_waitcnt vmcnt(0)
    v_cmp_gt_u32 vcc, 8, v3
    s_nop 1
    s_cbranch_vccz wd_f1_6
    s_sleep 2
    s_branch wc_f1_5
wd_f1_6:
    buffer_inv sc1
    s_waitcnt vmcnt(0)
wo_f1_7:
    s_barrier
    s_mul_i32 s42, s22, 57344
    v_and_b32 v2, 63, v0
    v_lshlrev_b32 v2, 7, v2
    s_mul_i32 s93, s24, 14336
    s_add_u32 s93, s93, s42
    v_add_u32 v2, s93, v2
    global_load_dword v255, v2, s[6:7]
    v_add_u32 v2, 8192, v2
    v_and_b32 v3, 63, v0
    v_cmp_gt_u32 vcc, 48, v3
    s_and_saveexec_b64 s[88:89], vcc
    global_load_dword v255, v2, s[6:7]
    s_mov_b64 exec, s[88:89]
    s_lshr_b32 s25, s24, 1
    s_and_b32 s26, s24, 1
    v_lshrrev_b32 v2, 3, v0
    v_and_b32 v3, 7, v0
    v_lshlrev_b32 v3, 4, v3
    s_mul_i32 s27, s22, 64
    s_mul_i32 s28, s23, 64
    s_mov_b32 s29, 896
    s_mov_b32 s30, 896
    v_add_u32 v4, s27, v2
    v_mul_lo_u32 v4, v4, s29
    v_add_u32 v8, v4, v3
    v_add_u32 v9, 28672, v8
    v_add_u32 v4, s28, v2
    v_mul_lo_u32 v4, v4, s30
    v_add_u32 v10, v4, v3
    v_add_u32 v11, 28672, v10
    v_mul_u32_u24 v4, 144, v2
    v_add_u32 v12, v4, v3
    v_add_u32 v13, 9216, v12
    v_and_b32 v4, 31, v1
    v_lshrrev_b32 v5, 5, v1
    v_lshlrev_b32 v5, 4, v5
    s_mul_i32 s31, s25, 32
    v_add_u32 v6, s31, v4
    v_mul_u32_u24 v6, 144, v6
    v_add_u32 v14, v6, v5
    s_mul_i32 s31, s26, 32
    v_add_u32 v6, s31, v4
    v_mul_u32_u24 v6, 144, v6
    v_add_u32 v6, v6, v5
    v_add_u32 v15, 9216, v6
    v_accvgpr_write_b32 a0, 0
    v_accvgpr_write_b32 a1, 0
    v_accvgpr_write_b32 a2, 0
    v_accvgpr_write_b32 a3, 0
    v_accvgpr_write_b32 a4, 0
    v_accvgpr_write_b32 a5, 0
    v_accvgpr_write_b32 a6, 0
    v_accvgpr_write_b32 a7, 0
    v_accvgpr_write_b32 a8, 0
    v_accvgpr_write_b32 a9, 0
    v_accvgpr_write_b32 a10, 0
    v_accvgpr_write_b32 a11, 0
    v_accvgpr_write_b32 a12, 0
    v_accvgpr_write_b32 a13, 0
    v_accvgpr_write_b32 a14, 0
    v_accvgpr_write_b32 a15, 0
    v_add_u32 v18, 18432, v14
    v_add_u32 v19, 18432, v15
    v_add_u32 v16, 18432, v12
    v_add_u32 v17, 18432, v13
    global_load_dwordx4 v[24:27], v8, s[6:7]
    global_load_dwordx4 v[28:31], v9, s[6:7]
    global_load_dwordx4 v[32:35], v10, s[8:9]
    global_load_dwordx4 v[36:39], v11, s[8:9]
    s_add_u32 s6, s6, 128
    s_addc_u32 s7, s7, 0
    s_add_u32 s8, s8, 128
    s_addc_u32 s9, s9, 0
    global_load_dwordx4 v[40:43], v8, s[6:7]
    global_load_dwordx4 v[44:47], v9, s[6:7]
    global_load_dwordx4 v[48:51], v10, s[8:9]
    global_load_dwordx4 v[52:55], v11, s[8:9]
    s_add_u32 s6, s6, 128
    s_addc_u32 s7, s7, 0
    s_add_u32 s8, s8, 128
    s_addc_u32 s9, s9, 0
    global_load_dwordx4 v[56:59], v8, s[6:7]
    global_load_dwordx4 v[60:63], v9, s[6:7]
    global_load_dwordx4 v[64:67], v10, s[8:9]
    global_load_dwordx4 v[68:71], v11, s[8:9]
    s_add_u32 s6, s6, 128
    s_addc_u32 s7, s7, 0
    s_add_u32 s8, s8, 128
    s_addc_u32 s9, s9, 0
    global_load_dwordx4 v[72:75], v8, s[6:7]
    global_load_dwordx4 v[76:79], v9, s[6:7]
    global_load_dwordx4 v[80:83], v10, s[8:9]
    global_load_dwordx4 v[84:87], v11, s[8:9]
    s_add_u32 s6, s6, 128
    s_addc_u32 s7, s7, 0
    s_add_u32 s8, s8, 128
    s_addc_u32 s9, s9, 0
    s_waitcnt vmcnt(12)
    ds_write_b128 v12, v[24:27] offset:0
    ds_write_b128 v12, v[28:31] offset:4608
    ds_write_b128 v13, v[32:35] offset:0
    ds_write_b128 v13, v[36:39] offset:4608
    s_waitcnt lgkmcnt(0)
    s_barrier
    global_load_dwordx4 v[24:27], v8, s[6:7]
    global_load_dwordx4 v[28:31], v9, s[6:7]
    global_load_dwordx4 v[32:35], v10, s[8:9]
    global_load_dwordx4 v[36:39], v11, s[8:9]
    s_add_u32 s6, s6, 128
    s_addc_u32 s7, s7, 0
    s_add_u32 s8, s8, 128
    s_addc_u32 s9, s9, 0
    ds_read_b128 v[88:91], v14 offset:0
    ds_read_b128 v[92:95], v15 offset:0
    ds_read_b128 v[96:99], v14 offset:32
    ds_read_b128 v[100:103], v15 offset:32
    ds_read_b128 v[104:107], v14 offset:64
    ds_read_b128 v[108:111], v15 offset:64
    ds_read_b128 v[112:115], v14 offset:96
    ds_read_b128 v[116:119], v15 offset:96
    s_waitcnt lgkmcnt(6)
    v_mfma_f32_32x32x16_bf16 a[0:15], v[92:95], v[88:91], a[0:15]
    s_waitcnt lgkmcnt(4)
    v_mfma_f32_32x32x16_bf16 a[0:15], v[100:103], v[96:99], a[0:15]
    s_waitcnt lgkmcnt(2)
    v_mfma_f32_32x32x16_bf16 a[0:15], v[108:111], v[104:107], a[0:15]
    s_waitcnt lgkmcnt(0)
    v_mfma_f32_32x32x16_bf16 a[0:15], v[116:119], v[112:115], a[0:15]
    s_waitcnt vmcnt(12)
    ds_write_b128 v16, v[40:43] offset:0
    ds_write_b128 v16, v[44:47] offset:4608
    ds_write_b128 v17, v[48:51] offset:0
    ds_write_b128 v17, v[52:55] offset:4608
    s_waitcnt lgkmcnt(0)
    s_barrier
    global_load_dwordx4 v[40:43], v8, s[6:7]
    global_load_dwordx4 v[44:47], v9, s[6:7]
    global_load_dwordx4 v[48:51], v10, s[8:9]
    global_load_dwordx4 v[52:55], v11, s[8:9]
    s_add_u32 s6, s6, 128
    s_addc_u32 s7, s7, 0
    s_add_u32 s8, s8, 128
    s_addc_u32 s9, s9, 0
    ds_read_b128 v[88:91], v18 offset:0
    ds_read_b128 v[92:95], v19 offset:0
    ds_read_b128 v[96:99], v18 offset:32
    ds_read_b128 v[100:103], v19 offset:32
    ds_read_b128 v[104:107], v18 offset:64
    ds_read_b128 v[108:111], v19 offset:64
    ds_read_b128 v[112:115], v18 offset:96
    ds_read_b128 v[116:119], v19 offset:96
    s_waitcnt lgkmcnt(6)
    v_mfma_f32_32x32x16_bf16 a[0:15], v[92:95], v[88:91], a[0:15]
    s_waitcnt lgkmcnt(4)
    v_mfma_f32_32x32x16_bf16 a[0:15], v[100:103], v[96:99], a[0:15]
    s_waitcnt lgkmcnt(2)
    v_mfma_f32_32x32x16_bf16 a[0:15], v[108:111], v[104:107], a[0:15]
    s_waitcnt lgkmcnt(0)
    v_mfma_f32_32x32x16_bf16 a[0:15], v[116:119], v[112:115], a[0:15]
    s_waitcnt vmcnt(12)
    ds_write_b128 v12, v[56:59] offset:0
    ds_write_b128 v12, v[60:63] offset:4608
    ds_write_b128 v13, v[64:67] offset:0
    ds_write_b128 v13, v[68:71] offset:4608
    s_waitcnt lgkmcnt(0)
    s_barrier
    global_load_dwordx4 v[56:59], v8, s[6:7]
    global_load_dwordx4 v[60:63], v9, s[6:7]
    global_load_dwordx4 v[64:67], v10, s[8:9]
    global_load_dwordx4 v[68:71], v11, s[8:9]
    s_add_u32 s6, s6, 128
    s_addc_u32 s7, s7, 0
    s_add_u32 s8, s8, 128
    s_addc_u32 s9, s9, 0
    ds_read_b128 v[88:91], v14 offset:0
    ds_read_b128 v[92:95], v15 offset:0
    ds_read_b128 v[96:99], v14 offset:32
    ds_read_b128 v[100:103], v15 offset:32
    ds_read_b128 v[104:107], v14 offset:64
    ds_read_b128 v[108:111], v15 offset:64
    ds_read_b128 v[112:115], v14 offset:96
    ds_read_b128 v[116:119], v15 offset:96
    s_waitcnt lgkmcnt(6)
    v_mfma_f32_32x32x16_bf16 a[0:15], v[92:95], v[88:91], a[0:15]
    s_waitcnt lgkmcnt(4)
    v_mfma_f32_32x32x16_bf16 a[0:15], v[100:103], v[96:99], a[0:15]
    s_waitcnt lgkmcnt(2)
    v_mfma_f32_32x32x16_bf16 a[0:15], v[108:111], v[104:107], a[0:15]
    s_waitcnt lgkmcnt(0)
    v_mfma_f32_32x32x16_bf16 a[0:15], v[116:119], v[112:115], a[0:15]
    s_waitcnt vmcnt(12)
    ds_write_b128 v16, v[72:75] offset:0
    ds_write_b128 v16, v[76:79] offset:4608
    ds_write_b128 v17, v[80:83] offset:0
    ds_write_b128 v17, v[84:87] offset:4608
    s_waitcnt lgkmcnt(0)
    s_barrier
    ds_read_b128 v[88:91], v18 offset:0
    ds_read_b128 v[92:95], v19 offset:0
    ds_read_b128 v[96:99], v18 offset:32
    ds_read_b128 v[100:103], v19 offset:32
    ds_read_b128 v[104:107], v18 offset:64
    ds_read_b128 v[108:111], v19 offset:64
    ds_read_b128 v[112:115], v18 offset:96
    ds_read_b128 v[116:119], v19 offset:96
    s_waitcnt lgkmcnt(6)
    v_mfma_f32_32x32x16_bf16 a[0:15], v[92:95], v[88:91], a[0:15]
    s_waitcnt lgkmcnt(4)
    v_mfma_f32_32x32x16_bf16 a[0:15], v[100:103], v[96:99], a[0:15]
    s_waitcnt lgkmcnt(2)
    v_mfma_f32_32x32x16_bf16 a[0:15], v[108:111], v[104:107], a[0:15]
    s_waitcnt lgkmcnt(0)
    v_mfma_f32_32x32x16_bf16 a[0:15], v[116:119], v[112:115], a[0:15]
    s_waitcnt vmcnt(8)
    ds_write_b128 v12, v[24:27] offset:0
    ds_write_b128 v12, v[28:31] offset:4608
    ds_write_b128 v13, v[32:35] offset:0
    ds_write_b128 v13, v[36:39] offset:4608
    s_waitcnt lgkmcnt(0)
    s_barrier
    ds_read_b128 v[88:91], v14 offset:0
    ds_read_b128 v[92:95], v15 offset:0
    ds_read_b128 v[96:99], v14 offset:32
    ds_read_b128 v[100:103], v15 offset:32
    ds_read_b128 v[104:107], v14 offset:64
    ds_read_b128 v[108:111], v15 offset:64
    ds_read_b128 v[112:115], v14 offset:96
    ds_read_b128 v[116:119], v15 offset:96
    s_waitcnt lgkmcnt(6)
    v_mfma_f32_32x32x16_bf16 a[0:15], v[92:95], v[88:91], a[0:15]
    s_waitcnt lgkmcnt(4)
    v_mfma_f32_32x32x16_bf16 a[0:15], v[100:103], v[96:99], a[0:15]
    s_waitcnt lgkmcnt(2)
    v_mfma_f32_32x32x16_bf16 a[0:15], v[108:111], v[104:107], a[0:15]
    s_waitcnt lgkmcnt(0)
    v_mfma_f32_32x32x16_bf16 a[0:15], v[116:119], v[112:115], a[0:15]
    s_waitcnt vmcnt(4)
    ds_write_b128 v16, v[40:43] offset:0
    ds_write_b128 v16, v[44:47] offset:4608
    ds_write_b128 v17, v[48:51] offset:0
    ds_write_b128 v17, v[52:55] offset:4608
    s_waitcnt lgkmcnt(0)
    s_barrier
    ds_read_b128 v[88:91], v18 offset:0
    ds_read_b128 v[92:95], v19 offset:0
    ds_read_b128 v[96:99], v18 offset:32
    ds_read_b128 v[100:103], v19 offset:32
    ds_read_b128 v[104:107], v18 offset:64
    ds_read_b128 v[108:111], v19 offset:64
    ds_read_b128 v[112:115], v18 offset:96
    ds_read_b128 v[116:119], v19 offset:96
    s_waitcnt lgkmcnt(6)
    v_mfma_f32_32x32x16_bf16 a[0:15], v[92:95], v[88:91], a[0:15]
    s_waitcnt lgkmcnt(4)
    v_mfma_f32_32x32x16_bf16 a[0:15], v[100:103], v[96:99], a[0:15]
    s_waitcnt lgkmcnt(2)
    v_mfma_f32_32x32x16_bf16 a[0:15], v[108:111], v[104:107], a[0:15]
    s_waitcnt lgkmcnt(0)
    v_mfma_f32_32x32x16_bf16 a[0:15], v[116:119], v[112:115], a[0:15]
    s_waitcnt vmcnt(0)
    ds_write_b128 v12, v[56:59] offset:0
    ds_write_b128 v12, v[60:63] offset:4608
    ds_write_b128 v13, v[64:67] offset:0
    ds_write_b128 v13, v[68:71] offset:4608
    s_waitcnt lgkmcnt(0)
    s_barrier
    ds_read_b128 v[88:91], v14 offset:0
    ds_read_b128 v[92:95], v15 offset:0
    ds_read_b128 v[96:99], v14 offset:32
    ds_read_b128 v[100:103], v15 offset:32
    ds_read_b128 v[104:107], v14 offset:64
    ds_read_b128 v[108:111], v15 offset:64
    ds_read_b128 v[112:115], v14 offset:96
    ds_read_b128 v[116:119], v15 offset:96
    s_waitcnt lgkmcnt(6)
    v_mfma_f32_32x32x16_bf16 a[0:15], v[92:95], v[88:91], a[0:15]
    s_waitcnt lgkmcnt(4)
    v_mfma_f32_32x32x16_bf16 a[0:15], v[100:103], v[96:99], a[0:15]
    s_waitcnt lgkmcnt(2)
    v_mfma_f32_32x32x16_bf16 a[0:15], v[108:111], v[104:107], a[0:15]
    s_waitcnt lgkmcnt(0)
    v_mfma_f32_32x32x16_bf16 a[0:15], v[116:119], v[112:115], a[0:15]
    s_nop 15
    v_and_b32 v4, 31, v1
    v_lshrrev_b32 v5, 5, v1
    s_mul_i32 s31, s25, 32
    s_add_u32 s31, s31, s27
    v_add_u32 v4, s31, v4
    s_mul_i32 s36, s26, 32
    s_add_u32 s36, s36, s28
    v_lshlrev_b32 v5, 2, v5
    v_add_u32 v5, s36, v5
    s_mov_b32 s37, 3584
    v_mul_lo_u32 v6, v4, s37
    v_lshl_add_u32 v6, v5, 1, v6
    v_lshlrev_b32 v7, 1, v5
    global_load_dwordx2 v[28:29], v7, s[12:13] offset:0
    v_accvgpr_read_b32 v24, a0
    v_accvgpr_read_b32 v25, a1
    v_accvgpr_read_b32 v26, a2
    v_accvgpr_read_b32 v27, a3
    v_cvt_pk_bf16_f32 v36, v24, v25
    v_lshlrev_b32 v24, 16, v36
    v_and_b32 v25, 0xffff0000, v36
    v_cvt_pk_bf16_f32 v36, v26, v27
    v_lshlrev_b32 v26, 16, v36
    v_and_b32 v27, 0xffff0000, v36
    s_waitcnt vmcnt(0)
    v_lshlrev_b32 v36, 16, v28
    v_and_b32 v37, 0xffff0000, v28
    v_add_f32 v24, v24, v36
    v_add_f32 v25, v25, v37
    v_lshlrev_b32 v36, 16, v29
    v_and_b32 v37, 0xffff0000, v29
    v_add_f32 v26, v26, v36
    v_add_f32 v27, v27, v37
    v_cvt_pk_bf16_f32 v36, v24, v25
    v_lshlrev_b32 v24, 16, v36
    v_and_b32 v25, 0xffff0000, v36
    v_cvt_pk_bf16_f32 v36, v26, v27
    v_lshlrev_b32 v26, 16, v36
    v_and_b32 v27, 0xffff0000, v36
    v_mul_f32 v36, v24, v24
    v_mov_b32 v37, 0x3d372713
    v_fma_f32 v36, v36, v37, 1.0
    v_mul_f32 v36, v36, v24
    v_mul_f32 v36, 0xc0135761, v36
    v_exp_f32 v36, v36
    s_nop 0
    v_add_f32 v36, 1.0, v36
    v_rcp_f32 v36, v36
    s_nop 0
    v_mul_f32 v24, v24, v36
    v_mul_f32 v36, v25, v25
    v_mov_b32 v37, 0x3d372713
    v_fma_f32 v36, v36, v37, 1.0
    v_mul_f32 v36, v36, v25
    v_mul_f32 v36, 0xc0135761, v36
    v_exp_f32 v36, v36
    s_nop 0
    v_add_f32 v36, 1.0, v36
    v_rcp_f32 v36, v36
    s_nop 0
    v_mul_f32 v25, v25, v36
    v_mul_f32 v36, v26, v26
    v_mov_b32 v37, 0x3d372713
    v_fma_f32 v36, v36, v37, 1.0
    v_mul_f32 v36, v36, v26
    v_mul_f32 v36, 0xc0135761, v36
    v_exp_f32 v36, v36
    s_nop 0
    v_add_f32 v36, 1.0, v36
    v_rcp_f32 v36, v36
    s_nop 0
    v_mul_f32 v26, v26, v36
    v_mul_f32 v36, v27, v27
    v_mov_b32 v37, 0x3d372713
    v_fma_f32 v36, v36, v37, 1.0
    v_mul_f32 v36, v36, v27
    v_mul_f32 v36, 0xc0135761, v36
    v_exp_f32 v36, v36
    s_nop 0
    v_add_f32 v36, 1.0, v36
    v_rcp_f32 v36, v36
    s_nop 0
    v_mul_f32 v27, v27, v36
    v_cvt_pk_bf16_f32 v38, v24, v25
    v_cvt_pk_bf16_f32 v39, v26, v27
    global_store_dwordx2 v6, v[38:39], s[10:11] offset:0 sc1
    global_load_dwordx2 v[44:45], v7, s[12:13] offset:16
    v_accvgpr_read_b32 v40, a4
    v_accvgpr_read_b32 v41, a5
    v_accvgpr_read_b32 v42, a6
    v_accvgpr_read_b32 v43, a7
    v_cvt_pk_bf16_f32 v52, v40, v41
    v_lshlrev_b32 v40, 16, v52
    v_and_b32 v41, 0xffff0000, v52
    v_cvt_pk_bf16_f32 v52, v42, v43
    v_lshlrev_b32 v42, 16, v52
    v_and_b32 v43, 0xffff0000, v52
    s_waitcnt vmcnt(0)
    v_lshlrev_b32 v52, 16, v44
    v_and_b32 v53, 0xffff0000, v44
    v_add_f32 v40, v40, v52
    v_add_f32 v41, v41, v53
    v_lshlrev_b32 v52, 16, v45
    v_and_b32 v53, 0xffff0000, v45
    v_add_f32 v42, v42, v52
    v_add_f32 v43, v43, v53
    v_cvt_pk_bf16_f32 v52, v40, v41
    v_lshlrev_b32 v40, 16, v52
    v_and_b32 v41, 0xffff0000, v52
    v_cvt_pk_bf16_f32 v52, v42, v43
    v_lshlrev_b32 v42, 16, v52
    v_and_b32 v43, 0xffff0000, v52
    v_mul_f32 v52, v40, v40
    v_mov_b32 v53, 0x3d372713
    v_fma_f32 v52, v52, v53, 1.0
    v_mul_f32 v52, v52, v40
    v_mul_f32 v52, 0xc0135761, v52
    v_exp_f32 v52, v52
    s_nop 0
    v_add_f32 v52, 1.0, v52
    v_rcp_f32 v52, v52
    s_nop 0
    v_mul_f32 v40, v40, v52
    v_mul_f32 v52, v41, v41
    v_mov_b32 v53, 0x3d372713
    v_fma_f32 v52, v52, v53, 1.0
    v_mul_f32 v52, v52, v41
    v_mul_f32 v52, 0xc0135761, v52
    v_exp_f32 v52, v52
    s_nop 0
    v_add_f32 v52, 1.0, v52
    v_rcp_f32 v52, v52
    s_nop 0
    v_mul_f32 v41, v41, v52
    v_mul_f32 v52, v42, v42
    v_mov_b32 v53, 0x3d372713
    v_fma_f32 v52, v52, v53, 1.0
    v_mul_f32 v52, v52, v42
    v_mul_f32 v52, 0xc0135761, v52
    v_exp_f32 v52, v52
    s_nop 0
    v_add_f32 v52, 1.0, v52
    v_rcp_f32 v52, v52
    s_nop 0
    v_mul_f32 v42, v42, v52
    v_mul_f32 v52, v43, v43
    v_mov_b32 v53, 0x3d372713
    v_fma_f32 v52, v52, v53, 1.0
    v_mul_f32 v52, v52, v43
    v_mul_f32 v52, 0xc0135761, v52
    v_exp_f32 v52, v52
    s_nop 0
    v_add_f32 v52, 1.0, v52
    v_rcp_f32 v52, v52
    s_nop 0
    v_mul_f32 v43, v43, v52
    v_cvt_pk_bf16_f32 v54, v40, v41
    v_cvt_pk_bf16_f32 v55, v42, v43
    global_store_dwordx2 v6, v[54:55], s[10:11] offset:16 sc1
    global_load_dwordx2 v[60:61], v7, s[12:13] offset:32
    v_accvgpr_read_b32 v56, a8
    v_accvgpr_read_b32 v57, a9
    v_accvgpr_read_b32 v58, a10
    v_accvgpr_read_b32 v59, a11
    v_cvt_pk_bf16_f32 v68, v56, v57
    v_lshlrev_b32 v56, 16, v68
    v_and_b32 v57, 0xffff0000, v68
    v_cvt_pk_bf16_f32 v68, v58, v59
    v_lshlrev_b32 v58, 16, v68
    v_and_b32 v59, 0xffff0000, v68
    s_waitcnt vmcnt(0)
    v_lshlrev_b32 v68, 16, v60
    v_and_b32 v69, 0xffff0000, v60
    v_add_f32 v56, v56, v68
    v_add_f32 v57, v57, v69
    v_lshlrev_b32 v68, 16, v61
    v_and_b32 v69, 0xffff0000, v61
    v_add_f32 v58, v58, v68
    v_add_f32 v59, v59, v69
    v_cvt_pk_bf16_f32 v68, v56, v57
    v_lshlrev_b32 v56, 16, v68
    v_and_b32 v57, 0xffff0000, v68
    v_cvt_pk_bf16_f32 v68, v58, v59
    v_lshlrev_b32 v58, 16, v68
    v_and_b32 v59, 0xffff0000, v68
    v_mul_f32 v68, v56, v56
    v_mov_b32 v69, 0x3d372713
    v_fma_f32 v68, v68, v69, 1.0
    v_mul_f32 v68, v68, v56
    v_mul_f32 v68, 0xc0135761, v68
    v_exp_f32 v68, v68
    s_nop 0
    v_add_f32 v68, 1.0, v68
    v_rcp_f32 v68, v68
    s_nop 0
    v_mul_f32 v56, v56, v68
    v_mul_f32 v68, v57, v57
    v_mov_b32 v69, 0x3d372713
    v_fma_f32 v68, v68, v69, 1.0
    v_mul_f32 v68, v68, v57
    v_mul_f32 v68, 0xc0135761, v68
    v_exp_f32 v68, v68
    s_nop 0
    v_add_f32 v68, 1.0, v68
    v_rcp_f32 v68, v68
    s_nop 0
    v_mul_f32 v57, v57, v68
    v_mul_f32 v68, v58, v58
    v_mov_b32 v69, 0x3d372713
    v_fma_f32 v68, v68, v69, 1.0
    v_mul_f32 v68, v68, v58
    v_mul_f32 v68, 0xc0135761, v68
    v_exp_f32 v68, v68
    s_nop 0
    v_add_f32 v68, 1.0, v68
    v_rcp_f32 v68, v68
    s_nop 0
    v_mul_f32 v58, v58, v68
    v_mul_f32 v68, v59, v59
    v_mov_b32 v69, 0x3d372713
    v_fma_f32 v68, v68, v69, 1.0
    v_mul_f32 v68, v68, v59
    v_mul_f32 v68, 0xc0135761, v68
    v_exp_f32 v68, v68
    s_nop 0
    v_add_f32 v68, 1.0, v68
    v_rcp_f32 v68, v68
    s_nop 0
    v_mul_f32 v59, v59, v68
    v_cvt_pk_bf16_f32 v70, v56, v57
    v_cvt_pk_bf16_f32 v71, v58, v59
    global_store_dwordx2 v6, v[70:71], s[10:11] offset:32 sc1
    global_load_dwordx2 v[76:77], v7, s[12:13] offset:48
    v_accvgpr_read_b32 v72, a12
    v_accvgpr_read_b32 v73, a13
    v_accvgpr_read_b32 v74, a14
    v_accvgpr_read_b32 v75, a15
    v_cvt_pk_bf16_f32 v84, v72, v73
    v_lshlrev_b32 v72, 16, v84
    v_and_b32 v73, 0xffff0000, v84
    v_cvt_pk_bf16_f32 v84, v74, v75
    v_lshlrev_b32 v74, 16, v84
    v_and_b32 v75, 0xffff0000, v84
    s_waitcnt vmcnt(0)
    v_lshlrev_b32 v84, 16, v76
    v_and_b32 v85, 0xffff0000, v76
    v_add_f32 v72, v72, v84
    v_add_f32 v73, v73, v85
    v_lshlrev_b32 v84, 16, v77
    v_and_b32 v85, 0xffff0000, v77
    v_add_f32 v74, v74, v84
    v_add_f32 v75, v75, v85
    v_cvt_pk_bf16_f32 v84, v72, v73
    v_lshlrev_b32 v72, 16, v84
    v_and_b32 v73, 0xffff0000, v84
    v_cvt_pk_bf16_f32 v84, v74, v75
    v_lshlrev_b32 v74, 16, v84
    v_and_b32 v75, 0xffff0000, v84
    v_mul_f32 v84, v72, v72
    v_mov_b32 v85, 0x3d372713
    v_fma_f32 v84, v84, v85, 1.0
    v_mul_f32 v84, v84, v72
    v_mul_f32 v84, 0xc0135761, v84
    v_exp_f32 v84, v84
    s_nop 0
    v_add_f32 v84, 1.0, v84
    v_rcp_f32 v84, v84
    s_nop 0
    v_mul_f32 v72, v72, v84
    v_mul_f32 v84, v73, v73
    v_mov_b32 v85, 0x3d372713
    v_fma_f32 v84, v84, v85, 1.0
    v_mul_f32 v84, v84, v73
    v_mul_f32 v84, 0xc0135761, v84
    v_exp_f32 v84, v84
    s_nop 0
    v_add_f32 v84, 1.0, v84
    v_rcp_f32 v84, v84
    s_nop 0
    v_mul_f32 v73, v73, v84
    v_mul_f32 v84, v74, v74
    v_mov_b32 v85, 0x3d372713
    v_fma_f32 v84, v84, v85, 1.0
    v_mul_f32 v84, v84, v74
    v_mul_f32 v84, 0xc0135761, v84
    v_exp_f32 v84, v84
    s_nop 0
    v_add_f32 v84, 1.0, v84
    v_rcp_f32 v84, v84
    s_nop 0
    v_mul_f32 v74, v74, v84
    v_mul_f32 v84, v75, v75
    v_mov_b32 v85, 0x3d372713
    v_fma_f32 v84, v84, v85, 1.0
    v_mul_f32 v84, v84, v75
    v_mul_f32 v84, 0xc0135761, v84
    v_exp_f32 v84, v84
    s_nop 0
    v_add_f32 v84, 1.0, v84
    v_rcp_f32 v84, v84
    s_nop 0
    v_mul_f32 v75, v75, v84
    v_cvt_pk_bf16_f32 v86, v72, v73
    v_cvt_pk_bf16_f32 v87, v74, v75
    global_store_dwordx2 v6, v[86:87], s[10:11] offset:48 sc1
    s_waitcnt vmcnt(0)
    s_lshl_b32 s22, s22, 6
    s_waitcnt vmcnt(0)
    s_barrier
    s_add_u32 s94, s4, 0x6bd3c00
    s_addc_u32 s95, s5, 0
    v_mov_b32 v2, s22
    v_mov_b32 v3, 1
    v_cmp_eq_u32 vcc, 0, v0
    s_and_saveexec_b64 s[88:89], vcc
    s_cbranch_execz sg_f1_8
    global_atomic_add v2, v3, s[94:95] sc1
sg_f1_8:
    s_mov_b64 exec, s[88:89]
end_f1_1:
    s_barrier
    s_add_u32 s90, s90, 96
    s_cmp_lt_u32 s90, 896
    s_cbranch_scc1 wl_chain_39
sk_chain_40:
    s_cmp_ge_u32 s91, 112
    s_cbranch_scc1 sk_chain_42
    s_mul_i32 s90, s91, 293
    s_lshr_b32 s90, s90, 11
    s_mul_i32 s87, s90, 7
    s_sub_u32 s87, s91, s87
wl_chain_41:
    s_mul_i32 s86, s90, 37
    s_lshr_b32 s86, s86, 8
    s_mul_i32 s85, s86, 7
    s_sub_u32 s84, s90, s85
    s_add_u32 s85, s85, s87
    s_cmp_ge_u32 s85, 32
    s_cbranch_scc1 sk_chain_42
    s_mul_i32 s2, s85, 7
    s_add_u32 s2, s2, s84
    s_cmp_ge_u32 s2, 224
    s_cbranch_scc1 end_f2_1
    s_load_dwordx2 s[4:5], s[0:1], 128
    s_load_dwordx2 s[10:11], s[0:1], 112
    s_load_dwordx2 s[12:13], s[0:1], 88
    s_mov_b32 s20, 0
    s_mov_b32 s21, s2
    s_mul_i32 s22, s21, 293
    s_lshr_b32 s22, s22, 11
    s_mul_i32 s23, s22, 7
    s_sub_u32 s23, s21, s23
    v_and_b32 v1, 63, v0
    v_lshrrev_b32 v2, 6, v0
    s_nop 0
    v_readfirstlane_b32 s24, v2
    s_waitcnt lgkmcnt(0)
    s_add_u32 s6, s4, 0x6fd5000
    s_addc_u32 s7, s5, 0
    s_add_u32 s8, s4, 0x6cb000
    s_addc_u32 s9, s5, 0
    s_mul_i32 s42, s23, 229376
    v_and_b32 v2, 63, v0
    v_lshlrev_b32 v2, 7, v2
    s_mul_i32 s93, s24, 57344
    s_add_u32 s93, s93, s42
    v_add_u32 v2, s93, v2
    global_load_dword v255, v2, s[8:9]
    v_add_u32 v2, 8192, v2
    global_load_dword v255, v2, s[8:9]
    v_add_u32 v2, 8192, v2
    global_load_dword v255, v2, s[8:9]
    v_add_u32 v2, 8192, v2
    global_load_dword v255, v2, s[8:9]
    v_add_u32 v2, 8192, v2
    global_load_dword v255, v2, s[8:9]
    v_add_u32 v2, 8192, v2
    global_load_dword v255, v2, s[8:9]
    v_add_u32 v2, 8192, v2
    global_load_dword v255, v2, s[8:9]
    s_lshr_b32 s41, s22, 0
    s_lshl_b32 s41, s41, 6
    s_cmp_lg_u32 s24, 0
    s_cbranch_scc1 wo_f2_7
    s_add_u32 s94, s4, 0x6bd3c00
    s_addc_u32 s95, s5, 0
    v_mov_b32 v2, s41
wc_f2_5:
    global_load_dword v3, v2, s[94:95] sc1
    s_add_u32 s92, s92, 1
    s_cmp_gt_u32 s92, 524288
    s_cbranch_scc1 wd_f2_6
    s_waitcnt vmcnt(0)
    v_cmp_gt_u32 vcc, 28, v3
    s_nop 1
    s_cbranch_vccz wd_f2_6
    s_sleep 2
    s_branch wc_f2_5
wd_f2_6:
    buffer_inv sc1
    s_waitcnt vmcnt(0)
wo_f2_7:
    s_barrier
    s_mul_i32 s42, s22, 229376
    s_mul_i32 s43, s23, 32768
    s_add_u32 s42, s42, s43
    v_and_b32 v2, 63, v0
    v_lshlrev_b32 v2, 7, v2
    s_mul_i32 s93, s24, 8192
    s_add_u32 s93, s93, s42
    v_add_u32 v2, s93, v2
    global_load_dword v255, v2, s[6:7]
    s_lshr_b32 s25, s24, 1
    s_and_b32 s26, s24, 1
    v_lshrrev_b32 v2, 4, v0
    v_and_b32 v3, 15, v0
    v_lshlrev_b32 v3, 4, v3
    s_mul_i32 s27, s22, 64
    s_mul_i32 s28, s23, 64
    s_mov_b32 s29, 3584
    s_mov_b32 s30, 3584
    v_add_u32 v4, s27, v2
    v_mul_lo_u32 v4, v4, s29
    v_add_u32 v8, v4, v3
    v_add_u32 v9, 57344, v8
    v_add_u32 v10, 57344, v9
    v_add_u32 v11, 57344, v10
    v_add_u32 v4, s28, v2
    v_mul_lo_u32 v4, v4, s30
    v_add_u32 v12, v4, v3
    v_add_u32 v13, 57344, v12
    v_add_u32 v14, 57344, v13
    v_add_u32 v15, 57344, v14
    v_mul_u32_u24 v4, 272, v2
    v_add_u32 v16, v4, v3
    v_add_u32 v17, 17408, v16
    v_and_b32 v4, 31, v1
    v_lshrrev_b32 v5, 5, v1
    v_lshlrev_b32 v5, 4, v5
    s_mul_i32 s31, s25, 32
    v_add_u32 v6, s31, v4
    v_mul_u32_u24 v6, 272, v6
    v_add_u32 v18, v6, v5
    s_mul_i32 s31, s26, 32
    v_add_u32 v6, s31, v4
    v_mul_u32_u24 v6, 272, v6
    v_add_u32 v6, v6, v5
    v_add_u32 v19, 17408, v6
    v_accvgpr_write_b32 a0, 0
    v_accvgpr_write_b32 a1, 0
    v_accvgpr_write_b32 a2, 0
    v_accvgpr_write_b32 a3, 0
    v_accvgpr_write_b32 a4, 0
    v_accvgpr_write_b32 a5, 0
    v_accvgpr_write_b32 a6, 0
    v_accvgpr_write_b32 a7, 0
    v_accvgpr_write_b32 a8, 0
    v_accvgpr_write_b32 a9, 0
    v_accvgpr_write_b32 a10, 0
    v_accvgpr_write_b32 a11, 0
    v_accvgpr_write_b32 a12, 0
    v_accvgpr_write_b32 a13, 0
    v_accvgpr_write_b32 a14, 0
    v_accvgpr_write_b32 a15, 0
    v_add_u32 v22, 34816, v18
    v_add_u32 v23, 34816, v19
    v_add_u32 v20, 34816, v16
    v_add_u32 v21, 34816, v17
    global_load_dwordx4 v[28:31], v8, s[6:7]
    global_load_dwordx4 v[32:35], v9, s[6:7]
    global_load_dwordx4 v[36:39], v10, s[6:7]
    global_load_dwordx4 v[40:43], v11, s[6:7]
    global_load_dwordx4 v[44:47], v12, s[8:9]
    global_load_dwordx4 v[48:51], v13, s[8:9]
    global_load_dwordx4 v[52:55], v14, s[8:9]
    global_load_dwordx4 v[56:59], v15, s[8:9]
    s_add_u32 s6, s6, 256
    s_addc_u32 s7, s7, 0
    s_add_u32 s8, s8, 256
    s_addc_u32 s9, s9, 0
    global_load_dwordx4 v[60:63], v8, s[6:7]
    global_load_dwordx4 v[64:67], v9, s[6:7]
    global_load_dwordx4 v[68:71], v10, s[6:7]
    global_load_dwordx4 v[72:75], v11, s[6:7]
    global_load_dwordx4 v[76:79], v12, s[8:9]
    global_load_dwordx4 v[80:83], v13, s[8:9]
    global_load_dwordx4 v[84:87], v14, s[8:9]
    global_load_dwordx4 v[88:91], v15, s[8:9]
    s_add_u32 s6, s6, 256
    s_addc_u32 s7, s7, 0
    s_add_u32 s8, s8, 256
    s_addc_u32 s9, s9, 0
    global_load_dwordx4 v[92:95], v8, s[6:7]
    global_load_dwordx4 v[96:99], v9, s[6:7]
    global_load_dwordx4 v[100:103], v10, s[6:7]
    global_load_dwordx4 v[104:107], v11, s[6:7]
    global_load_dwordx4 v[108:111], v12, s[8:9]
    global_load_dwordx4 v[112:115], v13, s[8:9]
    global_load_dwordx4 v[116:119], v14, s[8:9]
    global_load_dwordx4 v[120:123], v15, s[8:9]
    s_add_u32 s6, s6, 256
    s_addc_u32 s7, s7, 0
    s_add_u32 s8, s8, 256
    s_addc_u32 s9, s9, 0
    s_waitcnt vmcnt(16)
    ds_write_b128 v16, v[28:31] offset:0
    ds_write_b128 v16, v[32:35] offset:4352
    ds_write_b128 v16, v[36:39] offset:8704
    ds_write_b128 v16, v[40:43] offset:13056
    ds_write_b128 v17, v[44:47] offset:0
    ds_write_b128 v17, v[48:51] offset:4352
    ds_write_b128 v17, v[52:55] offset:8704
    ds_write_b128 v17, v[56:59] offset:13056
    s_waitcnt lgkmcnt(0)
    s_barrier
    global_load_dwordx4 v[28:31], v8, s[6:7]
    global_load_dwordx4 v[32:35], v9, s[6:7]
    global_load_dwordx4 v[36:39], v10, s[6:7]
    global_load_dwordx4 v[40:43], v11, s[6:7]
    global_load_dwordx4 v[44:47], v12, s[8:9]
    global_load_dwordx4 v[48:51], v13, s[8:9]
    global_load_dwordx4 v[52:55], v14, s[8:9]
    global_load_dwordx4 v[56:59], v15, s[8:9]
    s_add_u32 s6, s6, 256
    s_addc_u32 s7, s7, 0
    s_add_u32 s8, s8, 256
    s_addc_u32 s9, s9, 0
    ds_read_b128 v[124:127], v18 offset:0
    ds_read_b128 v[128:131], v19 offset:0
    ds_read_b128 v[132:135], v18 offset:32
    ds_read_b128 v[136:139], v19 offset:32
    ds_read_b128 v[140:143], v18 offset:64
    ds_read_b128 v[144:147], v19 offset:64
    ds_read_b128 v[148:151], v18 offset:96
    ds_read_b128 v[152:155], v19 offset:96
    s_waitcnt lgkmcnt(6)
    v_mfma_f32_32x32x16_bf16 a[0:15], v[128:131], v[124:127], a[0:15]
    ds_read_b128 v[124:127], v18 offset:128
    ds_read_b128 v[128:131], v19 offset:128
    s_waitcnt lgkmcnt(6)
    v_mfma_f32_32x32x16_bf16 a[0:15], v[136:139], v[132:135], a[0:15]
    ds_read_b128 v[132:135], v18 offset:160
    ds_read_b128 v[136:139], v19 offset:160
    s_waitcnt lgkmcnt(6)
    v_mfma_f32_32x32x16_bf16 a[0:15], v[144:147], v[140:143], a[0:15]
    ds_read_b128 v[140:143], v18 offset:192
    ds_read_b128 v[144:147], v19 offset:192
    s_waitcnt lgkmcnt(6)
    v_mfma_f32_32x32x16_bf16 a[0:15], v[152:155], v[148:151], a[0:15]
    ds_read_b128 v[148:151], v18 offset:224
    ds_read_b128 v[152:155], v19 offset:224
    s_waitcnt lgkmcnt(6)
    v_mfma_f32_32x32x16_bf16 a[0:15], v[128:131], v[124:127], a[0:15]
    s_waitcnt lgkmcnt(4)
    v_mfma_f32_32x32x16_bf16 a[0:15], v[136:139], v[132:135], a[0:15]
    s_waitcnt lgkmcnt(2)
    v_mfma_f32_32x32x16_bf16 a[0:15], v[144:147], v[140:143], a[0:15]
    s_waitcnt lgkmcnt(0)
    v_mfma_f32_32x32x16_bf16 a[0:15], v[152:155], v[148:151], a[0:15]
    s_waitcnt vmcnt(16)
    ds_write_b128 v20, v[60:63] offset:0
    ds_write_b128 v20, v[64:67] offset:4352
    ds_write_b128 v20, v[68:71] offset:8704
    ds_write_b128 v20, v[72:75] offset:13056
    ds_write_b128 v21, v[76:79] offset:0
    ds_write_b128 v21, v[80:83] offset:4352
    ds_write_b128 v21, v[84:87] offset:8704
    ds_write_b128 v21, v[88:91] offset:13056
    s_waitcnt lgkmcnt(0)
    s_barrier
    global_load_dwordx4 v[60:63], v8, s[6:7]
    global_load_dwordx4 v[64:67], v9, s[6:7]
    global_load_dwordx4 v[68:71], v10, s[6:7]
    global_load_dwordx4 v[72:75], v11, s[6:7]
    global_load_dwordx4 v[76:79], v12, s[8:9]
    global_load_dwordx4 v[80:83], v13, s[8:9]
    global_load_dwordx4 v[84:87], v14, s[8:9]
    global_load_dwordx4 v[88:91], v15, s[8:9]
    s_add_u32 s6, s6, 256
    s_addc_u32 s7, s7, 0
    s_add_u32 s8, s8, 256
    s_addc_u32 s9, s9, 0
    ds_read_b128 v[124:127], v22 offset:0
    ds_read_b128 v[128:131], v23 offset:0
    ds_read_b128 v[132:135], v22 offset:32
    ds_read_b128 v[136:139], v23 offset:32
    ds_read_b128 v[140:143], v22 offset:64
    ds_read_b128 v[144:147], v23 offset:64
    ds_read_b128 v[148:151], v22 offset:96
    ds_read_b128 v[152:155], v23 offset:96
    s_waitcnt lgkmcnt(6)
    v_mfma_f32_32x32x16_bf16 a[0:15], v[128:131], v[124:127], a[0:15]
    ds_read_b128 v[124:127], v22 offset:128
    ds_read_b128 v[128:131], v23 offset:128
    s_waitcnt lgkmcnt(6)
    v_mfma_f32_32x32x16_bf16 a[0:15], v[136:139], v[132:135], a[0:15]
    ds_read_b128 v[132:135], v22 offset:160
    ds_read_b128 v[136:139], v23 offset:160
    s_waitcnt lgkmcnt(6)
    v_mfma_f32_32x32x16_bf16 a[0:15], v[144:147], v[140:143], a[0:15]
    ds_read_b128 v[140:143], v22 offset:192
    ds_read_b128 v[144:147], v23 offset:192
    s_waitcnt lgkmcnt(6)
    v_mfma_f32_32x32x16_bf16 a[0:15], v[152:155], v[148:151], a[0:15]
    ds_read_b128 v[148:151], v22 offset:224
    ds_read_b128 v[152:155], v23 offset:224
    s_waitcnt lgkmcnt(6)
    v_mfma_f32_32x32x16_bf16 a[0:15], v[128:131], v[124:127], a[0:15]
    s_waitcnt lgkmcnt(4)
    v_mfma_f32_32x32x16_bf16 a[0:15], v[136:139], v[132:135], a[0:15]
    s_waitcnt lgkmcnt(2)
    v_mfma_f32_32x32x16_bf16 a[0:15], v[144:147], v[140:143], a[0:15]
    s_waitcnt lgkmcnt(0)
    v_mfma_f32_32x32x16_bf16 a[0:15], v[152:155], v[148:151], a[0:15]
    s_waitcnt vmcnt(16)
    ds_write_b128 v16, v[92:95] offset:0
    ds_write_b128 v16, v[96:99] offset:4352
    ds_write_b128 v16, v[100:103] offset:8704
    ds_write_b128 v16, v[104:107] offset:13056
    ds_write_b128 v17, v[108:111] offset:0
    ds_write_b128 v17, v[112:115] offset:4352
    ds_write_b128 v17, v[116:119] offset:8704
    ds_write_b128 v17, v[120:123] offset:13056
    s_waitcnt lgkmcnt(0)
    s_barrier
    global_load_dwordx4 v[92:95], v8, s[6:7]
    global_load_dwordx4 v[96:99], v9, s[6:7]
    global_load_dwordx4 v[100:103], v10, s[6:7]
    global_load_dwordx4 v[104:107], v11, s[6:7]
    global_load_dwordx4 v[108:111], v12, s[8:9]
    global_load_dwordx4 v[112:115], v13, s[8:9]
    global_load_dwordx4 v[116:119], v14, s[8:9]
    global_load_dwordx4 v[120:123], v15, s[8:9]
    s_add_u32 s6, s6, 256
    s_addc_u32 s7, s7, 0
    s_add_u32 s8, s8, 256
    s_addc_u32 s9, s9, 0
    ds_read_b128 v[124:127], v18 offset:0
    ds_read_b128 v[128:131], v19 offset:0
    ds_read_b128 v[132:135], v18 offset:32
    ds_read_b128 v[136:139], v19 offset:32
    ds_read_b128 v[140:143], v18 offset:64
    ds_read_b128 v[144:147], v19 offset:64
    ds_read_b128 v[148:151], v18 offset:96
    ds_read_b128 v[152:155], v19 offset:96
    s_waitcnt lgkmcnt(6)
    v_mfma_f32_32x32x16_bf16 a[0:15], v[128:131], v[124:127], a[0:15]
    ds_read_b128 v[124:127], v18 offset:128
    ds_read_b128 v[128:131], v19 offset:128
    s_waitcnt lgkmcnt(6)
    v_mfma_f32_32x32x16_bf16 a[0:15], v[136:139], v[132:135], a[0:15]
    ds_read_b128 v[132:135], v18 offset:160
    ds_read_b128 v[136:139], v19 offset:160
    s_waitcnt lgkmcnt(6)
    v_mfma_f32_32x32x16_bf16 a[0:15], v[144:147], v[140:143], a[0:15]
    ds_read_b128 v[140:143], v18 offset:192
    ds_read_b128 v[144:147], v19 offset:192
    s_waitcnt lgkmcnt(6)
    v_mfma_f32_32x32x16_bf16 a[0:15], v[152:155], v[148:151], a[0:15]
    ds_read_b128 v[148:151], v18 offset:224
    ds_read_b128 v[152:155], v19 offset:224
    s_waitcnt lgkmcnt(6)
    v_mfma_f32_32x32x16_bf16 a[0:15], v[128:131], v[124:127], a[0:15]
    s_waitcnt lgkmcnt(4)
    v_mfma_f32_32x32x16_bf16 a[0:15], v[136:139], v[132:135], a[0:15]
    s_waitcnt lgkmcnt(2)
    v_mfma_f32_32x32x16_bf16 a[0:15], v[144:147], v[140:143], a[0:15]
    s_waitcnt lgkmcnt(0)
    v_mfma_f32_32x32x16_bf16 a[0:15], v[152:155], v[148:151], a[0:15]
    s_waitcnt vmcnt(16)
    ds_write_b128 v20, v[28:31] offset:0
    ds_write_b128 v20, v[32:35] offset:4352
    ds_write_b128 v20, v[36:39] offset:8704
    ds_write_b128 v20, v[40:43] offset:13056
    ds_write_b128 v21, v[44:47] offset:0
    ds_write_b128 v21, v[48:51] offset:4352
    ds_write_b128 v21, v[52:55] offset:8704
    ds_write_b128 v21, v[56:59] offset:13056
    s_waitcnt lgkmcnt(0)
    s_barrier
    global_load_dwordx4 v[28:31], v8, s[6:7]
    global_load_dwordx4 v[32:35], v9, s[6:7]
    global_load_dwordx4 v[36:39], v10, s[6:7]
    global_load_dwordx4 v[40:43], v11, s[6:7]
    global_load_dwordx4 v[44:47], v12, s[8:9]
    global_load_dwordx4 v[48:51], v13, s[8:9]
    global_load_dwordx4 v[52:55], v14, s[8:9]
    global_load_dwordx4 v[56:59], v15, s[8:9]
    s_add_u32 s6, s6, 256
    s_addc_u32 s7, s7, 0
    s_add_u32 s8, s8, 256
    s_addc_u32 s9, s9, 0
    ds_read_b128 v[124:127], v22 offset:0
    ds_read_b128 v[128:131], v23 offset:0
    ds_read_b128 v[132:135], v22 offset:32
    ds_read_b128 v[136:139], v23 offset:32
    ds_read_b128 v[140:143], v22 offset:64
    ds_read_b128 v[144:147], v23 offset:64
    ds_read_b128 v[148:151], v22 offset:96
    ds_read_b128 v[152:155], v23 offset:96
    s_waitcnt lgkmcnt(6)
    v_mfma_f32_32x32x16_bf16 a[0:15], v[128:131], v[124:127], a[0:15]
    ds_read_b128 v[124:127], v22 offset:128
    ds_read_b128 v[128:131], v23 offset:128
    s_waitcnt lgkmcnt(6)
    v_mfma_f32_32x32x16_bf16 a[0:15], v[136:139], v[132:135], a[0:15]
    ds_read_b128 v[132:135], v22 offset:160
    ds_read_b128 v[136:139], v23 offset:160
    s_waitcnt lgkmcnt(6)
    v_mfma_f32_32x32x16_bf16 a[0:15], v[144:147], v[140:143], a[0:15]
    ds_read_b128 v[140:143], v22 offset:192
    ds_read_b128 v[144:147], v23 offset:192
    s_waitcnt lgkmcnt(6)
    v_mfma_f32_32x32x16_bf16 a[0:15], v[152:155], v[148:151], a[0:15]
    ds_read_b128 v[148:151], v22 offset:224
    ds_read_b128 v[152:155], v23 offset:224
    s_waitcnt lgkmcnt(6)
    v_mfma_f32_32x32x16_bf16 a[0:15], v[128:131], v[124:127], a[0:15]
    s_waitcnt lgkmcnt(4)
    v_mfma_f32_32x32x16_bf16 a[0:15], v[136:139], v[132:135], a[0:15]
    s_waitcnt lgkmcnt(2)
    v_mfma_f32_32x32x16_bf16 a[0:15], v[144:147], v[140:143], a[0:15]
    s_waitcnt lgkmcnt(0)
    v_mfma_f32_32x32x16_bf16 a[0:15], v[152:155], v[148:151], a[0:15]
    s_waitcnt vmcnt(16)
    ds_write_b128 v16, v[60:63] offset:0
    ds_write_b128 v16, v[64:67] offset:4352
    ds_write_b128 v16, v[68:71] offset:8704
    ds_write_b128 v16, v[72:75] offset:13056
    ds_write_b128 v17, v[76:79] offset:0
    ds_write_b128 v17, v[80:83] offset:4352
    ds_write_b128 v17, v[84:87] offset:8704
    ds_write_b128 v17, v[88:91] offset:13056
    s_waitcnt lgkmcnt(0)
    s_barrier
    global_load_dwordx4 v[60:63], v8, s[6:7]
    global_load_dwordx4 v[64:67], v9, s[6:7]
    global_load_dwordx4 v[68:71], v10, s[6:7]
    global_load_dwordx4 v[72:75], v11, s[6:7]
    global_load_dwordx4 v[76:79], v12, s[8:9]
    global_load_dwordx4 v[80:83], v13, s[8:9]
    global_load_dwordx4 v[84:87], v14, s[8:9]
    global_load_dwordx4 v[88:91], v15, s[8:9]
    s_add_u32 s6, s6, 256
    s_addc_u32 s7, s7, 0
    s_add_u32 s8, s8, 256
    s_addc_u32 s9, s9, 0
    ds_read_b128 v[124:127], v18 offset:0
    ds_read_b128 v[128:131], v19 offset:0
    ds_read_b128 v[132:135], v18 offset:32
    ds_read_b128 v[136:139], v19 offset:32
    ds_read_b128 v[140:143], v18 offset:64
    ds_read_b128 v[144:147], v19 offset:64
    ds_read_b128 v[148:151], v18 offset:96
    ds_read_b128 v[152:155], v19 offset:96
    s_waitcnt lgkmcnt(6)
    v_mfma_f32_32x32x16_bf16 a[0:15], v[128:131], v[124:127], a[0:15]
    ds_read_b128 v[124:127], v18 offset:128
    ds_read_b128 v[128:131], v19 offset:128
    s_waitcnt lgkmcnt(6)
    v_mfma_f32_32x32x16_bf16 a[0:15], v[136:139], v[132:135], a[0:15]
    ds_read_b128 v[132:135], v18 offset:160
    ds_read_b128 v[136:139], v19 offset:160
    s_waitcnt lgkmcnt(6)
    v_mfma_f32_32x32x16_bf16 a[0:15], v[144:147], v[140:143], a[0:15]
    ds_read_b128 v[140:143], v18 offset:192
    ds_read_b128 v[144:147], v19 offset:192
    s_waitcnt lgkmcnt(6)
    v_mfma_f32_32x32x16_bf16 a[0:15], v[152:155], v[148:151], a[0:15]
    ds_read_b128 v[148:151], v18 offset:224
    ds_read_b128 v[152:155], v19 offset:224
    s_waitcnt lgkmcnt(6)
    v_mfma_f32_32x32x16_bf16 a[0:15], v[128:131], v[124:127], a[0:15]
    s_waitcnt lgkmcnt(4)
    v_mfma_f32_32x32x16_bf16 a[0:15], v[136:139], v[132:135], a[0:15]
    s_waitcnt lgkmcnt(2)
    v_mfma_f32_32x32x16_bf16 a[0:15], v[144:147], v[140:143], a[0:15]
    s_waitcnt lgkmcnt(0)
    v_mfma_f32_32x32x16_bf16 a[0:15], v[152:155], v[148:151], a[0:15]
    s_waitcnt vmcnt(16)
    ds_write_b128 v20, v[92:95] offset:0
    ds_write_b128 v20, v[96:99] offset:4352
    ds_write_b128 v20, v[100:103] offset:8704
    ds_write_b128 v20, v[104:107] offset:13056
    ds_write_b128 v21, v[108:111] offset:0
    ds_write_b128 v21, v[112:115] offset:4352
    ds_write_b128 v21, v[116:119] offset:8704
    ds_write_b128 v21, v[120:123] offset:13056
    s_waitcnt lgkmcnt(0)
    s_barrier
    global_load_dwordx4 v[92:95], v8, s[6:7]
    global_load_dwordx4 v[96:99], v9, s[6:7]
    global_load_dwordx4 v[100:103], v10, s[6:7]
    global_load_dwordx4 v[104:107], v11, s[6:7]
    global_load_dwordx4 v[108:111], v12, s[8:9]
    global_load_dwordx4 v[112:115], v13, s[8:9]
    global_load_dwordx4 v[116:119], v14, s[8:9]
    global_load_dwordx4 v[120:123], v15, s[8:9]
    s_add_u32 s6, s6, 256
    s_addc_u32 s7, s7, 0
    s_add_u32 s8, s8, 256
    s_addc_u32 s9, s9, 0
    ds_read_b128 v[124:127], v22 offset:0
    ds_read_b128 v[128:131], v23 offset:0
    ds_read_b128 v[132:135], v22 offset:32
    ds_read_b128 v[136:139], v23 offset:32
    ds_read_b128 v[140:143], v22 offset:64
    ds_read_b128 v[144:147], v23 offset:64
    ds_read_b128 v[148:151], v22 offset:96
    ds_read_b128 v[152:155], v23 offset:96
    s_waitcnt lgkmcnt(6)
    v_mfma_f32_32x32x16_bf16 a[0:15], v[128:131], v[124:127], a[0:15]
    ds_read_b128 v[124:127], v22 offset:128
    ds_read_b128 v[128:131], v23 offset:128
    s_waitcnt lgkmcnt(6)
    v_mfma_f32_32x32x16_bf16 a[0:15], v[136:139], v[132:135], a[0:15]
    ds_read_b128 v[132:135], v22 offset:160
    ds_read_b128 v[136:139], v23 offset:160
    s_waitcnt lgkmcnt(6)
    v_mfma_f32_32x32x16_bf16 a[0:15], v[144:147], v[140:143], a[0:15]
    ds_read_b128 v[140:143], v22 offset:192
    ds_read_b128 v[144:147], v23 offset:192
    s_waitcnt lgkmcnt(6)
    v_mfma_f32_32x32x16_bf16 a[0:15], v[152:155], v[148:151], a[0:15]
    ds_read_b128 v[148:151], v22 offset:224
    ds_read_b128 v[152:155], v23 offset:224
    s_waitcnt lgkmcnt(6)
    v_mfma_f32_32x32x16_bf16 a[0:15], v[128:131], v[124:127], a[0:15]
    s_waitcnt lgkmcnt(4)
    v_mfma_f32_32x32x16_bf16 a[0:15], v[136:139], v[132:135], a[0:15]
    s_waitcnt lgkmcnt(2)
    v_mfma_f32_32x32x16_bf16 a[0:15], v[144:147], v[140:143], a[0:15]
    s_waitcnt lgkmcnt(0)
    v_mfma_f32_32x32x16_bf16 a[0:15], v[152:155], v[148:151], a[0:15]
    s_waitcnt vmcnt(16)
    ds_write_b128 v16, v[28:31] offset:0
    ds_write_b128 v16, v[32:35] offset:4352
    ds_write_b128 v16, v[36:39] offset:8704
    ds_write_b128 v16, v[40:43] offset:13056
    ds_write_b128 v17, v[44:47] offset:0
    ds_write_b128 v17, v[48:51] offset:4352
    ds_write_b128 v17, v[52:55] offset:8704
    ds_write_b128 v17, v[56:59] offset:13056
    s_waitcnt lgkmcnt(0)
    s_barrier
    global_load_dwordx4 v[28:31], v8, s[6:7]
    global_load_dwordx4 v[32:35], v9, s[6:7]
    global_load_dwordx4 v[36:39], v10, s[6:7]
    global_load_dwordx4 v[40:43], v11, s[6:7]
    global_load_dwordx4 v[44:47], v12, s[8:9]
    global_load_dwordx4 v[48:51], v13, s[8:9]
    global_load_dwordx4 v[52:55], v14, s[8:9]
    global_load_dwordx4 v[56:59], v15, s[8:9]
    s_add_u32 s6, s6, 256
    s_addc_u32 s7, s7, 0
    s_add_u32 s8, s8, 256
    s_addc_u32 s9, s9, 0
    ds_read_b128 v[124:127], v18 offset:0
    ds_read_b128 v[128:131], v19 offset:0
    ds_read_b128 v[132:135], v18 offset:32
    ds_read_b128 v[136:139], v19 offset:32
    ds_read_b128 v[140:143], v18 offset:64
    ds_read_b128 v[144:147], v19 offset:64
    ds_read_b128 v[148:151], v18 offset:96
    ds_read_b128 v[152:155], v19 offset:96
    s_waitcnt lgkmcnt(6)
    v_mfma_f32_32x32x16_bf16 a[0:15], v[128:131], v[124:127], a[0:15]
    ds_read_b128 v[124:127], v18 offset:128
    ds_read_b128 v[128:131], v19 offset:128
    s_waitcnt lgkmcnt(6)
    v_mfma_f32_32x32x16_bf16 a[0:15], v[136:139], v[132:135], a[0:15]
    ds_read_b128 v[132:135], v18 offset:160
    ds_read_b128 v[136:139], v19 offset:160
    s_waitcnt lgkmcnt(6)
    v_mfma_f32_32x32x16_bf16 a[0:15], v[144:147], v[140:143], a[0:15]
    ds_read_b128 v[140:143], v18 offset:192
    ds_read_b128 v[144:147], v19 offset:192
    s_waitcnt lgkmcnt(6)
    v_mfma_f32_32x32x16_bf16 a[0:15], v[152:155], v[148:151], a[0:15]
    ds_read_b128 v[148:151], v18 offset:224
    ds_read_b128 v[152:155], v19 offset:224
    s_waitcnt lgkmcnt(6)
    v_mfma_f32_32x32x16_bf16 a[0:15], v[128:131], v[124:127], a[0:15]
    s_waitcnt lgkmcnt(4)
    v_mfma_f32_32x32x16_bf16 a[0:15], v[136:139], v[132:135], a[0:15]
    s_waitcnt lgkmcnt(2)
    v_mfma_f32_32x32x16_bf16 a[0:15], v[144:147], v[140:143], a[0:15]
    s_waitcnt lgkmcnt(0)
    v_mfma_f32_32x32x16_bf16 a[0:15], v[152:155], v[148:151], a[0:15]
    s_waitcnt vmcnt(16)
    ds_write_b128 v20, v[60:63] offset:0
    ds_write_b128 v20, v[64:67] offset:4352
    ds_write_b128 v20, v[68:71] offset:8704
    ds_write_b128 v20, v[72:75] offset:13056
    ds_write_b128 v21, v[76:79] offset:0
    ds_write_b128 v21, v[80:83] offset:4352
    ds_write_b128 v21, v[84:87] offset:8704
    ds_write_b128 v21, v[88:91] offset:13056
    s_waitcnt lgkmcnt(0)
    s_barrier
    global_load_dwordx4 v[60:63], v8, s[6:7]
    global_load_dwordx4 v[64:67], v9, s[6:7]
    global_load_dwordx4 v[68:71], v10, s[6:7]
    global_load_dwordx4 v[72:75], v11, s[6:7]
    global_load_dwordx4 v[76:79], v12, s[8:9]
    global_load_dwordx4 v[80:83], v13, s[8:9]
    global_load_dwordx4 v[84:87], v14, s[8:9]
    global_load_dwordx4 v[88:91], v15, s[8:9]
    s_add_u32 s6, s6, 256
    s_addc_u32 s7, s7, 0
    s_add_u32 s8, s8, 256
    s_addc_u32 s9, s9, 0
    ds_read_b128 v[124:127], v22 offset:0
    ds_read_b128 v[128:131], v23 offset:0
    ds_read_b128 v[132:135], v22 offset:32
    ds_read_b128 v[136:139], v23 offset:32
    ds_read_b128 v[140:143], v22 offset:64
    ds_read_b128 v[144:147], v23 offset:64
    ds_read_b128 v[148:151], v22 offset:96
    ds_read_b128 v[152:155], v23 offset:96
    s_waitcnt lgkmcnt(6)
    v_mfma_f32_32x32x16_bf16 a[0:15], v[128:131], v[124:127], a[0:15]
    ds_read_b128 v[124:127], v22 offset:128
    ds_read_b128 v[128:131], v23 offset:128
    s_waitcnt lgkmcnt(6)
    v_mfma_f32_32x32x16_bf16 a[0:15], v[136:139], v[132:135], a[0:15]
    ds_read_b128 v[132:135], v22 offset:160
    ds_read_b128 v[136:139], v23 offset:160
    s_waitcnt lgkmcnt(6)
    v_mfma_f32_32x32x16_bf16 a[0:15], v[144:147], v[140:143], a[0:15]
    ds_read_b128 v[140:143], v22 offset:192
    ds_read_b128 v[144:147], v23 offset:192
    s_waitcnt lgkmcnt(6)
    v_mfma_f32_32x32x16_bf16 a[0:15], v[152:155], v[148:151], a[0:15]
    ds_read_b128 v[148:151], v22 offset:224
    ds_read_b128 v[152:155], v23 offset:224
    s_waitcnt lgkmcnt(6)
    v_mfma_f32_32x32x16_bf16 a[0:15], v[128:131], v[124:127], a[0:15]
    s_waitcnt lgkmcnt(4)
    v_mfma_f32_32x32x16_bf16 a[0:15], v[136:139], v[132:135], a[0:15]
    s_waitcnt lgkmcnt(2)
    v_mfma_f32_32x32x16_bf16 a[0:15], v[144:147], v[140:143], a[0:15]
    s_waitcnt lgkmcnt(0)
    v_mfma_f32_32x32x16_bf16 a[0:15], v[152:155], v[148:151], a[0:15]
    s_waitcnt vmcnt(16)
    ds_write_b128 v16, v[92:95] offset:0
    ds_write_b128 v16, v[96:99] offset:4352
    ds_write_b128 v16, v[100:103] offset:8704
    ds_write_b128 v16, v[104:107] offset:13056
    ds_write_b128 v17, v[108:111] offset:0
    ds_write_b128 v17, v[112:115] offset:4352
    ds_write_b128 v17, v[116:119] offset:8704
    ds_write_b128 v17, v[120:123] offset:13056
    s_waitcnt lgkmcnt(0)
    s_barrier
    global_load_dwordx4 v[92:95], v8, s[6:7]
    global_load_dwordx4 v[96:99], v9, s[6:7]
    global_load_dwordx4 v[100:103], v10, s[6:7]
    global_load_dwordx4 v[104:107], v11, s[6:7]
    global_load_dwordx4 v[108:111], v12, s[8:9]
    global_load_dwordx4 v[112:115], v13, s[8:9]
    global_load_dwordx4 v[116:119], v14, s[8:9]
    global_load_dwordx4 v[120:123], v15, s[8:9]
    s_add_u32 s6, s6, 256
    s_addc_u32 s7, s7, 0
    s_add_u32 s8, s8, 256
    s_addc_u32 s9, s9, 0
    ds_read_b128 v[124:127], v18 offset:0
    ds_read_b128 v[128:131], v19 offset:0
    ds_read_b128 v[132:135], v18 offset:32
    ds_read_b128 v[136:139], v19 offset:32
    ds_read_b128 v[140:143], v18 offset:64
    ds_read_b128 v[144:147], v19 offset:64
    ds_read_b128 v[148:151], v18 offset:96
    ds_read_b128 v[152:155], v19 offset:96
    s_waitcnt lgkmcnt(6)
    v_mfma_f32_32x32x16_bf16 a[0:15], v[128:131], v[124:127], a[0:15]
    ds_read_b128 v[124:127], v18 offset:128
    ds_read_b128 v[128:131], v19 offset:128
    s_waitcnt lgkmcnt(6)
    v_mfma_f32_32x32x16_bf16 a[0:15], v[136:139], v[132:135], a[0:15]
    ds_read_b128 v[132:135], v18 offset:160
    ds_read_b128 v[136:139], v19 offset:160
    s_waitcnt lgkmcnt(6)
    v_mfma_f32_32x32x16_bf16 a[0:15], v[144:147], v[140:143], a[0:15]
    ds_read_b128 v[140:143], v18 offset:192
    ds_read_b128 v[144:147], v19 offset:192
    s_waitcnt lgkmcnt(6)
    v_mfma_f32_32x32x16_bf16 a[0:15], v[152:155], v[148:151], a[0:15]
    ds_read_b128 v[148:151], v18 offset:224
    ds_read_b128 v[152:155], v19 offset:224
    s_waitcnt lgkmcnt(6)
    v_mfma_f32_32x32x16_bf16 a[0:15], v[128:131], v[124:127], a[0:15]
    s_waitcnt lgkmcnt(4)
    v_mfma_f32_32x32x16_bf16 a[0:15], v[136:139], v[132:135], a[0:15]
    s_waitcnt lgkmcnt(2)
    v_mfma_f32_32x32x16_bf16 a[0:15], v[144:147], v[140:143], a[0:15]
    s_waitcnt lgkmcnt(0)
    v_mfma_f32_32x32x16_bf16 a[0:15], v[152:155], v[148:151], a[0:15]
    s_waitcnt vmcnt(16)
    ds_write_b128 v20, v[28:31] offset:0
    ds_write_b128 v20, v[32:35] offset:4352
    ds_write_b128 v20, v[36:39] offset:8704
    ds_write_b128 v20, v[40:43] offset:13056
    ds_write_b128 v21, v[44:47] offset:0
    ds_write_b128 v21, v[48:51] offset:4352
    ds_write_b128 v21, v[52:55] offset:8704
    ds_write_b128 v21, v[56:59] offset:13056
    s_waitcnt lgkmcnt(0)
    s_barrier
    global_load_dwordx4 v[28:31], v8, s[6:7]
    global_load_dwordx4 v[32:35], v9, s[6:7]
    global_load_dwordx4 v[36:39], v10, s[6:7]
    global_load_dwordx4 v[40:43], v11, s[6:7]
    global_load_dwordx4 v[44:47], v12, s[8:9]
    global_load_dwordx4 v[48:51], v13, s[8:9]
    global_load_dwordx4 v[52:55], v14, s[8:9]
    global_load_dwordx4 v[56:59], v15, s[8:9]
    s_add_u32 s6, s6, 256
    s_addc_u32 s7, s7, 0
    s_add_u32 s8, s8, 256
    s_addc_u32 s9, s9, 0
    ds_read_b128 v[124:127], v22 offset:0
    ds_read_b128 v[128:131], v23 offset:0
    ds_read_b128 v[132:135], v22 offset:32
    ds_read_b128 v[136:139], v23 offset:32
    ds_read_b128 v[140:143], v22 offset:64
    ds_read_b128 v[144:147], v23 offset:64
    ds_read_b128 v[148:151], v22 offset:96
    ds_read_b128 v[152:155], v23 offset:96
    s_waitcnt lgkmcnt(6)
    v_mfma_f32_32x32x16_bf16 a[0:15], v[128:131], v[124:127], a[0:15]
    ds_read_b128 v[124:127], v22 offset:128
    ds_read_b128 v[128:131], v23 offset:128
    s_waitcnt lgkmcnt(6)
    v_mfma_f32_32x32x16_bf16 a[0:15], v[136:139], v[132:135], a[0:15]
    ds_read_b128 v[132:135], v22 offset:160
    ds_read_b128 v[136:139], v23 offset:160
    s_waitcnt lgkmcnt(6)
    v_mfma_f32_32x32x16_bf16 a[0:15], v[144:147], v[140:143], a[0:15]
    ds_read_b128 v[140:143], v22 offset:192
    ds_read_b128 v[144:147], v23 offset:192
    s_waitcnt lgkmcnt(6)
    v_mfma_f32_32x32x16_bf16 a[0:15], v[152:155], v[148:151], a[0:15]
    ds_read_b128 v[148:151], v22 offset:224
    ds_read_b128 v[152:155], v23 offset:224
    s_waitcnt lgkmcnt(6)
    v_mfma_f32_32x32x16_bf16 a[0:15], v[128:131], v[124:127], a[0:15]
    s_waitcnt lgkmcnt(4)
    v_mfma_f32_32x32x16_bf16 a[0:15], v[136:139], v[132:135], a[0:15]
    s_waitcnt lgkmcnt(2)
    v_mfma_f32_32x32x16_bf16 a[0:15], v[144:147], v[140:143], a[0:15]
    s_waitcnt lgkmcnt(0)
    v_mfma_f32_32x32x16_bf16 a[0:15], v[152:155], v[148:151], a[0:15]
    s_waitcnt vmcnt(16)
    ds_write_b128 v16, v[60:63] offset:0
    ds_write_b128 v16, v[64:67] offset:4352
    ds_write_b128 v16, v[68:71] offset:8704
    ds_write_b128 v16, v[72:75] offset:13056
    ds_write_b128 v17, v[76:79] offset:0
    ds_write_b128 v17, v[80:83] offset:4352
    ds_write_b128 v17, v[84:87] offset:8704
    ds_write_b128 v17, v[88:91] offset:13056
    s_waitcnt lgkmcnt(0)
    s_barrier
    global_load_dwordx4 v[60:63], v8, s[6:7]
    global_load_dwordx4 v[64:67], v9, s[6:7]
    global_load_dwordx4 v[68:71], v10, s[6:7]
    global_load_dwordx4 v[72:75], v11, s[6:7]
    global_load_dwordx4 v[76:79], v12, s[8:9]
    global_load_dwordx4 v[80:83], v13, s[8:9]
    global_load_dwordx4 v[84:87], v14, s[8:9]
    global_load_dwordx4 v[88:91], v15, s[8:9]
    s_add_u32 s6, s6, 256
    s_addc_u32 s7, s7, 0
    s_add_u32 s8, s8, 256
    s_addc_u32 s9, s9, 0
    ds_read_b128 v[124:127], v18 offset:0
    ds_read_b128 v[128:131], v19 offset:0
    ds_read_b128 v[132:135], v18 offset:32
    ds_read_b128 v[136:139], v19 offset:32
    ds_read_b128 v[140:143], v18 offset:64
    ds_read_b128 v[144:147], v19 offset:64
    ds_read_b128 v[148:151], v18 offset:96
    ds_read_b128 v[152:155], v19 offset:96
    s_waitcnt lgkmcnt(6)
    v_mfma_f32_32x32x16_bf16 a[0:15], v[128:131], v[124:127], a[0:15]
    ds_read_b128 v[124:127], v18 offset:128
    ds_read_b128 v[128:131], v19 offset:128
    s_waitcnt lgkmcnt(6)
    v_mfma_f32_32x32x16_bf16 a[0:15], v[136:139], v[132:135], a[0:15]
    ds_read_b128 v[132:135], v18 offset:160
    ds_read_b128 v[136:139], v19 offset:160
    s_waitcnt lgkmcnt(6)
    v_mfma_f32_32x32x16_bf16 a[0:15], v[144:147], v[140:143], a[0:15]
    ds_read_b128 v[140:143], v18 offset:192
    ds_read_b128 v[144:147], v19 offset:192
    s_waitcnt lgkmcnt(6)
    v_mfma_f32_32x32x16_bf16 a[0:15], v[152:155], v[148:151], a[0:15]
    ds_read_b128 v[148:151], v18 offset:224
    ds_read_b128 v[152:155], v19 offset:224
    s_waitcnt lgkmcnt(6)
    v_mfma_f32_32x32x16_bf16 a[0:15], v[128:131], v[124:127], a[0:15]
    s_waitcnt lgkmcnt(4)
    v_mfma_f32_32x32x16_bf16 a[0:15], v[136:139], v[132:135], a[0:15]
    s_waitcnt lgkmcnt(2)
    v_mfma_f32_32x32x16_bf16 a[0:15], v[144:147], v[140:143], a[0:15]
    s_waitcnt lgkmcnt(0)
    v_mfma_f32_32x32x16_bf16 a[0:15], v[152:155], v[148:151], a[0:15]
    s_waitcnt vmcnt(16)
    ds_write_b128 v20, v[92:95] offset:0
    ds_write_b128 v20, v[96:99] offset:4352
    ds_write_b128 v20, v[100:103] offset:8704
    ds_write_b128 v20, v[104:107] offset:13056
    ds_write_b128 v21, v[108:111] offset:0
    ds_write_b128 v21, v[112:115] offset:4352
    ds_write_b128 v21, v[116:119] offset:8704
    ds_write_b128 v21, v[120:123] offset:13056
    s_waitcnt lgkmcnt(0)
    s_barrier
    ds_read_b128 v[124:127], v22 offset:0
    ds_read_b128 v[128:131], v23 offset:0
    ds_read_b128 v[132:135], v22 offset:32
    ds_read_b128 v[136:139], v23 offset:32
    ds_read_b128 v[140:143], v22 offset:64
    ds_read_b128 v[144:147], v23 offset:64
    ds_read_b128 v[148:151], v22 offset:96
    ds_read_b128 v[152:155], v23 offset:96
    s_waitcnt lgkmcnt(6)
    v_mfma_f32_32x32x16_bf16 a[0:15], v[128:131], v[124:127], a[0:15]
    ds_read_b128 v[124:127], v22 offset:128
    ds_read_b128 v[128:131], v23 offset:128
    s_waitcnt lgkmcnt(6)
    v_mfma_f32_32x32x16_bf16 a[0:15], v[136:139], v[132:135], a[0:15]
    ds_read_b128 v[132:135], v22 offset:160
    ds_read_b128 v[136:139], v23 offset:160
    s_waitcnt lgkmcnt(6)
    v_mfma_f32_32x32x16_bf16 a[0:15], v[144:147], v[140:143], a[0:15]
    ds_read_b128 v[140:143], v22 offset:192
    ds_read_b128 v[144:147], v23 offset:192
    s_waitcnt lgkmcnt(6)
    v_mfma_f32_32x32x16_bf16 a[0:15], v[152:155], v[148:151], a[0:15]
    ds_read_b128 v[148:151], v22 offset:224
    ds_read_b128 v[152:155], v23 offset:224
    s_waitcnt lgkmcnt(6)
    v_mfma_f32_32x32x16_bf16 a[0:15], v[128:131], v[124:127], a[0:15]
    s_waitcnt lgkmcnt(4)
    v_mfma_f32_32x32x16_bf16 a[0:15], v[136:139], v[132:135], a[0:15]
    s_waitcnt lgkmcnt(2)
    v_mfma_f32_32x32x16_bf16 a[0:15], v[144:147], v[140:143], a[0:15]
    s_waitcnt lgkmcnt(0)
    v_mfma_f32_32x32x16_bf16 a[0:15], v[152:155], v[148:151], a[0:15]
    s_waitcnt vmcnt(8)
    ds_write_b128 v16, v[28:31] offset:0
    ds_write_b128 v16, v[32:35] offset:4352
    ds_write_b128 v16, v[36:39] offset:8704
    ds_write_b128 v16, v[40:43] offset:13056
    ds_write_b128 v17, v[44:47] offset:0
    ds_write_b128 v17, v[48:51] offset:4352
    ds_write_b128 v17, v[52:55] offset:8704
    ds_write_b128 v17, v[56:59] offset:13056
    s_waitcnt lgkmcnt(0)
    s_barrier
    ds_read_b128 v[124:127], v18 offset:0
    ds_read_b128 v[128:131], v19 offset:0
    ds_read_b128 v[132:135], v18 offset:32
    ds_read_b128 v[136:139], v19 offset:32
    ds_read_b128 v[140:143], v18 offset:64
    ds_read_b128 v[144:147], v19 offset:64
    ds_read_b128 v[148:151], v18 offset:96
    ds_read_b128 v[152:155], v19 offset:96
    s_waitcnt lgkmcnt(6)
    v_mfma_f32_32x32x16_bf16 a[0:15], v[128:131], v[124:127], a[0:15]
    ds_read_b128 v[124:127], v18 offset:128
    ds_read_b128 v[128:131], v19 offset:128
    s_waitcnt lgkmcnt(6)
    v_mfma_f32_32x32x16_bf16 a[0:15], v[136:139], v[132:135], a[0:15]
    ds_read_b128 v[132:135], v18 offset:160
    ds_read_b128 v[136:139], v19 offset:160
    s_waitcnt lgkmcnt(6)
    v_mfma_f32_32x32x16_bf16 a[0:15], v[144:147], v[140:143], a[0:15]
    ds_read_b128 v[140:143], v18 offset:192
    ds_read_b128 v[144:147], v19 offset:192
    s_waitcnt lgkmcnt(6)
    v_mfma_f32_32x32x16_bf16 a[0:15], v[152:155], v[148:151], a[0:15]
    ds_read_b128 v[148:151], v18 offset:224
    ds_read_b128 v[152:155], v19 offset:224
    s_waitcnt lgkmcnt(6)
    v_mfma_f32_32x32x16_bf16 a[0:15], v[128:131], v[124:127], a[0:15]
    s_waitcnt lgkmcnt(4)
    v_mfma_f32_32x32x16_bf16 a[0:15], v[136:139], v[132:135], a[0:15]
    s_waitcnt lgkmcnt(2)
    v_mfma_f32_32x32x16_bf16 a[0:15], v[144:147], v[140:143], a[0:15]
    s_waitcnt lgkmcnt(0)
    v_mfma_f32_32x32x16_bf16 a[0:15], v[152:155], v[148:151], a[0:15]
    s_waitcnt vmcnt(0)
    ds_write_b128 v20, v[60:63] offset:0
    ds_write_b128 v20, v[64:67] offset:4352
    ds_write_b128 v20, v[68:71] offset:8704
    ds_write_b128 v20, v[72:75] offset:13056
    ds_write_b128 v21, v[76:79] offset:0
    ds_write_b128 v21, v[80:83] offset:4352
    ds_write_b128 v21, v[84:87] offset:8704
    ds_write_b128 v21, v[88:91] offset:13056
    s_waitcnt lgkmcnt(0)
    s_barrier
    ds_read_b128 v[124:127], v22 offset:0
    ds_read_b128 v[128:131], v23 offset:0
    ds_read_b128 v[132:135], v22 offset:32
    ds_read_b128 v[136:139], v23 offset:32
    ds_read_b128 v[140:143], v22 offset:64
    ds_read_b128 v[144:147], v23 offset:64
    ds_read_b128 v[148:151], v22 offset:96
    ds_read_b128 v[152:155], v23 offset:96
    s_waitcnt lgkmcnt(6)
    v_mfma_f32_32x32x16_bf16 a[0:15], v[128:131], v[124:127], a[0:15]
    ds_read_b128 v[124:127], v22 offset:128
    ds_read_b128 v[128:131], v23 offset:128
    s_waitcnt lgkmcnt(6)
    v_mfma_f32_32x32x16_bf16 a[0:15], v[136:139], v[132:135], a[0:15]
    ds_read_b128 v[132:135], v22 offset:160
    ds_read_b128 v[136:139], v23 offset:160
    s_waitcnt lgkmcnt(6)
    v_mfma_f32_32x32x16_bf16 a[0:15], v[144:147], v[140:143], a[0:15]
    ds_read_b128 v[140:143], v22 offset:192
    ds_read_b128 v[144:147], v23 offset:192
    s_waitcnt lgkmcnt(6)
    v_mfma_f32_32x32x16_bf16 a[0:15], v[152:155], v[148:151], a[0:15]
    ds_read_b128 v[148:151], v22 offset:224
    ds_read_b128 v[152:155], v23 offset:224
    s_waitcnt lgkmcnt(6)
    v_mfma_f32_32x32x16_bf16 a[0:15], v[128:131], v[124:127], a[0:15]
    s_waitcnt lgkmcnt(4)
    v_mfma_f32_32x32x16_bf16 a[0:15], v[136:139], v[132:135], a[0:15]
    s_waitcnt lgkmcnt(2)
    v_mfma_f32_32x32x16_bf16 a[0:15], v[144:147], v[140:143], a[0:15]
    s_waitcnt lgkmcnt(0)
    v_mfma_f32_32x32x16_bf16 a[0:15], v[152:155], v[148:151], a[0:15]
    s_nop 15
    v_and_b32 v4, 31, v1
    v_lshrrev_b32 v5, 5, v1
    s_mul_i32 s31, s25, 32
    s_add_u32 s31, s31, s27
    v_add_u32 v4, s31, v4
    s_mul_i32 s36, s26, 32
    s_add_u32 s36, s36, s28
    v_lshlrev_b32 v5, 2, v5
    v_add_u32 v5, s36, v5
    s_mov_b32 s37, 896
    v_mul_lo_u32 v6, v4, s37
    v_lshl_add_u32 v6, v5, 1, v6
    v_lshlrev_b32 v7, 1, v5
    s_add_u32 s14, s4, 0x2300
    s_addc_u32 s15, s5, 0
    s_add_u32 s16, s4, 0x6c55000
    s_addc_u32 s17, s5, 0
    v_lshlrev_b32 v2, 2, v5
    global_load_dwordx2 v[32:33], v7, s[12:13] offset:0
    global_load_dwordx4 v[36:39], v2, s[14:15] offset:0
    global_load_dwordx2 v[34:35], v6, s[16:17] offset:0
    v_accvgpr_read_b32 v28, a0
    v_accvgpr_read_b32 v29, a1
    v_accvgpr_read_b32 v30, a2
    v_accvgpr_read_b32 v31, a3
    v_cvt_pk_bf16_f32 v40, v28, v29
    v_lshlrev_b32 v28, 16, v40
    v_and_b32 v29, 0xffff0000, v40
    v_cvt_pk_bf16_f32 v40, v30, v31
    v_lshlrev_b32 v30, 16, v40
    v_and_b32 v31, 0xffff0000, v40
    s_waitcnt vmcnt(0)
    v_lshlrev_b32 v40, 16, v32
    v_and_b32 v41, 0xffff0000, v32
    v_add_f32 v28, v28, v40
    v_add_f32 v29, v29, v41
    v_lshlrev_b32 v40, 16, v33
    v_and_b32 v41, 0xffff0000, v33
    v_add_f32 v30, v30, v40
    v_add_f32 v31, v31, v41
    v_cvt_pk_bf16_f32 v40, v28, v29
    v_lshlrev_b32 v28, 16, v40
    v_and_b32 v29, 0xffff0000, v40
    v_cvt_pk_bf16_f32 v40, v30, v31
    v_lshlrev_b32 v30, 16, v40
    v_and_b32 v31, 0xffff0000, v40
    v_mul_f32 v28, v28, v36
    v_mul_f32 v29, v29, v37
    v_mul_f32 v30, v30, v38
    v_mul_f32 v31, v31, v39
    v_cvt_pk_bf16_f32 v40, v28, v29
    v_lshlrev_b32 v28, 16, v40
    v_and_b32 v29, 0xffff0000, v40
    v_cvt_pk_bf16_f32 v40, v30, v31
    v_lshlrev_b32 v30, 16, v40
    v_and_b32 v31, 0xffff0000, v40
    v_lshlrev_b32 v40, 16, v34
    v_and_b32 v41, 0xffff0000, v34
    v_add_f32 v28, v28, v40
    v_add_f32 v29, v29, v41
    v_lshlrev_b32 v40, 16, v35
    v_and_b32 v41, 0xffff0000, v35
    v_add_f32 v30, v30, v40
    v_add_f32 v31, v31, v41
    v_cvt_pk_bf16_f32 v42, v28, v29
    v_cvt_pk_bf16_f32 v43, v30, v31
    global_store_dwordx2 v6, v[42:43], s[10:11] offset:0
    global_load_dwordx2 v[48:49], v7, s[12:13] offset:16
    global_load_dwordx4 v[52:55], v2, s[14:15] offset:32
    global_load_dwordx2 v[50:51], v6, s[16:17] offset:16
    v_accvgpr_read_b32 v44, a4
    v_accvgpr_read_b32 v45, a5
    v_accvgpr_read_b32 v46, a6
    v_accvgpr_read_b32 v47, a7
    v_cvt_pk_bf16_f32 v56, v44, v45
    v_lshlrev_b32 v44, 16, v56
    v_and_b32 v45, 0xffff0000, v56
    v_cvt_pk_bf16_f32 v56, v46, v47
    v_lshlrev_b32 v46, 16, v56
    v_and_b32 v47, 0xffff0000, v56
    s_waitcnt vmcnt(0)
    v_lshlrev_b32 v56, 16, v48
    v_and_b32 v57, 0xffff0000, v48
    v_add_f32 v44, v44, v56
    v_add_f32 v45, v45, v57
    v_lshlrev_b32 v56, 16, v49
    v_and_b32 v57, 0xffff0000, v49
    v_add_f32 v46, v46, v56
    v_add_f32 v47, v47, v57
    v_cvt_pk_bf16_f32 v56, v44, v45
    v_lshlrev_b32 v44, 16, v56
    v_and_b32 v45, 0xffff0000, v56
    v_cvt_pk_bf16_f32 v56, v46, v47
    v_lshlrev_b32 v46, 16, v56
    v_and_b32 v47, 0xffff0000, v56
    v_mul_f32 v44, v44, v52
    v_mul_f32 v45, v45, v53
    v_mul_f32 v46, v46, v54
    v_mul_f32 v47, v47, v55
    v_cvt_pk_bf16_f32 v56, v44, v45
    v_lshlrev_b32 v44, 16, v56
    v_and_b32 v45, 0xffff0000, v56
    v_cvt_pk_bf16_f32 v56, v46, v47
    v_lshlrev_b32 v46, 16, v56
    v_and_b32 v47, 0xffff0000, v56
    v_lshlrev_b32 v56, 16, v50
    v_and_b32 v57, 0xffff0000, v50
    v_add_f32 v44, v44, v56
    v_add_f32 v45, v45, v57
    v_lshlrev_b32 v56, 16, v51
    v_and_b32 v57, 0xffff0000, v51
    v_add_f32 v46, v46, v56
    v_add_f32 v47, v47, v57
    v_cvt_pk_bf16_f32 v58, v44, v45
    v_cvt_pk_bf16_f32 v59, v46, v47
    global_store_dwordx2 v6, v[58:59], s[10:11] offset:16
    global_load_dwordx2 v[64:65], v7, s[12:13] offset:32
    global_load_dwordx4 v[68:71], v2, s[14:15] offset:64
    global_load_dwordx2 v[66:67], v6, s[16:17] offset:32
    v_accvgpr_read_b32 v60, a8
    v_accvgpr_read_b32 v61, a9
    v_accvgpr_read_b32 v62, a10
    v_accvgpr_read_b32 v63, a11
    v_cvt_pk_bf16_f32 v72, v60, v61
    v_lshlrev_b32 v60, 16, v72
    v_and_b32 v61, 0xffff0000, v72
    v_cvt_pk_bf16_f32 v72, v62, v63
    v_lshlrev_b32 v62, 16, v72
    v_and_b32 v63, 0xffff0000, v72
    s_waitcnt vmcnt(0)
    v_lshlrev_b32 v72, 16, v64
    v_and_b32 v73, 0xffff0000, v64
    v_add_f32 v60, v60, v72
    v_add_f32 v61, v61, v73
    v_lshlrev_b32 v72, 16, v65
    v_and_b32 v73, 0xffff0000, v65
    v_add_f32 v62, v62, v72
    v_add_f32 v63, v63, v73
    v_cvt_pk_bf16_f32 v72, v60, v61
    v_lshlrev_b32 v60, 16, v72
    v_and_b32 v61, 0xffff0000, v72
    v_cvt_pk_bf16_f32 v72, v62, v63
    v_lshlrev_b32 v62, 16, v72
    v_and_b32 v63, 0xffff0000, v72
    v_mul_f32 v60, v60, v68
    v_mul_f32 v61, v61, v69
    v_mul_f32 v62, v62, v70
    v_mul_f32 v63, v63, v71
    v_cvt_pk_bf16_f32 v72, v60, v61
    v_lshlrev_b32 v60, 16, v72
    v_and_b32 v61, 0xffff0000, v72
    v_cvt_pk_bf16_f32 v72, v62, v63
    v_lshlrev_b32 v62, 16, v72
    v_and_b32 v63, 0xffff0000, v72
    v_lshlrev_b32 v72, 16, v66
    v_and_b32 v73, 0xffff0000, v66
    v_add_f32 v60, v60, v72
    v_add_f32 v61, v61, v73
    v_lshlrev_b32 v72, 16, v67
    v_and_b32 v73, 0xffff0000, v67
    v_add_f32 v62, v62, v72
    v_add_f32 v63, v63, v73
    v_cvt_pk_bf16_f32 v74, v60, v61
    v_cvt_pk_bf16_f32 v75, v62, v63
    global_store_dwordx2 v6, v[74:75], s[10:11] offset:32
    global_load_dwordx2 v[80:81], v7, s[12:13] offset:48
    global_load_dwordx4 v[84:87], v2, s[14:15] offset:96
    global_load_dwordx2 v[82:83], v6, s[16:17] offset:48
    v_accvgpr_read_b32 v76, a12
    v_accvgpr_read_b32 v77, a13
    v_accvgpr_read_b32 v78, a14
    v_accvgpr_read_b32 v79, a15
    v_cvt_pk_bf16_f32 v88, v76, v77
    v_lshlrev_b32 v76, 16, v88
    v_and_b32 v77, 0xffff0000, v88
    v_cvt_pk_bf16_f32 v88, v78, v79
    v_lshlrev_b32 v78, 16, v88
    v_and_b32 v79, 0xffff0000, v88
    s_waitcnt vmcnt(0)
    v_lshlrev_b32 v88, 16, v80
    v_and_b32 v89, 0xffff0000, v80
    v_add_f32 v76, v76, v88
    v_add_f32 v77, v77, v89
    v_lshlrev_b32 v88, 16, v81
    v_and_b32 v89, 0xffff0000, v81
    v_add_f32 v78, v78, v88
    v_add_f32 v79, v79, v89
    v_cvt_pk_bf16_f32 v88, v76, v77
    v_lshlrev_b32 v76, 16, v88
    v_and_b32 v77, 0xffff0000, v88
    v_cvt_pk_bf16_f32 v88, v78, v79
    v_lshlrev_b32 v78, 16, v88
    v_and_b32 v79, 0xffff0000, v88
    v_mul_f32 v76, v76, v84
    v_mul_f32 v77, v77, v85
    v_mul_f32 v78, v78, v86
    v_mul_f32 v79, v79, v87
    v_cvt_pk_bf16_f32 v88, v76, v77
    v_lshlrev_b32 v76, 16, v88
    v_and_b32 v77, 0xffff0000, v88
    v_cvt_pk_bf16_f32 v88, v78, v79
    v_lshlrev_b32 v78, 16, v88
    v_and_b32 v79, 0xffff0000, v88
    v_lshlrev_b32 v88, 16, v82
    v_and_b32 v89, 0xffff0000, v82
    v_add_f32 v76, v76, v88
    v_add_f32 v77, v77, v89
    v_lshlrev_b32 v88, 16, v83
    v_and_b32 v89, 0xffff0000, v83
    v_add_f32 v78, v78, v88
    v_add_f32 v79, v79, v89
    v_cvt_pk_bf16_f32 v90, v76, v77
    v_cvt_pk_bf16_f32 v91, v78, v79
    global_store_dwordx2 v6, v[90:91], s[10:11] offset:48
    s_waitcnt vmcnt(0)
end_f2_1:
    s_barrier
    s_add_u32 s90, s90, 16
    s_branch wl_chain_41
sk_chain_42:
end_chain_1:
    s_endpgm
.section .rodata,"a"
.p2align 6
.amdhsa_kernel chain_kernel
  .amdhsa_next_free_vgpr 512
  .amdhsa_next_free_sgpr 102
  .amdhsa_accum_offset 256
  .amdhsa_group_segment_fixed_size 0
  .amdhsa_kernarg_size 136
  .amdhsa_user_sgpr_count 2
  .amdhsa_user_sgpr_kernarg_segment_ptr 1
  .amdhsa_system_sgpr_workgroup_id_x 1
.end_amdhsa_kernel
```
